```python
import torch

def _softmax(x, axis=-1):
    return torch.softmax(x, dim=axis)
def _gelu(x):
    return torch.nn.functional.gelu(x, approximate="tanh")
def _silu(x):
    return torch.nn.functional.silu(x)
def _sigmoid(x):
    return torch.sigmoid(x)
def _layernorm(x, axis=-1, eps=1e-5):
    m = x.mean(dim=axis, keepdim=True)
    v = x.var(dim=axis, keepdim=True, unbiased=False)
    return (x - m) / torch.sqrt(v + eps)
def _scatter_add(tgt, idx, src, axis=0):
    return tgt.clone().index_add_(axis, idx, src)
def _segment_sum(src, seg, n):
    out = torch.zeros((n,) + src.shape[1:], dtype=src.dtype)
    return out.index_add_(0, seg, src)
def _pad(x, pw):
    flat = tuple(v for pair in reversed(pw) for v in pair)
    return torch.nn.functional.pad(x, flat)

kernel_name = 'gated_mix__sliding_block__sliding_local_dilated__prompt'

def setup_inputs():

    _w = (lambda a: (lambda t: t.to(torch.bfloat16) if t.is_floating_point() else t)(torch.as_tensor(a)))
    def _A_setup():
        B, S, D = 1, 2048, 640
        return {
            "x": _w((lambda *s: torch.randn(*s, dtype=torch.bfloat16) * 0.05)(B, S, D)),
            "wqkv": _w((lambda *s: torch.randn(*s, dtype=torch.bfloat16) * 0.8)(D, 3 * D)),
            "wo": _w((lambda *s: torch.randn(*s, dtype=torch.bfloat16) * 0.05)(D, D)),
        }
    _A_in = _A_setup()

    def _B_setup():
        B, S, D = 1, 2048, 640
        return {
            "x": _w((lambda *s: torch.randn(*s, dtype=torch.bfloat16) * 0.05)(B, S, D)),
            "wqkv": _w((lambda *s: torch.randn(*s, dtype=torch.bfloat16) * 0.8)(D, 3 * D)),
            "wo": _w((lambda *s: torch.randn(*s, dtype=torch.bfloat16) * 0.05)(D, D)),
        }
    _B_in = _B_setup()

    return {
        "A_x": _A_in["x"],
        "A_wqkv": _A_in["wqkv"],
        "A_wo": _A_in["wo"],
        "B_x": _B_in["x"],
        "B_wqkv": _B_in["wqkv"],
        "B_wo": _B_in["wo"],
        "gate_w": _w((lambda *s: torch.randn(*s, dtype=torch.bfloat16) * 0.05)(640) * 16.0),
    }

def reference(A_x, A_wqkv, A_wo, B_x, B_wqkv, B_wo, gate_w):
    def _A_ref(x, wqkv, wo):
        B, S, D = x.shape
        H = 32; Dh = D // H; W = 256
        qkv = (lambda x, *d: x.permute(*d))((x @ wqkv).reshape(B, S, 3, H, Dh), 2, 0, 3, 1, 4)
        q, k, v = qkv[0], qkv[1], qkv[2]
        scores = torch.einsum("bhqd,bhkd->bhqk", q, k) * (Dh ** -0.5)
        idx = torch.arange(S)
        mask = (idx[:, None] - idx[None, :] >= 0) & (idx[:, None] - idx[None, :] < W)
        scores = torch.where(mask[None, None], scores, -1e9)
        p = _softmax(scores, axis=-1)
        o = torch.einsum("bhqk,bhkd->bhqd", p, v)
        return (lambda x, *d: x.permute(*d))(o, 0, 2, 1, 3).reshape(B, S, D) @ wo

    def _B_ref(x, wqkv, wo):
        B, S, D = x.shape
        H = 32; Dh = D // H
        W, dil = 8, 2
        qkv = (lambda x, *d: x.permute(*d))((x @ wqkv).reshape(B, S, 3, H, Dh), 2, 0, 3, 1, 4)
        q, k, v = qkv[0], qkv[1], qkv[2]
        scale = Dh ** -0.5
        pos = torch.arange(S)
        off = torch.arange(W) * dil
        idx = pos[:, None] - off[None, :]
        mask = idx >= 0
        idx_c = torch.where(mask, idx, 0).reshape(-1)
        kg = k[:, :, idx_c, :].reshape(B, H, S, W, Dh)
        vg = v[:, :, idx_c, :].reshape(B, H, S, W, Dh)
        logits = torch.einsum("bhsd,bhswd->bhsw", q, kg) * scale
        logits = torch.where(mask[None, None, :, :], logits, -1e9)
        attn = _softmax(logits, axis=-1)
        o = torch.einsum("bhsw,bhswd->bhsd", attn, vg)
        return (lambda x, *d: x.permute(*d))(o, 0, 2, 1, 3).reshape(B, S, D) @ wo

    x = A_x
    g = _sigmoid((x * gate_w).sum(-1, keepdims=True))
    a = _A_ref(x, A_wqkv, A_wo)
    b = _B_ref(x, B_wqkv, B_wo)
    return g * a + (1 - g) * b
```

```asm
; @launch grid=(256,1,1) block=(256,1,1) lds=163840
.amdgcn_target "amdgcn-amd-amdhsa--gfx950"
.text
.globl gated_mix__sliding_block__sliding_local_dilated__prompt_kernel
.p2align 8
.type gated_mix__sliding_block__sliding_local_dilated__prompt_kernel,@function
gated_mix__sliding_block__sliding_local_dilated__prompt_kernel:
    s_load_dwordx2 s[4:5], s[0:1], 0
    s_load_dwordx2 s[8:9], s[0:1], 8
    s_getpc_b64 s[28:29]
    s_andn2_b32 s37, s2, 7
    v_min_u32 v132, 7, v0
    s_cmpk_ge_u32 s2, 0x100
    s_cbranch_scc1 L_end
    v_add_lshl_u32 v132, v132, s37, 7
    global_load_dword v133, v132, s[28:29]
    v_readfirstlane_b32 s94, v0
    v_and_b32 v1, 63, v0
    s_and_b32 s32, s2, 7
    s_lshr_b32 s33, s2, 3
    s_and_b32 s38, s33, 7
    s_and_b32 s37, s2, 2
    s_lshl2_add_u32 s34, s37, s38
    s_lshl_b32 s6, 5, 19
    s_lshl_b32 s7, 1, 17
    s_lshr_b32 s36, s94, 6
    s_lshl_b32 s92, s2, 3
    s_and_b32 s92, s92, 32
    s_xor_b32 s92, s92, s2
    s_andn2_b32 s93, 0xe1, s92
    s_cbranch_scc0 L_spare
    s_lshr_b32 s39, s2, 6
    s_lshr_b32 s40, s32, 2
    s_add_u32 s91, s38, s39
    s_and_b32 s91, s91, 1
    s_lshl1_add_u32 s37, s40, s32
    s_and_b32 s37, s37, 3
    s_mul_i32 s91, s91, 5
    s_add_u32 s91, s91, s37
    s_lshl_b32 s92, s91, 7
    v_lshrrev_b32 v22, 4, v1
    v_lshrrev_b32 v23, 3, v1
    v_and_b32 v24, 7, v1
    s_lshl2_add_u32 s37, s34, s36
    v_xor_b32 v24, v24, v22
    v_lshl_add_u32 v23, s37, 5, v23
    s_lshl_b32 m0, s94, 6
    v_mul_u32_u24 v23, 1280, v23
    s_bitset1_b32 m0, 16
    v_lshl_add_u32 v6, v24, 4, v23
    s_waitcnt lgkmcnt(0)
    buffer_load_dwordx4 v6, s[4:7], s92 offen offset:0 lds
    s_addk_i32 s92, 9216
    v_xor_b32 v7, 64, v6
    buffer_load_dwordx4 v7, s[4:7], s92 offen offset:1024 lds
    s_addk_i32 s92, 9216
    buffer_load_dwordx4 v6, s[4:7], s92 offen offset:2048 lds
    s_addk_i32 s92, 9216
    buffer_load_dwordx4 v7, s[4:7], s92 offen offset:3072 lds
    s_bitset0_b32 m0, 16
    s_lshl1_add_u32 s35, s39, s40
    s_and_b32 s37, s2, 1
    s_lshl3_add_u32 s35, s37, s35
    s_min_u32 s35, s35, 14
    s_mov_b32 s10, 2457600
    s_mov_b32 s11, s7
    s_mul_i32 s92, s91, 245760
    v_and_b32 v23, 15, v1
    v_lshlrev_b32 v24, 1, v22
    v_xor_b32 v23, v23, v24
    s_lshl_b32 s37, s35, 4
    v_lshl_add_u32 v24, s36, 4, v22
    s_movk_i32 s38, 3840
    v_add_lshl_u32 v23, v23, s37, 4
    v_mad_u32_u24 v2, v24, s38, v23
    buffer_load_dwordx4 v2, s[8:11], s92 offen offset:0 lds
    s_addk_i32 s92, 14336
    v_xor_b32 v4, 128, v2
    buffer_load_dwordx4 v2, s[8:11], s92 offen offset:1024 lds
    s_addk_i32 s92, 14336
    buffer_load_dwordx4 v4, s[8:11], s92 offen offset:2048 lds
    s_addk_i32 s92, 14336
    buffer_load_dwordx4 v4, s[8:11], s92 offen offset:3072 lds
    s_load_dwordx2 s[12:13], s[0:1], 32
    s_load_dwordx2 s[16:17], s[0:1], 72
    s_load_dwordx2 s[20:21], s[0:1], 56
    s_load_dwordx2 s[24:25], s[0:1], 64
    v_add_u32 v8, 18432, v6
    v_add_u32 v9, 27648, v7
    v_add_u32 v7, 9216, v7
    v_add_u32 v3, 14336, v2
    v_add_u32 v5, 43008, v4
    v_add_u32 v4, 28672, v4
    s_lshl_b32 s44, s36, 12
    s_add_u32 s45, s44, 65536
    s_mul_i32 s60, s91, 245760
    s_lshl_b32 s70, s91, 7
    s_add_u32 s91, s91, 1
    s_cmp_eq_u32 s91, 10
    s_cselect_b32 s91, 0, s91
    s_mul_i32 s61, s91, 245760
    s_lshl_b32 s71, s91, 7
    s_add_u32 s91, s91, 1
    s_cmp_eq_u32 s91, 10
    s_cselect_b32 s91, 0, s91
    s_add_u32 m0, s45, 16384
    s_mul_i32 s62, s91, 245760
    s_lshl_b32 s72, s91, 7
    s_add_u32 s91, s91, 1
    s_cmp_eq_u32 s91, 10
    s_cselect_b32 s91, 0, s91
    s_mul_i32 s63, s91, 245760
    s_lshl_b32 s73, s91, 7
    buffer_load_dwordx4 v6, s[4:7], s71 offen offset:0 lds
    s_add_u32 s91, s91, 1
    v_lshrrev_b32 v22, 4, v1
    v_bfe_u32 v23, v1, 2, 2
    v_lshl_add_u32 v24, v22, 3, v23
    v_lshlrev_b32 v24, 8, v24
    v_bfe_u32 v26, v1, 2, 3
    v_lshl_add_u32 v24, v26, 5, v24
    buffer_load_dwordx4 v7, s[4:7], s71 offen offset:1024 lds
    v_and_b32 v26, 3, v1
    v_lshl_add_u32 v24, v26, 3, v24
    s_and_b32 s37, s36, 1
    s_lshr_b32 s38, s36, 1
    s_lshl_b32 s39, s37, 7
    v_xor_b32 v10, s39, v24
    v_xor_b32 v11, 32, v10
    buffer_load_dwordx4 v8, s[4:7], s71 offen offset:2048 lds
    v_xor_b32 v12, 64, v10
    v_xor_b32 v13, 96, v10
    v_and_b32 v23, 15, v1
    v_bfe_u32 v24, v1, 1, 3
    v_xor_b32 v24, v24, v22
    v_lshlrev_b32 v24, 4, v24
    v_lshl_add_u32 v24, v23, 7, v24
    buffer_load_dwordx4 v9, s[4:7], s71 offen offset:3072 lds
    s_add_u32 m0, s44, 16384
    s_lshl_b32 s39, s38, 13
    s_add_u32 s39, s39, 65536
    v_add_u32 v14, s39, v24
    v_xor_b32 v15, 64, v14
    s_lshl_b32 s39, s34, 1
    s_add_u32 s39, s39, s38
    s_lshl_b32 s39, s39, 10
    buffer_load_dwordx4 v2, s[8:11], s61 offen offset:0 lds
    v_and_b32 v24, 1, v22
    v_lshrrev_b32 v22, 1, v22
    v_lshl_add_u32 v22, v24, 1, v22
    v_lshlrev_b32 v22, 15, v22
    v_lshl_add_u32 v22, v23, 4, v22
    v_add_u32 v16, s39, v22
    s_lshl_b32 s41, s35, 1
    buffer_load_dwordx4 v3, s[8:11], s61 offen offset:1024 lds
    s_add_u32 s41, s41, s37
    s_lshl_b32 s41, s41, 18
    s_cmp_lt_u32 s35, 5
    s_cselect_b32 s42, 0x3ea52b5c, 1.0
    s_cselect_b32 s52, -2, -1
    s_mov_b32 s18, 18489344
    s_mov_b32 s19, 0x20000
    s_mov_b32 s26, 256
    s_mov_b32 s27, 0x20000
    buffer_load_dwordx4 v4, s[8:11], s61 offen offset:2048 lds
    s_mov_b32 s31, 0x20000
    v_or_b32 v17, s36, v1
    v_cmp_eq_u32 vcc, 0, v17
    v_mov_b32 v21, 1073741824
    v_mov_b32 v18, 1
    v_lshlrev_b32 v20, 4, v1
    v_cndmask_b32 v17, v21, 0, vcc
    buffer_load_dwordx4 v5, s[8:11], s61 offen offset:3072 lds
    s_mov_b32 s14, 2457600
    s_mov_b32 s15, 0x20000
    v_lshrrev_b32 v134, 1, v1
    v_mul_u32_u24 v134, 3840, v134
    v_and_b32 v135, 1, v1
    v_lshl_add_u32 v134, v135, 7, v134
    s_waitcnt vmcnt(8)
    s_barrier
    ds_read_b128 a[0:3], v14 offset:0
    ds_read_b128 a[4:7], v14 offset:2048
    ds_read_b128 a[8:11], v14 offset:4096
    ds_read_b128 a[12:15], v14 offset:6144
    ds_read_b64_tr_b16 v[48:49], v10 offset:0
    ds_read_b64_tr_b16 v[50:51], v10 offset:1024
    ds_read_b64_tr_b16 v[52:53], v11 offset:0
    ds_read_b64_tr_b16 v[54:55], v11 offset:1024
    s_waitcnt lgkmcnt(0)
    v_mfma_f32_16x16x32_bf16 v[64:67], v[48:51], a[0:3], 0
    v_cmp_gt_u32 vcc, 40, v1
    s_and_b32 s56, s34, 7
    s_lshl_b32 s56, s56, 2
    v_mfma_f32_16x16x32_bf16 v[72:75], v[48:51], a[4:7], 0
    s_add_u32 s56, s56, s36
    v_cndmask_b32 v134, v21, v134, vcc
    s_mul_i32 s56, s56, 76800
    v_mfma_f32_16x16x32_bf16 v[80:83], v[48:51], a[8:11], 0
    s_lshl_b32 s57, s35, 8
    s_add_u32 s56, s56, s57
    s_cmp_ge_u32 s70, 640
    s_cselect_b32 s58, 640, 0
    v_mfma_f32_16x16x32_bf16 v[88:91], v[48:51], a[12:15], 0
    s_sub_u32 s58, s70, s58
    v_cmp_gt_u32 vcc, 30, v1
    v_mfma_f32_16x16x32_bf16 v[92:95], v[52:55], a[12:15], 0
    ds_read_b64_tr_b16 v[56:57], v12 offset:0
    ds_read_b64_tr_b16 v[58:59], v12 offset:1024
    s_cmp_ge_u32 s58, 256
    s_cselect_b64 s[58:59], -1, 0
    s_xor_b64 vcc, vcc, s[58:59]
    v_cndmask_b32 v134, v21, v134, vcc
    v_mfma_f32_16x16x32_bf16 v[84:87], v[52:55], a[8:11], 0
    s_add_u32 m0, s45, 32768
    s_and_b32 s50, s33, 7
    s_lshl_b32 s50, s50, 1
    s_add_u32 s50, s50, s36
    v_mfma_f32_16x16x32_bf16 v[76:79], v[52:55], a[4:7], 0
    s_cmp_ge_u32 s50, 2
    s_cselect_b32 s43, 0, 1073741824
    s_cselect_b32 s50, 0x3f803f80, 0
    v_mov_b32 v128, s50
    v_mfma_f32_16x16x32_bf16 v[68:71], v[52:55], a[0:3], 0
    buffer_load_dwordx4 v6, s[4:7], s72 offen offset:0 lds
    v_mov_b32 v129, s50
    v_mov_b32 v130, s50
    v_mov_b32 v131, s50
    s_waitcnt lgkmcnt(0)
    v_mfma_f32_16x16x32_bf16 v[96:99], v[56:59], a[0:3], 0
    ds_read_b64_tr_b16 v[60:61], v13 offset:0
    ds_read_b64_tr_b16 v[62:63], v13 offset:1024
    s_lshl_b32 s50, s36, 11
    s_add_u32 s50, s50, 150144
    v_add_u32 v132, s50, v20
    v_mfma_f32_16x16x32_bf16 v[104:107], v[56:59], a[4:7], 0
    ds_read_b128 a[16:19], v15 offset:0
    ds_write_b128 v132, v[128:131]
    ds_write_b128 v132, v[128:131] offset:1024
    v_mfma_f32_16x16x32_bf16 v[112:115], v[56:59], a[8:11], 0
    ds_read_b128 a[20:23], v15 offset:2048
    buffer_load_dwordx4 v7, s[4:7], s72 offen offset:1024 lds
    s_cmp_eq_u32 s36, 0
    s_cselect_b32 s58, 0xffffffff, 0
    s_cselect_b32 s59, 0x1, 0
    s_cmp_eq_u32 s36, 1
    s_cselect_b32 s59, 0xfffffffe, s59
    s_cmp_eq_u32 s36, 2
    s_cselect_b32 s59, 0xaaaa0000, s59
    v_mfma_f32_16x16x32_bf16 v[120:123], v[56:59], a[12:15], 0
    ds_read_b128 a[24:27], v15 offset:4096
    v_mov_b32 v138, 0xff800000
    s_lshl_b32 s50, s36, 8
    s_add_u32 s50, s50, 158464
    s_waitcnt lgkmcnt(5)
    v_mfma_f32_16x16x32_bf16 v[124:127], v[60:63], a[12:15], 0
    ds_read_b64_tr_b16 v[48:49], v10 offset:8192
    ds_read_b64_tr_b16 v[50:51], v10 offset:9216
    ds_read_b128 a[28:31], v15 offset:6144
    v_cndmask_b32 v138, v138, 0, s[58:59]
    v_lshl_add_u32 v139, v1, 2, s50
    v_mfma_f32_16x16x32_bf16 v[116:119], v[60:63], a[8:11], 0
    buffer_load_dwordx4 v8, s[4:7], s72 offen offset:2048 lds
    ds_write_b32 v139, v138
    s_cmp_eq_u32 s91, 10
    s_cselect_b32 s91, 0, s91
    s_mul_i32 s64, s91, 245760
    v_mfma_f32_16x16x32_bf16 v[108:111], v[60:63], a[4:7], 0
    s_lshl_b32 s74, s91, 7
    s_add_u32 s91, s91, 1
    s_cmp_eq_u32 s91, 10
    s_cselect_b32 s91, 0, s91
    v_mfma_f32_16x16x32_bf16 v[100:103], v[60:63], a[0:3], 0
    s_mul_i32 s65, s91, 245760
    s_lshl_b32 s75, s91, 7
    s_waitcnt lgkmcnt(1)
    v_mfma_f32_16x16x32_bf16 v[64:67], v[48:51], a[16:19], v[64:67]
    ds_read_b64_tr_b16 v[52:53], v11 offset:8192
    ds_read_b64_tr_b16 v[54:55], v11 offset:9216
    buffer_load_dwordx4 v9, s[4:7], s72 offen offset:3072 lds
    s_add_u32 s91, s91, 1
    s_cmp_eq_u32 s91, 10
    s_cselect_b32 s91, 0, s91
    s_mul_i32 s66, s91, 245760
    v_mfma_f32_16x16x32_bf16 v[72:75], v[48:51], a[20:23], v[72:75]
    s_lshl_b32 s76, s91, 7
    s_add_u32 s91, s91, 1
    s_cmp_eq_u32 s91, 10
    s_cselect_b32 s91, 0, s91
    v_mfma_f32_16x16x32_bf16 v[80:83], v[48:51], a[24:27], v[80:83]
    s_mul_i32 s67, s91, 245760
    s_lshl_b32 s77, s91, 7
    v_mfma_f32_16x16x32_bf16 v[88:91], v[48:51], a[28:31], v[88:91]
    s_add_u32 m0, s44, 32768
    s_add_u32 s91, s91, 1
    s_cmp_eq_u32 s91, 10
    s_cselect_b32 s91, 0, s91
    s_mul_i32 s68, s91, 245760
    s_waitcnt lgkmcnt(0)
    v_mfma_f32_16x16x32_bf16 v[92:95], v[52:55], a[28:31], v[92:95]
    ds_read_b64_tr_b16 v[56:57], v12 offset:8192
    ds_read_b64_tr_b16 v[58:59], v12 offset:9216
    s_lshl_b32 s78, s91, 7
    s_add_u32 s91, s91, 1
    s_cmp_eq_u32 s91, 10
    s_cselect_b32 s91, 0, s91
    v_mfma_f32_16x16x32_bf16 v[84:87], v[52:55], a[24:27], v[84:87]
    buffer_load_dwordx4 v2, s[8:11], s62 offen offset:0 lds
    s_mul_i32 s69, s91, 245760
    s_lshl_b32 s79, s91, 7
    v_mfma_f32_16x16x32_bf16 v[76:79], v[52:55], a[20:23], v[76:79]
    s_waitcnt vmcnt(5)
    s_barrier
    s_add_u32 s91, s91, 1
    s_mov_b32 s14, 2457600
    s_mov_b32 s15, 0x20000
    v_mfma_f32_16x16x32_bf16 v[68:71], v[52:55], a[16:19], v[68:71]
    s_mov_b32 s22, 2621440
    s_mov_b32 s23, 0x20000
    s_mov_b32 s96, 18423808
    s_waitcnt lgkmcnt(0)
    v_mfma_f32_16x16x32_bf16 v[96:99], v[56:59], a[16:19], v[96:99]
    ds_read_b64_tr_b16 v[60:61], v13 offset:8192
    ds_read_b64_tr_b16 v[62:63], v13 offset:9216
    buffer_load_dwordx4 v3, s[8:11], s62 offen offset:1024 lds
    s_mov_b32 s97, 18456576
    s_and_b32 s101, s33, 7
    v_mfma_f32_16x16x32_bf16 v[104:107], v[56:59], a[20:23], v[104:107]
    ds_read_b128 a[32:35], v14 offset:16384
    s_lshr_b32 s39, s33, 3
    s_lshl_b32 s37, s32, 2
    s_add_u32 s100, s37, s39
    v_mfma_f32_16x16x32_bf16 v[112:115], v[56:59], a[24:27], v[112:115]
    ds_read_b128 a[36:39], v14 offset:18432
    s_mov_b32 s47, s101
    s_mov_b32 s46, s100
    s_lshr_b32 s100, s32, 1
    v_mfma_f32_16x16x32_bf16 v[120:123], v[56:59], a[28:31], v[120:123]
    ds_read_b128 a[40:43], v14 offset:20480
    buffer_load_dwordx4 v4, s[8:11], s62 offen offset:2048 lds
    buffer_load_dwordx4 v5, s[8:11], s62 offen offset:3072 lds
    s_add_u32 m0, s45, 49152
    s_lshl_b32 s100, s100, 3
    s_lshr_b32 s37, s33, 2
    s_waitcnt lgkmcnt(3)
    v_mfma_f32_16x16x32_bf16 v[124:127], v[60:63], a[28:31], v[124:127]
    ds_read_b64_tr_b16 v[48:49], v10 offset:16384
    ds_read_b64_tr_b16 v[50:51], v10 offset:17408
    ds_read_b128 a[44:47], v14 offset:22528
    s_add_u32 s100, s100, s37
    s_and_b32 s101, s32, 1
    s_lshl_b32 s101, s101, 2
    v_mfma_f32_16x16x32_bf16 v[116:119], v[60:63], a[24:27], v[116:119]
    buffer_load_dwordx4 v6, s[4:7], s73 offen offset:0 lds
    s_and_b32 s37, s33, 3
    s_add_u32 s101, s101, s37
    s_lshl_b32 s49, s47, 8
    v_mfma_f32_16x16x32_bf16 v[108:111], v[60:63], a[20:23], v[108:111]
    s_lshl_b32 s37, s36, 6
    s_add_u32 s49, s49, s37
    v_mfma_f32_16x16x32_bf16 v[100:103], v[60:63], a[16:19], v[100:103]
    s_mul_i32 s92, s46, 5
    s_lshr_b32 s92, s92, 1
    s_and_b32 s40, s46, 1
    s_waitcnt lgkmcnt(0)
    v_mfma_f32_16x16x32_bf16 v[64:67], v[48:51], a[32:35], v[64:67]
    ds_read_b64_tr_b16 v[52:53], v11 offset:16384
    ds_read_b64_tr_b16 v[54:55], v11 offset:17408
    buffer_load_dwordx4 v7, s[4:7], s73 offen offset:1024 lds
    s_add_u32 s93, s92, s40
    s_lshl_b32 s48, s40, 3
    s_lshl_b32 s40, s40, 1
    v_mfma_f32_16x16x32_bf16 v[72:75], v[48:51], a[36:39], v[72:75]
    s_add_u32 s94, s92, 2
    s_sub_u32 s94, s94, s40
    v_mfma_f32_16x16x32_bf16 v[80:83], v[48:51], a[40:43], v[80:83]
    s_lshl_b32 s93, s93, 15
    s_lshl_b32 s94, s94, 15
    s_lshl_b32 s37, s49, 4
    v_mfma_f32_16x16x32_bf16 v[88:91], v[48:51], a[44:47], v[88:91]
    buffer_load_dwordx4 v8, s[4:7], s73 offen offset:2048 lds
    s_add_u32 s84, s93, s37
    s_add_u32 s85, s94, s37
    s_lshl_b32 s95, s47, 1
    s_waitcnt lgkmcnt(0)
    v_mfma_f32_16x16x32_bf16 v[92:95], v[52:55], a[44:47], v[92:95]
    ds_read_b64_tr_b16 v[56:57], v12 offset:16384
    ds_read_b64_tr_b16 v[58:59], v12 offset:17408
    s_add_u32 s95, s95, s36
    s_lshl_b32 s37, s95, 11
    v_mfma_f32_16x16x32_bf16 v[84:87], v[52:55], a[40:43], v[84:87]
    s_add_u32 s86, s93, s37
    s_add_u32 s87, s94, s37
    s_lshl_b32 s88, s36, 11
    v_mfma_f32_16x16x32_bf16 v[76:79], v[52:55], a[36:39], v[76:79]
    buffer_load_dwordx4 v9, s[4:7], s73 offen offset:3072 lds
    s_mul_i32 s89, s36, 4608
    s_add_u32 s89, s89, 131584
    s_lshl_b32 s90, s49, 2
    v_mfma_f32_16x16x32_bf16 v[68:71], v[52:55], a[32:35], v[68:71]
    s_add_u32 s90, s90, 18415616
    s_lshl_b32 s51, s34, 11
    s_waitcnt lgkmcnt(0)
    v_mfma_f32_16x16x32_bf16 v[96:99], v[56:59], a[32:35], v[96:99]
    ds_read_b64_tr_b16 v[60:61], v13 offset:16384
    ds_read_b64_tr_b16 v[62:63], v13 offset:17408
    s_lshl_b32 s37, s35, 7
    s_add_u32 s51, s51, s37
    s_add_u32 s51, s51, 18423808
    v_mfma_f32_16x16x32_bf16 v[104:107], v[56:59], a[36:39], v[104:107]
    ds_read_b128 a[48:51], v15 offset:16384
    s_add_u32 m0, s44, 49152
    s_lshl_b32 s55, s101, 2
    s_add_u32 s55, s55, s36
    s_mul_i32 s55, s55, 25600
    v_mfma_f32_16x16x32_bf16 v[112:115], v[56:59], a[40:43], v[112:115]
    ds_read_b128 a[52:55], v15 offset:18432
    v_and_b32 v27, 60, v1
    v_lshrrev_b32 v45, 5, v1
    v_mfma_f32_16x16x32_bf16 v[120:123], v[56:59], a[44:47], v[120:123]
    ds_read_b128 a[56:59], v15 offset:20480
    buffer_load_dwordx4 v2, s[8:11], s63 offen offset:0 lds
    v_and_b32 v46, 31, v1
    v_bfe_u32 v22, v1, 2, 1
    v_lshl_add_u32 v22, v22, 1, s92
    s_waitcnt lgkmcnt(3)
    v_mfma_f32_16x16x32_bf16 v[124:127], v[60:63], a[44:47], v[124:127]
    ds_read_b64_tr_b16 v[48:49], v10 offset:24576
    ds_read_b64_tr_b16 v[50:51], v10 offset:25600
    ds_read_b128 a[60:63], v15 offset:22528
    v_lshrrev_b32 v22, 4, v22
    v_and_b32 v23, 3, v1
    v_min_u32 v24, 2, v23
    v_mfma_f32_16x16x32_bf16 v[116:119], v[60:63], a[40:43], v[116:119]
    v_mad_u32_u24 v25, v24, 5, v22
    v_mad_u32_u24 v26, v23, 5, v22
    v_mfma_f32_16x16x32_bf16 v[108:111], v[60:63], a[36:39], v[108:111]
    buffer_load_dwordx4 v3, s[8:11], s63 offen offset:1024 lds
    v_min_u32 v26, 15, v26
    s_sub_u32 s38, s95, 2
    s_max_i32 s38, s38, 0
    v_mfma_f32_16x16x32_bf16 v[100:103], v[60:63], a[32:35], v[100:103]
    s_lshl_b32 s38, s38, 11
    s_andn2_b32 s39, s49, 127
    s_lshl_b32 s39, s39, 4
    s_waitcnt lgkmcnt(0)
    v_mfma_f32_16x16x32_bf16 v[64:67], v[48:51], a[48:51], v[64:67]
    ds_read_b64_tr_b16 v[52:53], v11 offset:24576
    ds_read_b64_tr_b16 v[54:55], v11 offset:25600
    v_cmp_eq_u32 vcc, 0, v23
    v_mov_b32 v22, s38
    v_mfma_f32_16x16x32_bf16 v[72:75], v[48:51], a[52:55], v[72:75]
    buffer_load_dwordx4 v4, s[8:11], s63 offen offset:2048 lds
    v_mov_b32 v24, s39
    v_cndmask_b32 v22, v22, v24, vcc
    v_lshl_add_u32 v28, v25, 7, v22
    v_mfma_f32_16x16x32_bf16 v[80:83], v[48:51], a[56:59], v[80:83]
    s_sub_u32 s38, s49, 32
    s_max_i32 s38, s38, 0
    s_andn2_b32 s38, s38, 127
    v_mfma_f32_16x16x32_bf16 v[88:91], v[48:51], a[60:63], v[88:91]
    s_lshl_b32 s38, s38, 4
    v_and_b32 v23, 8, v1
    s_waitcnt lgkmcnt(0)
    v_mfma_f32_16x16x32_bf16 v[92:95], v[52:55], a[60:63], v[92:95]
    ds_read_b64_tr_b16 v[56:57], v12 offset:24576
    ds_read_b64_tr_b16 v[58:59], v12 offset:25600
    buffer_load_dwordx4 v5, s[8:11], s63 offen offset:3072 lds
    v_cmp_eq_u32 vcc, 0, v23
    v_mov_b32 v22, s38
    v_and_b32 v23, 1, v1
    v_mfma_f32_16x16x32_bf16 v[84:87], v[52:55], a[56:59], v[84:87]
    v_cndmask_b32 v22, v22, v24, vcc
    v_lshl_add_u32 v30, v26, 7, v22
    v_cmp_gt_u32 s[38:39], 32, v1
    v_mfma_f32_16x16x32_bf16 v[76:79], v[52:55], a[52:55], v[76:79]
    s_waitcnt vmcnt(8)
    s_barrier
    s_lshr_b32 s37, s100, 1
    s_lshl_b32 s37, s37, 4
    v_mfma_f32_16x16x32_bf16 v[68:71], v[52:55], a[48:51], v[68:71]
    s_add_u32 s37, s37, s36
    v_add_lshl_u32 v22, v23, s37, 7
    v_cndmask_b32 v30, v22, v30, s[38:39]
    s_waitcnt lgkmcnt(0)
    v_mfma_f32_16x16x32_bf16 v[96:99], v[56:59], a[48:51], v[96:99]
    ds_read_b64_tr_b16 v[60:61], v13 offset:24576
    ds_read_b64_tr_b16 v[62:63], v13 offset:25600
    s_lshr_b32 s40, s46, 1
    s_lshl_b32 s40, s40, 7
    v_add_u32 v22, s40, v24
    v_mfma_f32_16x16x32_bf16 v[104:107], v[56:59], a[52:55], v[104:107]
    ds_read_b128 a[64:67], v14 offset:32768
    v_cndmask_b32 v28, v22, v28, s[38:39]
    v_cmp_gt_u32 s[38:39], 48, v1
    v_mfma_f32_16x16x32_bf16 v[112:115], v[56:59], a[56:59], v[112:115]
    ds_read_b128 a[68:71], v14 offset:34816
    s_mul_i32 s40, s36, 3
    s_add_u32 s37, s37, s40
    v_and_b32 v22, 3, v1
    v_mfma_f32_16x16x32_bf16 v[120:123], v[56:59], a[60:63], v[120:123]
    ds_read_b128 a[72:75], v14 offset:36864
    s_add_u32 m0, s45, 0
    v_add_lshl_u32 v22, v22, s37, 7
    v_cndmask_b32 v30, v22, v30, s[38:39]
    s_lshl_b32 s53, s46, 14
    s_waitcnt lgkmcnt(3)
    v_mfma_f32_16x16x32_bf16 v[124:127], v[60:63], a[60:63], v[124:127]
    ds_read_b64_tr_b16 v[48:49], v10 offset:32768
    ds_read_b64_tr_b16 v[50:51], v10 offset:33792
    ds_read_b128 a[76:79], v14 offset:38912
    s_lshl_b32 s40, s49, 3
    s_add_u32 s53, s53, s40
    v_mfma_f32_16x16x32_bf16 v[116:119], v[60:63], a[56:59], v[116:119]
    buffer_load_dwordx4 v6, s[4:7], s74 offen offset:0 lds
    s_add_u32 s53, s53, 17367040
    s_lshl_b32 s37, s36, 1
    s_lshr_b32 s38, s101, 2
    v_mfma_f32_16x16x32_bf16 v[108:111], v[60:63], a[52:55], v[108:111]
    s_add_u32 s37, s37, s38
    s_lshl_b32 s37, s37, 11
    s_add_u32 s37, s37, 1920
    v_mfma_f32_16x16x32_bf16 v[100:103], v[60:63], a[48:51], v[100:103]
    v_lshl_add_u32 v29, v23, 14, s37
    v_cndmask_b32 v28, v29, v28, vcc
    s_waitcnt lgkmcnt(0)
    v_mfma_f32_16x16x32_bf16 v[64:67], v[48:51], a[64:67], v[64:67]
    ds_read_b64_tr_b16 v[52:53], v11 offset:32768
    ds_read_b64_tr_b16 v[54:55], v11 offset:33792
    buffer_load_dwordx4 v7, s[4:7], s74 offen offset:1024 lds
    buffer_load_dword v135, v134, s[12:15], s56 offen
    v_lshlrev_b32 v31, 15, v45
    v_lshl_add_u32 v31, v46, 4, v31
    v_cmp_eq_u32 vcc, 0, v45
    v_mfma_f32_16x16x32_bf16 v[72:75], v[48:51], a[68:71], v[72:75]
    v_lshl_add_u32 v22, v46, 4, s48
    s_cmp_eq_u32 s49, 0
    s_cselect_b32 s99, 1073741824, 0
    v_cndmask_b32 v32, v21, v22, vcc
    v_mfma_f32_16x16x32_bf16 v[80:83], v[48:51], a[72:75], v[80:83]
    v_cndmask_b32 v33, v22, v21, vcc
    v_mov_b32 v23, s99
    v_mfma_f32_16x16x32_bf16 v[88:91], v[48:51], a[76:79], v[88:91]
    buffer_load_dwordx4 v8, s[4:7], s74 offen offset:2048 lds
    v_cndmask_b32 v23, 0, v23, vcc
    v_add3_u32 v38, v23, v20, s48
    v_and_b32 v23, 15, v1
    s_waitcnt lgkmcnt(0)
    v_mfma_f32_16x16x32_bf16 v[92:95], v[52:55], a[76:79], v[92:95]
    ds_read_b64_tr_b16 v[56:57], v12 offset:32768
    ds_read_b64_tr_b16 v[58:59], v12 offset:33792
    v_mov_b32 v43, 0x10000
    v_lshrrev_b32 v22, 4, v1
    v_lshl_add_u32 v24, v22, 15, s84
    v_mfma_f32_16x16x32_bf16 v[84:87], v[52:55], a[72:75], v[84:87]
    v_cmp_eq_u32 vcc, 2, v22
    v_mov_b32 v25, s85
    v_mfma_f32_16x16x32_bf16 v[76:79], v[52:55], a[68:71], v[76:79]
    buffer_load_dwordx4 v9, s[4:7], s74 offen offset:3072 lds
    s_add_u32 s40, s99, 13106944
    v_cndmask_b32 v24, v24, v25, vcc
    v_cmp_eq_u32 vcc, 3, v22
    v_mfma_f32_16x16x32_bf16 v[68:71], v[52:55], a[64:67], v[68:71]
    v_lshl_add_u32 v24, v23, 4, v24
    v_add_u32 v24, s40, v24
    v_cndmask_b32 v39, v24, v21, vcc
    s_waitcnt lgkmcnt(0)
    v_mfma_f32_16x16x32_bf16 v[96:99], v[56:59], a[64:67], v[96:99]
    ds_read_b64_tr_b16 v[60:61], v13 offset:32768
    ds_read_b64_tr_b16 v[62:63], v13 offset:33792
    s_lshl_b32 s37, s36, 10
    v_mul_u32_u24 v22, 8256, v45
    v_mfma_f32_16x16x32_bf16 v[104:107], v[56:59], a[68:71], v[104:107]
    ds_read_b128 a[80:83], v15 offset:32768
    s_add_u32 m0, s44, 0
    v_lshl_add_u32 v22, v46, 4, v22
    s_add_u32 s38, s37, 81920
    v_add_u32 v34, s38, v22
    v_mfma_f32_16x16x32_bf16 v[112:115], v[56:59], a[72:75], v[112:115]
    ds_read_b128 a[84:87], v15 offset:34816
    s_add_u32 s54, s37, 98432
    s_add_u32 s54, s54, s48
    v_bfe_u32 v22, v1, 2, 2
    v_mfma_f32_16x16x32_bf16 v[120:123], v[56:59], a[76:79], v[120:123]
    ds_read_b128 a[88:91], v15 offset:36864
    buffer_load_dwordx4 v2, s[8:11], s64 offen offset:0 lds
    v_lshl_add_u32 v22, v45, 2, v22
    v_lshlrev_b32 v22, 4, v22
    s_waitcnt lgkmcnt(3)
    v_mfma_f32_16x16x32_bf16 v[124:127], v[60:63], a[76:79], v[124:127]
    ds_read_b64_tr_b16 v[48:49], v10 offset:40960
    ds_read_b64_tr_b16 v[50:51], v10 offset:41984
    ds_read_b128 a[92:95], v15 offset:38912
    v_and_b32 v19, 16, v1
    v_cmp_eq_u32 vcc, 0, v19
    v_and_b32 v23, 1, v1
    v_mfma_f32_16x16x32_bf16 v[116:119], v[60:63], a[72:75], v[116:119]
    v_bfe_u32 v24, v1, 1, 1
    v_add_u32 v25, 2, v24
    v_lshlrev_b32 v24, 3, v24
    v_mfma_f32_16x16x32_bf16 v[108:111], v[60:63], a[68:71], v[108:111]
    buffer_load_dwordx4 v3, s[8:11], s64 offen offset:1024 lds
    v_mov_b32 v26, s48
    v_cndmask_b32 v23, v25, v23, vcc
    v_mfma_f32_16x16x32_bf16 v[100:103], v[60:63], a[64:67], v[100:103]
    v_cndmask_b32 v24, v26, v24, vcc
    v_cmp_eq_u32 vcc, 3, v23
    v_add_u32 v22, v22, v24
    s_waitcnt lgkmcnt(0)
    v_mfma_f32_16x16x32_bf16 v[64:67], v[48:51], a[80:83], v[64:67]
    ds_read_b64_tr_b16 v[52:53], v11 offset:40960
    ds_read_b64_tr_b16 v[54:55], v11 offset:41984
    s_add_u32 s38, s37, 106688
    v_mul_u32_u24 v24, 8256, v23
    v_add3_u32 v35, v22, v24, s38
    v_mfma_f32_16x16x32_bf16 v[72:75], v[48:51], a[84:87], v[72:75]
    buffer_load_dwordx4 v4, s[8:11], s64 offen offset:2048 lds
    v_mul_u32_u24 v24, 1088, v23
    v_add3_u32 v36, v22, v24, s89
    v_mfma_f32_16x16x32_bf16 v[80:83], v[48:51], a[88:91], v[80:83]
    s_add_u32 s38, s89, 3264
    v_lshlrev_b32 v24, 8, v23
    v_add3_u32 v37, v22, v24, s38
    v_mfma_f32_16x16x32_bf16 v[88:91], v[48:51], a[92:95], v[88:91]
    s_add_u32 s38, s37, 150144
    v_add_u32 v24, s38, v22
    v_add_u32 v22, 154240, v22
    s_waitcnt lgkmcnt(0)
    v_mfma_f32_16x16x32_bf16 v[92:95], v[52:55], a[92:95], v[92:95]
    ds_read_b64_tr_b16 v[56:57], v12 offset:40960
    ds_read_b64_tr_b16 v[58:59], v12 offset:41984
    buffer_load_dwordx4 v5, s[8:11], s64 offen offset:3072 lds
    v_cndmask_b32 v35, v35, v24, vcc
    v_cndmask_b32 v36, v36, v22, vcc
    v_mfma_f32_16x16x32_bf16 v[84:87], v[52:55], a[88:91], v[84:87]
    v_cndmask_b32 v37, v37, v22, vcc
    v_lshlrev_b32 v22, 2, v45
    v_sub_u32 v22, v22, v46
    v_mfma_f32_16x16x32_bf16 v[76:79], v[52:55], a[84:87], v[76:79]
    s_waitcnt vmcnt(9)
    s_barrier
    v_lshlrev_b32 v22, 2, v22
    v_add_u32 v40, 158592, v22
    s_cmp_eq_u32 s49, 0
    s_cselect_b64 vcc, -1, 0
    v_mfma_f32_16x16x32_bf16 v[68:71], v[52:55], a[80:83], v[68:71]
    v_mov_b32 v22, 158720
    v_cndmask_b32 v41, v40, v22, vcc
    s_waitcnt lgkmcnt(0)
    v_mfma_f32_16x16x32_bf16 v[96:99], v[56:59], a[80:83], v[96:99]
    ds_read_b64_tr_b16 v[60:61], v13 offset:40960
    ds_read_b64_tr_b16 v[62:63], v13 offset:41984
    v_mfma_f32_16x16x32_bf16 v[104:107], v[56:59], a[84:87], v[104:107]
    ds_read_b128 a[96:99], v14 offset:49152
    ds_read_b128 a[100:103], v14 offset:51200
    v_mfma_f32_16x16x32_bf16 v[112:115], v[56:59], a[88:91], v[112:115]
    ds_read_b128 a[104:107], v14 offset:53248
    s_add_u32 m0, s45, 16384
    v_mfma_f32_16x16x32_bf16 v[120:123], v[56:59], a[92:95], v[120:123]
    ds_read_b128 a[108:111], v14 offset:55296
    s_waitcnt lgkmcnt(4)
    v_mfma_f32_16x16x32_bf16 v[124:127], v[60:63], a[92:95], v[124:127]
    ds_read_b64_tr_b16 v[48:49], v10 offset:49152
    ds_read_b64_tr_b16 v[50:51], v10 offset:50176
    v_mfma_f32_16x16x32_bf16 v[116:119], v[60:63], a[88:91], v[116:119]
    buffer_load_dwordx4 v6, s[4:7], s75 offen offset:0 lds
    v_mfma_f32_16x16x32_bf16 v[108:111], v[60:63], a[84:87], v[108:111]
    ds_read_b64_tr_b16 v[52:53], v11 offset:49152
    ds_read_b64_tr_b16 v[54:55], v11 offset:50176
    v_mfma_f32_16x16x32_bf16 v[100:103], v[60:63], a[80:83], v[100:103]
    ds_read_b128 a[112:115], v15 offset:49152
    s_waitcnt lgkmcnt(3)
    v_mfma_f32_16x16x32_bf16 v[64:67], v[48:51], a[96:99], v[64:67]
    buffer_load_dwordx4 v7, s[4:7], s75 offen offset:1024 lds
    v_mfma_f32_16x16x32_bf16 v[72:75], v[48:51], a[100:103], v[72:75]
    buffer_load_dwordx4 v8, s[4:7], s75 offen offset:2048 lds
    v_mfma_f32_16x16x32_bf16 v[80:83], v[48:51], a[104:107], v[80:83]
    ds_read_b64_tr_b16 v[56:57], v12 offset:49152
    ds_read_b64_tr_b16 v[58:59], v12 offset:50176
    v_mfma_f32_16x16x32_bf16 v[88:91], v[48:51], a[108:111], v[88:91]
    ds_read_b128 a[116:119], v15 offset:51200
    s_waitcnt lgkmcnt(4)
    v_mfma_f32_16x16x32_bf16 v[92:95], v[52:55], a[108:111], v[92:95]
    buffer_load_dwordx4 v9, s[4:7], s75 offen offset:3072 lds
    v_mfma_f32_16x16x32_bf16 v[84:87], v[52:55], a[104:107], v[84:87]
    ds_read_b64_tr_b16 v[60:61], v13 offset:49152
    ds_read_b64_tr_b16 v[62:63], v13 offset:50176
    v_mfma_f32_16x16x32_bf16 v[76:79], v[52:55], a[100:103], v[76:79]
    ds_read_b128 a[120:123], v15 offset:53248
    s_add_u32 m0, s44, 16384
    v_mfma_f32_16x16x32_bf16 v[68:71], v[52:55], a[96:99], v[68:71]
    ds_read_b128 a[124:127], v15 offset:55296
    s_waitcnt lgkmcnt(5)
    v_mfma_f32_16x16x32_bf16 v[96:99], v[56:59], a[96:99], v[96:99]
    buffer_load_dwordx4 v2, s[8:11], s65 offen offset:0 lds
    v_mfma_f32_16x16x32_bf16 v[104:107], v[56:59], a[100:103], v[104:107]
    ds_read_b64_tr_b16 v[48:49], v10 offset:57344
    ds_read_b64_tr_b16 v[50:51], v10 offset:58368
    v_mfma_f32_16x16x32_bf16 v[112:115], v[56:59], a[104:107], v[112:115]
    buffer_load_dwordx4 v3, s[8:11], s65 offen offset:1024 lds
    v_mfma_f32_16x16x32_bf16 v[120:123], v[56:59], a[108:111], v[120:123]
    s_waitcnt lgkmcnt(4)
    v_mfma_f32_16x16x32_bf16 v[124:127], v[60:63], a[108:111], v[124:127]
    ds_read_b64_tr_b16 v[52:53], v11 offset:57344
    ds_read_b64_tr_b16 v[54:55], v11 offset:58368
    v_mfma_f32_16x16x32_bf16 v[116:119], v[60:63], a[104:107], v[116:119]
    buffer_load_dwordx4 v4, s[8:11], s65 offen offset:2048 lds
    v_mfma_f32_16x16x32_bf16 v[108:111], v[60:63], a[100:103], v[108:111]
    v_mov_b32 v140, 0
    v_mfma_f32_16x16x32_bf16 v[100:103], v[60:63], a[96:99], v[100:103]
    s_waitcnt lgkmcnt(2)
    v_mfma_f32_16x16x32_bf16 v[64:67], v[48:51], a[112:115], v[64:67]
    ds_read_b64_tr_b16 v[56:57], v12 offset:57344
    ds_read_b64_tr_b16 v[58:59], v12 offset:58368
    v_mfma_f32_16x16x32_bf16 v[72:75], v[48:51], a[116:119], v[72:75]
    buffer_load_dwordx4 v5, s[8:11], s65 offen offset:3072 lds
    v_mfma_f32_16x16x32_bf16 v[80:83], v[48:51], a[120:123], v[80:83]
    v_mov_b32 v141, 0
    v_mov_b32 v142, 0
    v_mfma_f32_16x16x32_bf16 v[88:91], v[48:51], a[124:127], v[88:91]
    s_waitcnt lgkmcnt(2)
    v_mfma_f32_16x16x32_bf16 v[92:95], v[52:55], a[124:127], v[92:95]
    ds_read_b64_tr_b16 v[60:61], v13 offset:57344
    ds_read_b64_tr_b16 v[62:63], v13 offset:58368
    v_mfma_f32_16x16x32_bf16 v[84:87], v[52:55], a[120:123], v[84:87]
    v_mov_b32 v143, 0
    v_mfma_f32_16x16x32_bf16 v[76:79], v[52:55], a[116:119], v[76:79]
    s_waitcnt vmcnt(8)
    s_barrier
    v_mfma_f32_16x16x32_bf16 v[68:71], v[52:55], a[112:115], v[68:71]
    ds_read_b128 a[128:131], v14 offset:0
    s_waitcnt lgkmcnt(3)
    v_mfma_f32_16x16x32_bf16 v[96:99], v[56:59], a[112:115], v[96:99]
    ds_read_b128 a[132:135], v14 offset:2048
    s_lshr_b32 s95, s36, 1
    v_mfma_f32_16x16x32_bf16 v[104:107], v[56:59], a[116:119], v[104:107]
    ds_read_b128 a[136:139], v14 offset:4096
    s_add_u32 m0, s45, 32768
    v_mfma_f32_16x16x32_bf16 v[112:115], v[56:59], a[120:123], v[112:115]
    ds_read_b64_tr_b16 v[48:49], v10 offset:0
    ds_read_b64_tr_b16 v[50:51], v10 offset:1024
    v_mfma_f32_16x16x32_bf16 v[120:123], v[56:59], a[124:127], v[120:123]
    ds_read_b128 a[140:143], v14 offset:6144
    s_waitcnt lgkmcnt(6)
    v_mfma_f32_16x16x32_bf16 v[124:127], v[60:63], a[124:127], v[124:127]
    s_lshl_b32 s95, s95, 4
    s_add_u32 s95, s95, s35
    v_mfma_f32_16x16x32_bf16 v[116:119], v[60:63], a[120:123], v[116:119]
    buffer_load_dwordx4 v6, s[4:7], s76 offen offset:0 lds
    v_mfma_f32_16x16x32_bf16 v[108:111], v[60:63], a[116:119], v[108:111]
    ds_read_b64_tr_b16 v[52:53], v11 offset:0
    ds_read_b64_tr_b16 v[54:55], v11 offset:1024
    v_mfma_f32_16x16x32_bf16 v[100:103], v[60:63], a[112:115], v[100:103]
    s_lshl_b32 s95, s95, 1
    s_waitcnt lgkmcnt(2)
    v_mfma_f32_16x16x32_bf16 v[64:67], v[48:51], a[128:131], v[64:67]
    buffer_load_dwordx4 v7, s[4:7], s76 offen offset:1024 lds
    v_mfma_f32_16x16x32_bf16 v[72:75], v[48:51], a[132:135], v[72:75]
    s_and_b32 s94, s36, 1
    s_add_u32 s95, s95, s94
    v_mfma_f32_16x16x32_bf16 v[80:83], v[48:51], a[136:139], v[80:83]
    buffer_load_dwordx4 v8, s[4:7], s76 offen offset:2048 lds
    v_mfma_f32_16x16x32_bf16 v[88:91], v[48:51], a[140:143], v[88:91]
    s_lshl_b32 s95, s95, 4
    s_waitcnt lgkmcnt(0)
    v_mfma_f32_16x16x32_bf16 v[92:95], v[52:55], a[140:143], v[92:95]
    ds_read_b64_tr_b16 v[56:57], v12 offset:0
    ds_read_b64_tr_b16 v[58:59], v12 offset:1024
    v_mfma_f32_16x16x32_bf16 v[84:87], v[52:55], a[136:139], v[84:87]
    buffer_load_dwordx4 v9, s[4:7], s76 offen offset:3072 lds
    v_mfma_f32_16x16x32_bf16 v[76:79], v[52:55], a[132:135], v[76:79]
    ds_read_b64_tr_b16 v[60:61], v13 offset:0
    ds_read_b64_tr_b16 v[62:63], v13 offset:1024
    v_mfma_f32_16x16x32_bf16 v[68:71], v[52:55], a[128:131], v[68:71]
    s_add_u32 s95, s95, s34
    s_waitcnt lgkmcnt(2)
    v_mfma_f32_16x16x32_bf16 v[96:99], v[56:59], a[128:131], v[96:99]
    ds_read_b128 a[144:147], v15 offset:0
    s_add_u32 m0, s44, 32768
    v_mfma_f32_16x16x32_bf16 v[104:107], v[56:59], a[132:135], v[104:107]
    ds_read_b128 a[148:151], v15 offset:2048
    s_lshl_b32 s95, s95, 10
    v_mfma_f32_16x16x32_bf16 v[112:115], v[56:59], a[136:139], v[112:115]
    ds_read_b128 a[152:155], v15 offset:4096
    ds_read_b128 a[156:159], v15 offset:6144
    v_mfma_f32_16x16x32_bf16 v[120:123], v[56:59], a[140:143], v[120:123]
    buffer_load_dwordx4 v2, s[8:11], s66 offen offset:0 lds
    s_waitcnt lgkmcnt(4)
    v_mfma_f32_16x16x32_bf16 v[124:127], v[60:63], a[140:143], v[124:127]
    ds_read_b64_tr_b16 v[48:49], v10 offset:8192
    ds_read_b64_tr_b16 v[50:51], v10 offset:9216
    s_add_u32 s95, s95, 17367040
    v_mfma_f32_16x16x32_bf16 v[116:119], v[60:63], a[136:139], v[116:119]
    buffer_load_dwordx4 v3, s[8:11], s66 offen offset:1024 lds
    v_mfma_f32_16x16x32_bf16 v[108:111], v[60:63], a[132:135], v[108:111]
    buffer_store_dwordx4 v[140:143], v20, s[16:19], s95 offen sc1
    v_mfma_f32_16x16x32_bf16 v[100:103], v[60:63], a[128:131], v[100:103]
    s_waitcnt lgkmcnt(0)
    v_mfma_f32_16x16x32_bf16 v[64:67], v[48:51], a[144:147], v[64:67]
    ds_read_b64_tr_b16 v[52:53], v11 offset:8192
    ds_read_b64_tr_b16 v[54:55], v11 offset:9216
    v_mfma_f32_16x16x32_bf16 v[72:75], v[48:51], a[148:151], v[72:75]
    buffer_load_dwordx4 v4, s[8:11], s66 offen offset:2048 lds
    v_mfma_f32_16x16x32_bf16 v[80:83], v[48:51], a[152:155], v[80:83]
    ds_read_b64_tr_b16 v[56:57], v12 offset:8192
    ds_read_b64_tr_b16 v[58:59], v12 offset:9216
    v_mfma_f32_16x16x32_bf16 v[88:91], v[48:51], a[156:159], v[88:91]
    s_waitcnt lgkmcnt(2)
    v_mfma_f32_16x16x32_bf16 v[92:95], v[52:55], a[156:159], v[92:95]
    buffer_load_dwordx4 v5, s[8:11], s66 offen offset:3072 lds
    v_mfma_f32_16x16x32_bf16 v[84:87], v[52:55], a[152:155], v[84:87]
    ds_read_b64_tr_b16 v[60:61], v13 offset:8192
    ds_read_b64_tr_b16 v[62:63], v13 offset:9216
    v_mfma_f32_16x16x32_bf16 v[76:79], v[52:55], a[148:151], v[76:79]
    s_waitcnt vmcnt(9)
    s_barrier
    v_mfma_f32_16x16x32_bf16 v[68:71], v[52:55], a[144:147], v[68:71]
    ds_read_b128 a[160:163], v14 offset:16384
    s_waitcnt lgkmcnt(3)
    v_mfma_f32_16x16x32_bf16 v[96:99], v[56:59], a[144:147], v[96:99]
    ds_read_b128 a[164:167], v14 offset:18432
    ds_read_b128 a[168:171], v14 offset:20480
    v_mfma_f32_16x16x32_bf16 v[104:107], v[56:59], a[148:151], v[104:107]
    ds_read_b128 a[172:175], v14 offset:22528
    s_add_u32 m0, s45, 49152
    v_mfma_f32_16x16x32_bf16 v[112:115], v[56:59], a[152:155], v[112:115]
    ds_read_b64_tr_b16 v[48:49], v10 offset:16384
    ds_read_b64_tr_b16 v[50:51], v10 offset:17408
    v_mfma_f32_16x16x32_bf16 v[120:123], v[56:59], a[156:159], v[120:123]
    ds_read_b128 a[176:179], v15 offset:16384
    s_waitcnt lgkmcnt(7)
    v_mfma_f32_16x16x32_bf16 v[124:127], v[60:63], a[156:159], v[124:127]
    buffer_load_dwordx4 v6, s[4:7], s77 offen offset:0 lds
    v_mfma_f32_16x16x32_bf16 v[116:119], v[60:63], a[152:155], v[116:119]
    ds_read_b64_tr_b16 v[52:53], v11 offset:16384
    ds_read_b64_tr_b16 v[54:55], v11 offset:17408
    v_mfma_f32_16x16x32_bf16 v[108:111], v[60:63], a[148:151], v[108:111]
    buffer_load_dwordx4 v7, s[4:7], s77 offen offset:1024 lds
    v_mfma_f32_16x16x32_bf16 v[100:103], v[60:63], a[144:147], v[100:103]
    ds_read_b128 a[180:183], v15 offset:18432
    s_waitcnt lgkmcnt(4)
    v_mfma_f32_16x16x32_bf16 v[64:67], v[48:51], a[160:163], v[64:67]
    buffer_load_dwordx4 v8, s[4:7], s77 offen offset:2048 lds
    v_mfma_f32_16x16x32_bf16 v[72:75], v[48:51], a[164:167], v[72:75]
    ds_read_b64_tr_b16 v[56:57], v12 offset:16384
    ds_read_b64_tr_b16 v[58:59], v12 offset:17408
    v_mfma_f32_16x16x32_bf16 v[80:83], v[48:51], a[168:171], v[80:83]
    buffer_load_dwordx4 v9, s[4:7], s77 offen offset:3072 lds
    v_mfma_f32_16x16x32_bf16 v[88:91], v[48:51], a[172:175], v[88:91]
    ds_read_b128 a[184:187], v15 offset:20480
    s_waitcnt lgkmcnt(4)
    v_mfma_f32_16x16x32_bf16 v[92:95], v[52:55], a[172:175], v[92:95]
    ds_read_b64_tr_b16 v[60:61], v13 offset:16384
    ds_read_b64_tr_b16 v[62:63], v13 offset:17408
    v_mfma_f32_16x16x32_bf16 v[84:87], v[52:55], a[168:171], v[84:87]
    ds_read_b128 a[188:191], v15 offset:22528
    s_add_u32 m0, s44, 49152
    v_mfma_f32_16x16x32_bf16 v[76:79], v[52:55], a[164:167], v[76:79]
    buffer_load_dwordx4 v2, s[8:11], s67 offen offset:0 lds
    v_mfma_f32_16x16x32_bf16 v[68:71], v[52:55], a[160:163], v[68:71]
    s_waitcnt lgkmcnt(4)
    v_mfma_f32_16x16x32_bf16 v[96:99], v[56:59], a[160:163], v[96:99]
    ds_read_b64_tr_b16 v[48:49], v10 offset:24576
    ds_read_b64_tr_b16 v[50:51], v10 offset:25600
    v_mfma_f32_16x16x32_bf16 v[104:107], v[56:59], a[164:167], v[104:107]
    buffer_load_dwordx4 v3, s[8:11], s67 offen offset:1024 lds
    v_mfma_f32_16x16x32_bf16 v[112:115], v[56:59], a[168:171], v[112:115]
    ds_read_b64_tr_b16 v[52:53], v11 offset:24576
    ds_read_b64_tr_b16 v[54:55], v11 offset:25600
    v_mfma_f32_16x16x32_bf16 v[120:123], v[56:59], a[172:175], v[120:123]
    s_waitcnt lgkmcnt(5)
    v_mfma_f32_16x16x32_bf16 v[124:127], v[60:63], a[172:175], v[124:127]
    buffer_load_dwordx4 v4, s[8:11], s67 offen offset:2048 lds
    v_mfma_f32_16x16x32_bf16 v[116:119], v[60:63], a[168:171], v[116:119]
    ds_read_b64_tr_b16 v[56:57], v12 offset:24576
    ds_read_b64_tr_b16 v[58:59], v12 offset:25600
    v_mfma_f32_16x16x32_bf16 v[108:111], v[60:63], a[164:167], v[108:111]
    v_mfma_f32_16x16x32_bf16 v[100:103], v[60:63], a[160:163], v[100:103]
    s_waitcnt lgkmcnt(4)
    v_mfma_f32_16x16x32_bf16 v[64:67], v[48:51], a[176:179], v[64:67]
    buffer_load_dwordx4 v5, s[8:11], s67 offen offset:3072 lds
    v_mfma_f32_16x16x32_bf16 v[72:75], v[48:51], a[180:183], v[72:75]
    ds_read_b64_tr_b16 v[60:61], v13 offset:24576
    ds_read_b64_tr_b16 v[62:63], v13 offset:25600
    v_mfma_f32_16x16x32_bf16 v[80:83], v[48:51], a[184:187], v[80:83]
    v_mfma_f32_16x16x32_bf16 v[88:91], v[48:51], a[188:191], v[88:91]
    s_waitcnt lgkmcnt(4)
    v_mfma_f32_16x16x32_bf16 v[92:95], v[52:55], a[188:191], v[92:95]
    v_mfma_f32_16x16x32_bf16 v[84:87], v[52:55], a[184:187], v[84:87]
    v_mfma_f32_16x16x32_bf16 v[76:79], v[52:55], a[180:183], v[76:79]
    s_waitcnt vmcnt(8)
    s_barrier
    v_mfma_f32_16x16x32_bf16 v[68:71], v[52:55], a[176:179], v[68:71]
    ds_read_b128 a[192:195], v14 offset:32768
    s_waitcnt lgkmcnt(3)
    v_mfma_f32_16x16x32_bf16 v[96:99], v[56:59], a[176:179], v[96:99]
    ds_read_b128 a[196:199], v14 offset:34816
    ds_read_b128 a[200:203], v14 offset:36864
    v_mfma_f32_16x16x32_bf16 v[104:107], v[56:59], a[180:183], v[104:107]
    ds_read_b128 a[204:207], v14 offset:38912
    s_add_u32 m0, s45, 0
    v_mfma_f32_16x16x32_bf16 v[112:115], v[56:59], a[184:187], v[112:115]
    ds_read_b64_tr_b16 v[48:49], v10 offset:32768
    ds_read_b64_tr_b16 v[50:51], v10 offset:33792
    v_mfma_f32_16x16x32_bf16 v[120:123], v[56:59], a[188:191], v[120:123]
    ds_read_b128 a[208:211], v15 offset:32768
    s_waitcnt lgkmcnt(7)
    v_mfma_f32_16x16x32_bf16 v[124:127], v[60:63], a[188:191], v[124:127]
    buffer_load_dwordx4 v6, s[4:7], s78 offen offset:0 lds
    v_mfma_f32_16x16x32_bf16 v[116:119], v[60:63], a[184:187], v[116:119]
    ds_read_b64_tr_b16 v[52:53], v11 offset:32768
    ds_read_b64_tr_b16 v[54:55], v11 offset:33792
    v_mfma_f32_16x16x32_bf16 v[108:111], v[60:63], a[180:183], v[108:111]
    buffer_load_dwordx4 v7, s[4:7], s78 offen offset:1024 lds
    v_mfma_f32_16x16x32_bf16 v[100:103], v[60:63], a[176:179], v[100:103]
    ds_read_b128 a[212:215], v15 offset:34816
    s_waitcnt lgkmcnt(4)
    v_mfma_f32_16x16x32_bf16 v[64:67], v[48:51], a[192:195], v[64:67]
    buffer_load_dwordx4 v8, s[4:7], s78 offen offset:2048 lds
    v_mfma_f32_16x16x32_bf16 v[72:75], v[48:51], a[196:199], v[72:75]
    ds_read_b64_tr_b16 v[56:57], v12 offset:32768
    ds_read_b64_tr_b16 v[58:59], v12 offset:33792
    v_mfma_f32_16x16x32_bf16 v[80:83], v[48:51], a[200:203], v[80:83]
    buffer_load_dwordx4 v9, s[4:7], s78 offen offset:3072 lds
    v_mfma_f32_16x16x32_bf16 v[88:91], v[48:51], a[204:207], v[88:91]
    ds_read_b128 a[216:219], v15 offset:36864
    s_waitcnt lgkmcnt(4)
    v_mfma_f32_16x16x32_bf16 v[92:95], v[52:55], a[204:207], v[92:95]
    ds_read_b64_tr_b16 v[60:61], v13 offset:32768
    ds_read_b64_tr_b16 v[62:63], v13 offset:33792
    v_mfma_f32_16x16x32_bf16 v[84:87], v[52:55], a[200:203], v[84:87]
    ds_read_b128 a[220:223], v15 offset:38912
    s_add_u32 m0, s44, 0
    v_mfma_f32_16x16x32_bf16 v[76:79], v[52:55], a[196:199], v[76:79]
    buffer_load_dwordx4 v2, s[8:11], s68 offen offset:0 lds
    v_mfma_f32_16x16x32_bf16 v[68:71], v[52:55], a[192:195], v[68:71]
    s_waitcnt lgkmcnt(4)
    v_mfma_f32_16x16x32_bf16 v[96:99], v[56:59], a[192:195], v[96:99]
    ds_read_b64_tr_b16 v[48:49], v10 offset:40960
    ds_read_b64_tr_b16 v[50:51], v10 offset:41984
    v_mfma_f32_16x16x32_bf16 v[104:107], v[56:59], a[196:199], v[104:107]
    buffer_load_dwordx4 v3, s[8:11], s68 offen offset:1024 lds
    v_mfma_f32_16x16x32_bf16 v[112:115], v[56:59], a[200:203], v[112:115]
    ds_read_b64_tr_b16 v[52:53], v11 offset:40960
    ds_read_b64_tr_b16 v[54:55], v11 offset:41984
    v_mfma_f32_16x16x32_bf16 v[120:123], v[56:59], a[204:207], v[120:123]
    s_waitcnt lgkmcnt(5)
    v_mfma_f32_16x16x32_bf16 v[124:127], v[60:63], a[204:207], v[124:127]
    buffer_load_dwordx4 v4, s[8:11], s68 offen offset:2048 lds
    v_mfma_f32_16x16x32_bf16 v[116:119], v[60:63], a[200:203], v[116:119]
    ds_read_b64_tr_b16 v[56:57], v12 offset:40960
    ds_read_b64_tr_b16 v[58:59], v12 offset:41984
    v_mfma_f32_16x16x32_bf16 v[108:111], v[60:63], a[196:199], v[108:111]
    v_mfma_f32_16x16x32_bf16 v[100:103], v[60:63], a[192:195], v[100:103]
    s_waitcnt lgkmcnt(4)
    v_mfma_f32_16x16x32_bf16 v[64:67], v[48:51], a[208:211], v[64:67]
    buffer_load_dwordx4 v5, s[8:11], s68 offen offset:3072 lds
    v_mfma_f32_16x16x32_bf16 v[72:75], v[48:51], a[212:215], v[72:75]
    ds_read_b64_tr_b16 v[60:61], v13 offset:40960
    ds_read_b64_tr_b16 v[62:63], v13 offset:41984
    v_mfma_f32_16x16x32_bf16 v[80:83], v[48:51], a[216:219], v[80:83]
    v_mfma_f32_16x16x32_bf16 v[88:91], v[48:51], a[220:223], v[88:91]
    s_waitcnt lgkmcnt(4)
    v_mfma_f32_16x16x32_bf16 v[92:95], v[52:55], a[220:223], v[92:95]
    v_mfma_f32_16x16x32_bf16 v[84:87], v[52:55], a[216:219], v[84:87]
    v_mfma_f32_16x16x32_bf16 v[76:79], v[52:55], a[212:215], v[76:79]
    s_waitcnt vmcnt(8)
    s_barrier
    v_mfma_f32_16x16x32_bf16 v[68:71], v[52:55], a[208:211], v[68:71]
    ds_read_b128 a[224:227], v14 offset:49152
    s_waitcnt lgkmcnt(3)
    v_mfma_f32_16x16x32_bf16 v[96:99], v[56:59], a[208:211], v[96:99]
    ds_read_b128 a[228:231], v14 offset:51200
    ds_read_b128 a[232:235], v14 offset:53248
    v_mfma_f32_16x16x32_bf16 v[104:107], v[56:59], a[212:215], v[104:107]
    ds_read_b128 a[236:239], v14 offset:55296
    s_add_u32 m0, s45, 16384
    v_mfma_f32_16x16x32_bf16 v[112:115], v[56:59], a[216:219], v[112:115]
    ds_read_b64_tr_b16 v[48:49], v10 offset:49152
    ds_read_b64_tr_b16 v[50:51], v10 offset:50176
    v_mfma_f32_16x16x32_bf16 v[120:123], v[56:59], a[220:223], v[120:123]
    ds_read_b128 a[240:243], v15 offset:49152
    s_waitcnt lgkmcnt(7)
    v_mfma_f32_16x16x32_bf16 v[124:127], v[60:63], a[220:223], v[124:127]
    buffer_load_dwordx4 v6, s[4:7], s79 offen offset:0 lds
    v_mfma_f32_16x16x32_bf16 v[116:119], v[60:63], a[216:219], v[116:119]
    ds_read_b64_tr_b16 v[52:53], v11 offset:49152
    ds_read_b64_tr_b16 v[54:55], v11 offset:50176
    v_mfma_f32_16x16x32_bf16 v[108:111], v[60:63], a[212:215], v[108:111]
    buffer_load_dwordx4 v7, s[4:7], s79 offen offset:1024 lds
    v_mfma_f32_16x16x32_bf16 v[100:103], v[60:63], a[208:211], v[100:103]
    ds_read_b128 a[244:247], v15 offset:51200
    s_waitcnt lgkmcnt(4)
    v_mfma_f32_16x16x32_bf16 v[64:67], v[48:51], a[224:227], v[64:67]
    buffer_load_dword v19, v27, s[24:27], 0 offen offset:0 sc1
    v_mfma_f32_16x16x32_bf16 v[72:75], v[48:51], a[228:231], v[72:75]
    buffer_load_dwordx4 v8, s[4:7], s79 offen offset:2048 lds
    v_mfma_f32_16x16x32_bf16 v[80:83], v[48:51], a[232:235], v[80:83]
    ds_read_b64_tr_b16 v[56:57], v12 offset:49152
    ds_read_b64_tr_b16 v[58:59], v12 offset:50176
    v_mfma_f32_16x16x32_bf16 v[88:91], v[48:51], a[236:239], v[88:91]
    ds_read_b128 a[248:251], v15 offset:53248
    s_waitcnt lgkmcnt(4)
    v_mfma_f32_16x16x32_bf16 v[92:95], v[52:55], a[236:239], v[92:95]
    buffer_load_dwordx4 v9, s[4:7], s79 offen offset:3072 lds
    v_mfma_f32_16x16x32_bf16 v[84:87], v[52:55], a[232:235], v[84:87]
    ds_read_b64_tr_b16 v[60:61], v13 offset:49152
    ds_read_b64_tr_b16 v[62:63], v13 offset:50176
    v_mfma_f32_16x16x32_bf16 v[76:79], v[52:55], a[228:231], v[76:79]
    ds_read_b128 a[252:255], v15 offset:55296
    s_add_u32 m0, s44, 16384
    v_mfma_f32_16x16x32_bf16 v[68:71], v[52:55], a[224:227], v[68:71]
    s_waitcnt lgkmcnt(4)
    v_mfma_f32_16x16x32_bf16 v[96:99], v[56:59], a[224:227], v[96:99]
    buffer_load_dwordx4 v2, s[8:11], s69 offen offset:0 lds
    v_mfma_f32_16x16x32_bf16 v[104:107], v[56:59], a[228:231], v[104:107]
    ds_read_b64_tr_b16 v[48:49], v10 offset:57344
    ds_read_b64_tr_b16 v[50:51], v10 offset:58368
    v_mfma_f32_16x16x32_bf16 v[112:115], v[56:59], a[232:235], v[112:115]
    buffer_load_dwordx4 v3, s[8:11], s69 offen offset:1024 lds
    v_mfma_f32_16x16x32_bf16 v[120:123], v[56:59], a[236:239], v[120:123]
    s_waitcnt lgkmcnt(3)
    v_mfma_f32_16x16x32_bf16 v[124:127], v[60:63], a[236:239], v[124:127]
    ds_read_b64_tr_b16 v[52:53], v11 offset:57344
    ds_read_b64_tr_b16 v[54:55], v11 offset:58368
    v_mfma_f32_16x16x32_bf16 v[116:119], v[60:63], a[232:235], v[116:119]
    buffer_load_dwordx4 v4, s[8:11], s69 offen offset:2048 lds
    v_mfma_f32_16x16x32_bf16 v[108:111], v[60:63], a[228:231], v[108:111]
    ds_read_b64_tr_b16 v[56:57], v12 offset:57344
    ds_read_b64_tr_b16 v[58:59], v12 offset:58368
    v_mfma_f32_16x16x32_bf16 v[100:103], v[60:63], a[224:227], v[100:103]
    s_waitcnt lgkmcnt(4)
    v_mfma_f32_16x16x32_bf16 v[64:67], v[48:51], a[240:243], v[64:67]
    buffer_load_dwordx4 v5, s[8:11], s69 offen offset:3072 lds
    v_mfma_f32_16x16x32_bf16 v[72:75], v[48:51], a[244:247], v[72:75]
    ds_read_b64_tr_b16 v[60:61], v13 offset:57344
    ds_read_b64_tr_b16 v[62:63], v13 offset:58368
    v_mfma_f32_16x16x32_bf16 v[80:83], v[48:51], a[248:251], v[80:83]
    v_mfma_f32_16x16x32_bf16 v[88:91], v[48:51], a[252:255], v[88:91]
    s_waitcnt lgkmcnt(4)
    v_mfma_f32_16x16x32_bf16 v[92:95], v[52:55], a[252:255], v[92:95]
    v_mfma_f32_16x16x32_bf16 v[84:87], v[52:55], a[248:251], v[84:87]
    v_mfma_f32_16x16x32_bf16 v[76:79], v[52:55], a[244:247], v[76:79]
    s_waitcnt vmcnt(9)
    s_barrier
    v_mfma_f32_16x16x32_bf16 v[68:71], v[52:55], a[240:243], v[68:71]
    ds_read_b128 v[192:195], v14 offset:0
    s_waitcnt lgkmcnt(3)
    v_mfma_f32_16x16x32_bf16 v[96:99], v[56:59], a[240:243], v[96:99]
    ds_read_b128 v[196:199], v14 offset:2048
    ds_read_b128 v[200:203], v14 offset:4096
    v_mfma_f32_16x16x32_bf16 v[104:107], v[56:59], a[244:247], v[104:107]
    ds_read_b128 v[204:207], v14 offset:6144
    s_add_u32 m0, s44, 32768
    v_mfma_f32_16x16x32_bf16 v[112:115], v[56:59], a[248:251], v[112:115]
    ds_read_b64_tr_b16 v[48:49], v10 offset:0
    ds_read_b64_tr_b16 v[50:51], v10 offset:1024
    v_mfma_f32_16x16x32_bf16 v[120:123], v[56:59], a[252:255], v[120:123]
    ds_read_b128 v[208:211], v15 offset:0
    s_waitcnt lgkmcnt(7)
    v_mfma_f32_16x16x32_bf16 v[124:127], v[60:63], a[252:255], v[124:127]
    buffer_load_dwordx4 v2, s[12:15], s60 offen offset:0 lds
    v_mfma_f32_16x16x32_bf16 v[116:119], v[60:63], a[248:251], v[116:119]
    ds_read_b64_tr_b16 v[52:53], v11 offset:0
    ds_read_b64_tr_b16 v[54:55], v11 offset:1024
    v_mfma_f32_16x16x32_bf16 v[108:111], v[60:63], a[244:247], v[108:111]
    buffer_load_dwordx4 v3, s[12:15], s60 offen offset:1024 lds
    v_mfma_f32_16x16x32_bf16 v[100:103], v[60:63], a[240:243], v[100:103]
    ds_read_b128 v[212:215], v15 offset:2048
    s_waitcnt lgkmcnt(4)
    v_mfma_f32_16x16x32_bf16 v[64:67], v[48:51], v[192:195], v[64:67]
    buffer_load_dwordx4 v4, s[12:15], s60 offen offset:2048 lds
    v_mfma_f32_16x16x32_bf16 v[72:75], v[48:51], v[196:199], v[72:75]
    ds_read_b64_tr_b16 v[56:57], v12 offset:0
    ds_read_b64_tr_b16 v[58:59], v12 offset:1024
    v_mfma_f32_16x16x32_bf16 v[80:83], v[48:51], v[200:203], v[80:83]
    buffer_load_dwordx4 v5, s[12:15], s60 offen offset:3072 lds
    v_mfma_f32_16x16x32_bf16 v[88:91], v[48:51], v[204:207], v[88:91]
    ds_read_b128 v[216:219], v15 offset:4096
    s_waitcnt lgkmcnt(4)
    v_mfma_f32_16x16x32_bf16 v[92:95], v[52:55], v[204:207], v[92:95]
    ds_read_b64_tr_b16 v[60:61], v13 offset:0
    ds_read_b64_tr_b16 v[62:63], v13 offset:1024
    v_mfma_f32_16x16x32_bf16 v[84:87], v[52:55], v[200:203], v[84:87]
    ds_read_b128 v[220:223], v15 offset:6144
    s_add_u32 m0, s44, 98304
    v_mfma_f32_16x16x32_bf16 v[76:79], v[52:55], v[196:199], v[76:79]
    buffer_load_dwordx4 v2, s[12:15], s61 offen offset:0 lds
    v_mfma_f32_16x16x32_bf16 v[68:71], v[52:55], v[192:195], v[68:71]
    s_waitcnt lgkmcnt(4)
    v_mfma_f32_16x16x32_bf16 v[96:99], v[56:59], v[192:195], v[96:99]
    ds_read_b64_tr_b16 v[48:49], v10 offset:8192
    ds_read_b64_tr_b16 v[50:51], v10 offset:9216
    v_mfma_f32_16x16x32_bf16 v[104:107], v[56:59], v[196:199], v[104:107]
    buffer_load_dwordx4 v3, s[12:15], s61 offen offset:1024 lds
    v_mfma_f32_16x16x32_bf16 v[112:115], v[56:59], v[200:203], v[112:115]
    ds_read_b64_tr_b16 v[52:53], v11 offset:8192
    ds_read_b64_tr_b16 v[54:55], v11 offset:9216
    v_mfma_f32_16x16x32_bf16 v[120:123], v[56:59], v[204:207], v[120:123]
    s_waitcnt lgkmcnt(5)
    v_mfma_f32_16x16x32_bf16 v[124:127], v[60:63], v[204:207], v[124:127]
    buffer_load_dwordx4 v4, s[12:15], s61 offen offset:2048 lds
    v_mfma_f32_16x16x32_bf16 v[116:119], v[60:63], v[200:203], v[116:119]
    ds_read_b64_tr_b16 v[56:57], v12 offset:8192
    ds_read_b64_tr_b16 v[58:59], v12 offset:9216
    v_mfma_f32_16x16x32_bf16 v[108:111], v[60:63], v[196:199], v[108:111]
    v_mfma_f32_16x16x32_bf16 v[100:103], v[60:63], v[192:195], v[100:103]
    s_waitcnt lgkmcnt(4)
    v_mfma_f32_16x16x32_bf16 v[64:67], v[48:51], v[208:211], v[64:67]
    buffer_load_dwordx4 v5, s[12:15], s61 offen offset:3072 lds
    v_mfma_f32_16x16x32_bf16 v[72:75], v[48:51], v[212:215], v[72:75]
    ds_read_b64_tr_b16 v[60:61], v13 offset:8192
    ds_read_b64_tr_b16 v[62:63], v13 offset:9216
    v_mfma_f32_16x16x32_bf16 v[80:83], v[48:51], v[216:219], v[80:83]
    v_mfma_f32_16x16x32_bf16 v[88:91], v[48:51], v[220:223], v[88:91]
    s_waitcnt lgkmcnt(4)
    v_mfma_f32_16x16x32_bf16 v[92:95], v[52:55], v[220:223], v[92:95]
    v_mfma_f32_16x16x32_bf16 v[84:87], v[52:55], v[216:219], v[84:87]
    v_mfma_f32_16x16x32_bf16 v[76:79], v[52:55], v[212:215], v[76:79]
    s_waitcnt vmcnt(8)
    s_barrier
    v_mfma_f32_16x16x32_bf16 v[68:71], v[52:55], v[208:211], v[68:71]
    ds_read_b128 v[224:227], v14 offset:16384
    s_waitcnt lgkmcnt(3)
    v_mfma_f32_16x16x32_bf16 v[96:99], v[56:59], v[208:211], v[96:99]
    ds_read_b128 v[228:231], v14 offset:18432
    ds_read_b128 v[232:235], v14 offset:20480
    v_mfma_f32_16x16x32_bf16 v[104:107], v[56:59], v[212:215], v[104:107]
    ds_read_b128 v[236:239], v14 offset:22528
    s_add_u32 m0, s44, 49152
    v_mfma_f32_16x16x32_bf16 v[112:115], v[56:59], v[216:219], v[112:115]
    ds_read_b64_tr_b16 v[48:49], v10 offset:16384
    ds_read_b64_tr_b16 v[50:51], v10 offset:17408
    v_mfma_f32_16x16x32_bf16 v[120:123], v[56:59], v[220:223], v[120:123]
    ds_read_b128 v[240:243], v15 offset:16384
    s_waitcnt lgkmcnt(7)
    v_mfma_f32_16x16x32_bf16 v[124:127], v[60:63], v[220:223], v[124:127]
    buffer_load_dwordx4 v2, s[12:15], s62 offen offset:0 lds
    v_mfma_f32_16x16x32_bf16 v[116:119], v[60:63], v[216:219], v[116:119]
    ds_read_b64_tr_b16 v[52:53], v11 offset:16384
    ds_read_b64_tr_b16 v[54:55], v11 offset:17408
    v_mfma_f32_16x16x32_bf16 v[108:111], v[60:63], v[212:215], v[108:111]
    buffer_load_dwordx4 v3, s[12:15], s62 offen offset:1024 lds
    v_mfma_f32_16x16x32_bf16 v[100:103], v[60:63], v[208:211], v[100:103]
    ds_read_b128 v[244:247], v15 offset:18432
    s_waitcnt lgkmcnt(4)
    v_mfma_f32_16x16x32_bf16 v[64:67], v[48:51], v[224:227], v[64:67]
    v_cmp_ne_u32 vcc, 1, v19
    s_cbranch_vccnz L_poll_3
L_back_4:
    v_mfma_f32_16x16x32_bf16 v[72:75], v[48:51], v[228:231], v[72:75]
    ds_read_b128 v[248:251], v15 offset:20480
    ds_read_b128 v[252:255], v15 offset:22528
    v_mfma_f32_16x16x32_bf16 v[80:83], v[48:51], v[232:235], v[80:83]
    buffer_load_dwordx4 v4, s[12:15], s62 offen offset:2048 lds
    v_mfma_f32_16x16x32_bf16 v[88:91], v[48:51], v[236:239], v[88:91]
    v_add_u32 v6, s43, v20
    s_waitcnt lgkmcnt(3)
    v_mfma_f32_16x16x32_bf16 v[92:95], v[52:55], v[236:239], v[92:95]
    ds_read_b64_tr_b16 v[56:57], v10 offset:24576
    ds_read_b64_tr_b16 v[58:59], v10 offset:25600
    v_mfma_f32_16x16x32_bf16 v[84:87], v[52:55], v[232:235], v[84:87]
    buffer_load_dwordx4 v5, s[12:15], s62 offen offset:3072 lds
    v_mfma_f32_16x16x32_bf16 v[76:79], v[52:55], v[228:231], v[76:79]
    ds_read_b64_tr_b16 v[60:61], v11 offset:24576
    ds_read_b64_tr_b16 v[62:63], v11 offset:25600
    v_mfma_f32_16x16x32_bf16 v[68:71], v[52:55], v[224:227], v[68:71]
    s_add_u32 m0, s44, 114688
    s_waitcnt lgkmcnt(2)
    v_mfma_f32_16x16x32_bf16 v[64:67], v[56:59], v[240:243], v[64:67]
    v_lshlrev_b32 v7, 2, v46
    v_add_u32 v8, s99, v31
    v_mfma_f32_16x16x32_bf16 v[72:75], v[56:59], v[244:247], v[72:75]
    buffer_load_dwordx4 v2, s[12:15], s63 offen offset:0 lds
    v_mfma_f32_16x16x32_bf16 v[80:83], v[56:59], v[248:251], v[80:83]
    ds_read_b64_tr_b16 v[48:49], v12 offset:16384
    ds_read_b64_tr_b16 v[50:51], v12 offset:17408
    v_mfma_f32_16x16x32_bf16 v[88:91], v[56:59], v[252:255], v[88:91]
    v_add_u32 v9, s54, v20
    s_waitcnt lgkmcnt(2)
    v_mfma_f32_16x16x32_bf16 v[92:95], v[60:63], v[252:255], v[92:95]
    buffer_load_dwordx4 v3, s[12:15], s63 offen offset:1024 lds
    v_mfma_f32_16x16x32_bf16 v[84:87], v[60:63], v[248:251], v[84:87]
    v_lshlrev_b32 v27, 3, v1
    v_add_u32 v14, 65536, v10
    v_mfma_f32_16x16x32_bf16 v[76:79], v[60:63], v[244:247], v[76:79]
    ds_read_b64_tr_b16 v[52:53], v13 offset:16384
    ds_read_b64_tr_b16 v[54:55], v13 offset:17408
    v_mfma_f32_16x16x32_bf16 v[68:71], v[60:63], v[240:243], v[68:71]
    v_add_u32 v15, 65536, v11
    s_waitcnt lgkmcnt(2)
    v_mfma_f32_16x16x32_bf16 v[96:99], v[48:51], v[224:227], v[96:99]
    buffer_load_dwordx4 v4, s[12:15], s63 offen offset:2048 lds
    v_mfma_f32_16x16x32_bf16 v[104:107], v[48:51], v[228:231], v[104:107]
    ds_read_b64_tr_b16 v[56:57], v12 offset:24576
    ds_read_b64_tr_b16 v[58:59], v12 offset:25600
    v_mfma_f32_16x16x32_bf16 v[112:115], v[48:51], v[232:235], v[112:115]
    buffer_load_dwordx4 v5, s[12:15], s63 offen offset:3072 lds
    v_mfma_f32_16x16x32_bf16 v[120:123], v[48:51], v[236:239], v[120:123]
    s_add_u32 s92, s41, 0
    s_waitcnt lgkmcnt(2)
    v_mfma_f32_16x16x32_bf16 v[124:127], v[52:55], v[236:239], v[124:127]
    v_mul_f32 v64, s42, v64
    v_mul_f32 v65, s42, v65
    v_mfma_f32_16x16x32_bf16 v[116:119], v[52:55], v[232:235], v[116:119]
    v_mul_f32 v66, s42, v66
    v_mul_f32 v67, s42, v67
    v_mfma_f32_16x16x32_bf16 v[108:111], v[52:55], v[228:231], v[108:111]
    s_waitcnt vmcnt(12)
    s_barrier
    v_add_u32 v42, 65536, v12
    v_mfma_f32_16x16x32_bf16 v[100:103], v[52:55], v[224:227], v[100:103]
    v_mul_f32 v68, s42, v68
    v_mul_f32 v69, s42, v69
    v_mul_f32 v70, s42, v70
    s_waitcnt lgkmcnt(0)
    v_mfma_f32_16x16x32_bf16 v[96:99], v[56:59], v[240:243], v[96:99]
    ds_read_b64_tr_b16 v[60:61], v13 offset:24576
    ds_read_b64_tr_b16 v[62:63], v13 offset:25600
    v_mul_f32 v71, s42, v71
    v_cvt_pk_bf16_f32 v64, v64, v65
    v_add_u32 v44, 65536, v13
    v_mfma_f32_16x16x32_bf16 v[104:107], v[56:59], v[244:247], v[104:107]
    v_cvt_pk_bf16_f32 v65, v66, v67
    v_cvt_pk_bf16_f32 v66, v68, v69
    v_cvt_pk_bf16_f32 v67, v70, v71
    v_mfma_f32_16x16x32_bf16 v[112:115], v[56:59], v[248:251], v[112:115]
    v_mul_f32 v72, s42, v72
    v_mul_f32 v73, s42, v73
    v_mfma_f32_16x16x32_bf16 v[120:123], v[56:59], v[252:255], v[120:123]
    s_add_u32 m0, s44, 0
    v_mul_f32 v74, s42, v74
    v_mul_f32 v75, s42, v75
    v_mul_f32 v76, s42, v76
    s_waitcnt lgkmcnt(0)
    v_mfma_f32_16x16x32_bf16 v[124:127], v[60:63], v[252:255], v[124:127]
    ds_read_b64_tr_b16 v[48:49], v10 offset:32768
    ds_read_b64_tr_b16 v[50:51], v10 offset:33792
    v_mul_f32 v77, s42, v77
    v_mul_f32 v78, s42, v78
    v_mfma_f32_16x16x32_bf16 v[116:119], v[60:63], v[248:251], v[116:119]
    buffer_load_dwordx4 v2, s[12:15], s64 offen offset:0 lds
    v_mul_f32 v79, s42, v79
    v_cvt_pk_bf16_f32 v72, v72, v73
    v_cvt_pk_bf16_f32 v73, v74, v75
    v_mfma_f32_16x16x32_bf16 v[108:111], v[60:63], v[244:247], v[108:111]
    v_cvt_pk_bf16_f32 v74, v76, v77
    v_cvt_pk_bf16_f32 v75, v78, v79
    v_mfma_f32_16x16x32_bf16 v[100:103], v[60:63], v[240:243], v[100:103]
    v_permlane16_swap_b32 v64, v66
    v_permlane16_swap_b32 v65, v67
    v_and_b32 v64, s52, v64
    s_waitcnt lgkmcnt(0)
    v_mfma_f32_16x16x32_bf16 v[128:131], v[48:51], a[0:3], 0
    ds_read_b64_tr_b16 v[52:53], v11 offset:32768
    ds_read_b64_tr_b16 v[54:55], v11 offset:33792
    buffer_load_dwordx4 v3, s[12:15], s64 offen offset:1024 lds
    buffer_store_dwordx4 v[64:67], v16, s[16:19], s92 offen offset:0 sc1
    v_permlane16_swap_b32 v72, v74
    v_mfma_f32_16x16x32_bf16 v[136:139], v[48:51], a[4:7], 0
    v_permlane16_swap_b32 v73, v75
    v_and_b32 v72, s52, v72
    v_mfma_f32_16x16x32_bf16 v[144:147], v[48:51], a[8:11], 0
    buffer_store_dwordx4 v[72:75], v16, s[16:19], s92 offen offset:256 sc1
    v_mul_f32 v80, s42, v80
    v_mul_f32 v81, s42, v81
    v_mfma_f32_16x16x32_bf16 v[152:155], v[48:51], a[12:15], 0
    buffer_load_dwordx4 v4, s[12:15], s64 offen offset:2048 lds
    v_mul_f32 v82, s42, v82
    v_mul_f32 v83, s42, v83
    v_mul_f32 v84, s42, v84
    s_waitcnt lgkmcnt(0)
    v_mfma_f32_16x16x32_bf16 v[156:159], v[52:55], a[12:15], 0
    ds_read_b64_tr_b16 v[56:57], v12 offset:32768
    ds_read_b64_tr_b16 v[58:59], v12 offset:33792
    v_mul_f32 v85, s42, v85
    v_mul_f32 v86, s42, v86
    v_mfma_f32_16x16x32_bf16 v[148:151], v[52:55], a[8:11], 0
    v_mul_f32 v87, s42, v87
    v_cvt_pk_bf16_f32 v80, v80, v81
    v_cvt_pk_bf16_f32 v81, v82, v83
    v_mfma_f32_16x16x32_bf16 v[140:143], v[52:55], a[4:7], 0
    buffer_load_dwordx4 v5, s[12:15], s64 offen offset:3072 lds
    v_cvt_pk_bf16_f32 v82, v84, v85
    v_cvt_pk_bf16_f32 v83, v86, v87
    v_mfma_f32_16x16x32_bf16 v[132:135], v[52:55], a[0:3], 0
    v_mul_f32 v88, s42, v88
    v_mul_f32 v89, s42, v89
    s_waitcnt lgkmcnt(0)
    v_mfma_f32_16x16x32_bf16 v[160:163], v[56:59], a[0:3], 0
    ds_read_b64_tr_b16 v[60:61], v13 offset:32768
    ds_read_b64_tr_b16 v[62:63], v13 offset:33792
    v_mul_f32 v90, s42, v90
    v_mul_f32 v91, s42, v91
    v_mul_f32 v92, s42, v92
    v_mfma_f32_16x16x32_bf16 v[168:171], v[56:59], a[4:7], 0
    v_mul_f32 v93, s42, v93
    v_mul_f32 v94, s42, v94
    v_mfma_f32_16x16x32_bf16 v[176:179], v[56:59], a[8:11], 0
    v_mul_f32 v95, s42, v95
    v_cvt_pk_bf16_f32 v88, v88, v89
    v_cvt_pk_bf16_f32 v89, v90, v91
    v_mfma_f32_16x16x32_bf16 v[184:187], v[56:59], a[12:15], 0
    v_cvt_pk_bf16_f32 v90, v92, v93
    v_cvt_pk_bf16_f32 v91, v94, v95
    s_waitcnt lgkmcnt(0)
    v_mfma_f32_16x16x32_bf16 v[188:191], v[60:63], a[12:15], 0
    ds_read_b64_tr_b16 v[48:49], v10 offset:40960
    ds_read_b64_tr_b16 v[50:51], v10 offset:41984
    v_permlane16_swap_b32 v80, v82
    v_permlane16_swap_b32 v81, v83
    v_mfma_f32_16x16x32_bf16 v[180:183], v[60:63], a[8:11], 0
    v_and_b32 v80, s52, v80
    v_mfma_f32_16x16x32_bf16 v[172:175], v[60:63], a[4:7], 0
    buffer_store_dwordx4 v[80:83], v16, s[16:19], s92 offen offset:512 sc1
    v_permlane16_swap_b32 v88, v90
    v_permlane16_swap_b32 v89, v91
    v_and_b32 v88, s52, v88
    v_mfma_f32_16x16x32_bf16 v[164:167], v[60:63], a[0:3], 0
    buffer_store_dwordx4 v[88:91], v16, s[16:19], s92 offen offset:768 sc1
    s_add_u32 s92, s41, 131072
    v_mul_f32 v96, s42, v96
    s_waitcnt lgkmcnt(0)
    v_mfma_f32_16x16x32_bf16 v[128:131], v[48:51], a[16:19], v[128:131]
    ds_read_b64_tr_b16 v[52:53], v11 offset:40960
    ds_read_b64_tr_b16 v[54:55], v11 offset:41984
    v_mul_f32 v97, s42, v97
    v_mul_f32 v98, s42, v98
    v_mfma_f32_16x16x32_bf16 v[136:139], v[48:51], a[20:23], v[136:139]
    v_mul_f32 v99, s42, v99
    v_mul_f32 v100, s42, v100
    v_mul_f32 v101, s42, v101
    v_mfma_f32_16x16x32_bf16 v[144:147], v[48:51], a[24:27], v[144:147]
    v_mul_f32 v102, s42, v102
    v_mul_f32 v103, s42, v103
    v_mfma_f32_16x16x32_bf16 v[152:155], v[48:51], a[28:31], v[152:155]
    v_cvt_pk_bf16_f32 v96, v96, v97
    v_cvt_pk_bf16_f32 v97, v98, v99
    v_cvt_pk_bf16_f32 v98, v100, v101
    s_waitcnt lgkmcnt(0)
    v_mfma_f32_16x16x32_bf16 v[156:159], v[52:55], a[28:31], v[156:159]
    ds_read_b64_tr_b16 v[56:57], v12 offset:40960
    ds_read_b64_tr_b16 v[58:59], v12 offset:41984
    v_cvt_pk_bf16_f32 v99, v102, v103
    v_mul_f32 v104, s42, v104
    v_mfma_f32_16x16x32_bf16 v[148:151], v[52:55], a[24:27], v[148:151]
    v_mul_f32 v105, s42, v105
    v_mul_f32 v106, s42, v106
    v_mul_f32 v107, s42, v107
    v_mfma_f32_16x16x32_bf16 v[140:143], v[52:55], a[20:23], v[140:143]
    s_waitcnt vmcnt(16)
    s_barrier
    v_mul_f32 v108, s42, v108
    v_mul_f32 v109, s42, v109
    v_mfma_f32_16x16x32_bf16 v[132:135], v[52:55], a[16:19], v[132:135]
    v_mul_f32 v110, s42, v110
    v_mul_f32 v111, s42, v111
    v_cvt_pk_bf16_f32 v104, v104, v105
    s_waitcnt lgkmcnt(0)
    v_mfma_f32_16x16x32_bf16 v[160:163], v[56:59], a[16:19], v[160:163]
    ds_read_b64_tr_b16 v[60:61], v13 offset:40960
    ds_read_b64_tr_b16 v[62:63], v13 offset:41984
    v_cvt_pk_bf16_f32 v105, v106, v107
    v_cvt_pk_bf16_f32 v106, v108, v109
    v_mfma_f32_16x16x32_bf16 v[168:171], v[56:59], a[20:23], v[168:171]
    v_cvt_pk_bf16_f32 v107, v110, v111
    v_permlane16_swap_b32 v96, v98
    v_permlane16_swap_b32 v97, v99
    v_mfma_f32_16x16x32_bf16 v[176:179], v[56:59], a[24:27], v[176:179]
    v_and_b32 v96, s52, v96
    v_mfma_f32_16x16x32_bf16 v[184:187], v[56:59], a[28:31], v[184:187]
    buffer_store_dwordx4 v[96:99], v16, s[16:19], s92 offen offset:0 sc1
    v_permlane16_swap_b32 v104, v106
    v_permlane16_swap_b32 v105, v107
    v_and_b32 v104, s52, v104
    s_waitcnt lgkmcnt(0)
    v_mfma_f32_16x16x32_bf16 v[188:191], v[60:63], a[28:31], v[188:191]
    ds_read_b64_tr_b16 v[48:49], v14 offset:32768
    ds_read_b64_tr_b16 v[50:51], v14 offset:33792
    buffer_store_dwordx4 v[104:107], v16, s[16:19], s92 offen offset:256 sc1
    v_mul_f32 v112, s42, v112
    v_mfma_f32_16x16x32_bf16 v[180:183], v[60:63], a[24:27], v[180:183]
    v_mul_f32 v113, s42, v113
    v_mul_f32 v114, s42, v114
    v_mul_f32 v115, s42, v115
    v_mfma_f32_16x16x32_bf16 v[172:175], v[60:63], a[20:23], v[172:175]
    v_mul_f32 v116, s42, v116
    v_mul_f32 v117, s42, v117
    v_mfma_f32_16x16x32_bf16 v[164:167], v[60:63], a[16:19], v[164:167]
    v_mul_f32 v118, s42, v118
    v_mul_f32 v119, s42, v119
    s_waitcnt lgkmcnt(0)
    v_mfma_f32_16x16x32_bf16 v[128:131], v[48:51], a[32:35], v[128:131]
    ds_read_b64_tr_b16 v[52:53], v15 offset:32768
    ds_read_b64_tr_b16 v[54:55], v15 offset:33792
    v_cvt_pk_bf16_f32 v112, v112, v113
    v_cvt_pk_bf16_f32 v113, v114, v115
    v_cvt_pk_bf16_f32 v114, v116, v117
    v_mfma_f32_16x16x32_bf16 v[136:139], v[48:51], a[36:39], v[136:139]
    v_cvt_pk_bf16_f32 v115, v118, v119
    v_mul_f32 v120, s42, v120
    v_mfma_f32_16x16x32_bf16 v[144:147], v[48:51], a[40:43], v[144:147]
    v_mul_f32 v121, s42, v121
    v_mul_f32 v122, s42, v122
    v_mul_f32 v123, s42, v123
    v_mfma_f32_16x16x32_bf16 v[152:155], v[48:51], a[44:47], v[152:155]
    v_mul_f32 v124, s42, v124
    v_mul_f32 v125, s42, v125
    s_waitcnt lgkmcnt(0)
    v_mfma_f32_16x16x32_bf16 v[156:159], v[52:55], a[44:47], v[156:159]
    ds_read_b64_tr_b16 v[56:57], v42 offset:32768
    ds_read_b64_tr_b16 v[58:59], v42 offset:33792
    v_mul_f32 v126, s42, v126
    v_mul_f32 v127, s42, v127
    v_mfma_f32_16x16x32_bf16 v[148:151], v[52:55], a[40:43], v[148:151]
    v_cvt_pk_bf16_f32 v120, v120, v121
    v_cvt_pk_bf16_f32 v121, v122, v123
    v_cvt_pk_bf16_f32 v122, v124, v125
    v_mfma_f32_16x16x32_bf16 v[140:143], v[52:55], a[36:39], v[140:143]
    v_cvt_pk_bf16_f32 v123, v126, v127
    v_permlane16_swap_b32 v112, v114
    v_mfma_f32_16x16x32_bf16 v[132:135], v[52:55], a[32:35], v[132:135]
    v_permlane16_swap_b32 v113, v115
    v_and_b32 v112, s52, v112
    s_waitcnt lgkmcnt(0)
    v_mfma_f32_16x16x32_bf16 v[160:163], v[56:59], a[32:35], v[160:163]
    buffer_store_dwordx4 v[112:115], v16, s[16:19], s92 offen offset:512 sc1
    ds_read_b64_tr_b16 v[60:61], v44 offset:32768
    ds_read_b64_tr_b16 v[62:63], v44 offset:33792
    v_permlane16_swap_b32 v120, v122
    v_permlane16_swap_b32 v121, v123
    v_mfma_f32_16x16x32_bf16 v[168:171], v[56:59], a[36:39], v[168:171]
    v_and_b32 v120, s52, v120
    v_mfma_f32_16x16x32_bf16 v[176:179], v[56:59], a[40:43], v[176:179]
    buffer_store_dwordx4 v[120:123], v16, s[16:19], s92 offen offset:768 sc1
    v_mfma_f32_16x16x32_bf16 v[184:187], v[56:59], a[44:47], v[184:187]
    s_waitcnt lgkmcnt(0)
    v_mfma_f32_16x16x32_bf16 v[188:191], v[60:63], a[44:47], v[188:191]
    ds_read_b64_tr_b16 v[48:49], v14 offset:40960
    ds_read_b64_tr_b16 v[50:51], v14 offset:41984
    v_mfma_f32_16x16x32_bf16 v[180:183], v[60:63], a[40:43], v[180:183]
    ds_read_b64_tr_b16 v[52:53], v15 offset:40960
    ds_read_b64_tr_b16 v[54:55], v15 offset:41984
    v_mfma_f32_16x16x32_bf16 v[172:175], v[60:63], a[36:39], v[172:175]
    ds_read_b64_tr_b16 v[56:57], v42 offset:40960
    ds_read_b64_tr_b16 v[58:59], v42 offset:41984
    v_mfma_f32_16x16x32_bf16 v[164:167], v[60:63], a[32:35], v[164:167]
    s_waitcnt lgkmcnt(4)
    v_mfma_f32_16x16x32_bf16 v[128:131], v[48:51], a[48:51], v[128:131]
    buffer_load_dword v19, v29, s[16:19], s96 offen offset:0 sc1
    v_mfma_f32_16x16x32_bf16 v[136:139], v[48:51], a[52:55], v[136:139]
    ds_read_b64_tr_b16 v[60:61], v44 offset:40960
    ds_read_b64_tr_b16 v[62:63], v44 offset:41984
    v_mfma_f32_16x16x32_bf16 v[144:147], v[48:51], a[56:59], v[144:147]
    v_mfma_f32_16x16x32_bf16 v[152:155], v[48:51], a[60:63], v[152:155]
    s_waitcnt lgkmcnt(4)
    v_mfma_f32_16x16x32_bf16 v[156:159], v[52:55], a[60:63], v[156:159]
    v_mfma_f32_16x16x32_bf16 v[148:151], v[52:55], a[56:59], v[148:151]
    v_mfma_f32_16x16x32_bf16 v[140:143], v[52:55], a[52:55], v[140:143]
    s_waitcnt vmcnt(17)
    s_barrier
    v_mfma_f32_16x16x32_bf16 v[132:135], v[52:55], a[48:51], v[132:135]
    s_add_u32 m0, s44, 65536
    s_waitcnt lgkmcnt(2)
    v_mfma_f32_16x16x32_bf16 v[160:163], v[56:59], a[48:51], v[160:163]
    ds_read_b64_tr_b16 v[48:49], v10 offset:49152
    ds_read_b64_tr_b16 v[50:51], v10 offset:50176
    v_mfma_f32_16x16x32_bf16 v[168:171], v[56:59], a[52:55], v[168:171]
    buffer_load_dwordx4 v2, s[12:15], s65 offen offset:0 lds
    v_mfma_f32_16x16x32_bf16 v[176:179], v[56:59], a[56:59], v[176:179]
    ds_read_b64_tr_b16 v[52:53], v11 offset:49152
    ds_read_b64_tr_b16 v[54:55], v11 offset:50176
    v_mfma_f32_16x16x32_bf16 v[184:187], v[56:59], a[60:63], v[184:187]
    s_waitcnt lgkmcnt(4)
    v_mfma_f32_16x16x32_bf16 v[188:191], v[60:63], a[60:63], v[188:191]
    buffer_load_dwordx4 v3, s[12:15], s65 offen offset:1024 lds
    v_mfma_f32_16x16x32_bf16 v[180:183], v[60:63], a[56:59], v[180:183]
    ds_read_b64_tr_b16 v[56:57], v12 offset:49152
    ds_read_b64_tr_b16 v[58:59], v12 offset:50176
    v_mfma_f32_16x16x32_bf16 v[172:175], v[60:63], a[52:55], v[172:175]
    buffer_load_dwordx4 v4, s[12:15], s65 offen offset:2048 lds
    v_mfma_f32_16x16x32_bf16 v[164:167], v[60:63], a[48:51], v[164:167]
    s_waitcnt lgkmcnt(4)
    v_mfma_f32_16x16x32_bf16 v[128:131], v[48:51], a[64:67], v[128:131]
    ds_read_b64_tr_b16 v[60:61], v13 offset:49152
    ds_read_b64_tr_b16 v[62:63], v13 offset:50176
    v_mfma_f32_16x16x32_bf16 v[136:139], v[48:51], a[68:71], v[136:139]
    buffer_load_dwordx4 v5, s[12:15], s65 offen offset:3072 lds
    v_mfma_f32_16x16x32_bf16 v[144:147], v[48:51], a[72:75], v[144:147]
    v_mfma_f32_16x16x32_bf16 v[152:155], v[48:51], a[76:79], v[152:155]
    s_waitcnt lgkmcnt(4)
    v_mfma_f32_16x16x32_bf16 v[156:159], v[52:55], a[76:79], v[156:159]
    s_add_u32 m0, s44, 16384
    v_mfma_f32_16x16x32_bf16 v[148:151], v[52:55], a[72:75], v[148:151]
    ds_read_b64_tr_b16 v[48:49], v10 offset:57344
    ds_read_b64_tr_b16 v[50:51], v10 offset:58368
    v_mfma_f32_16x16x32_bf16 v[140:143], v[52:55], a[68:71], v[140:143]
    buffer_load_dwordx4 v2, s[12:15], s66 offen offset:0 lds
    v_mfma_f32_16x16x32_bf16 v[132:135], v[52:55], a[64:67], v[132:135]
    s_waitcnt lgkmcnt(4)
    v_mfma_f32_16x16x32_bf16 v[160:163], v[56:59], a[64:67], v[160:163]
    ds_read_b64_tr_b16 v[52:53], v11 offset:57344
    ds_read_b64_tr_b16 v[54:55], v11 offset:58368
    v_mfma_f32_16x16x32_bf16 v[168:171], v[56:59], a[68:71], v[168:171]
    buffer_load_dwordx4 v3, s[12:15], s66 offen offset:1024 lds
    v_mfma_f32_16x16x32_bf16 v[176:179], v[56:59], a[72:75], v[176:179]
    v_mfma_f32_16x16x32_bf16 v[184:187], v[56:59], a[76:79], v[184:187]
    s_waitcnt lgkmcnt(4)
    v_mfma_f32_16x16x32_bf16 v[188:191], v[60:63], a[76:79], v[188:191]
    buffer_load_dwordx4 v4, s[12:15], s66 offen offset:2048 lds
    v_mfma_f32_16x16x32_bf16 v[180:183], v[60:63], a[72:75], v[180:183]
    ds_read_b64_tr_b16 v[56:57], v12 offset:57344
    ds_read_b64_tr_b16 v[58:59], v12 offset:58368
    v_mfma_f32_16x16x32_bf16 v[172:175], v[60:63], a[68:71], v[172:175]
    v_mfma_f32_16x16x32_bf16 v[164:167], v[60:63], a[64:67], v[164:167]
    s_waitcnt lgkmcnt(4)
    v_mfma_f32_16x16x32_bf16 v[128:131], v[48:51], a[80:83], v[128:131]
    buffer_load_dwordx4 v5, s[12:15], s66 offen offset:3072 lds
    v_mfma_f32_16x16x32_bf16 v[136:139], v[48:51], a[84:87], v[136:139]
    ds_read_b64_tr_b16 v[60:61], v13 offset:57344
    ds_read_b64_tr_b16 v[62:63], v13 offset:58368
    v_mfma_f32_16x16x32_bf16 v[144:147], v[48:51], a[88:91], v[144:147]
    v_mfma_f32_16x16x32_bf16 v[152:155], v[48:51], a[92:95], v[152:155]
    s_waitcnt lgkmcnt(4)
    v_mfma_f32_16x16x32_bf16 v[156:159], v[52:55], a[92:95], v[156:159]
    v_mfma_f32_16x16x32_bf16 v[148:151], v[52:55], a[88:91], v[148:151]
    v_mfma_f32_16x16x32_bf16 v[140:143], v[52:55], a[84:87], v[140:143]
    s_waitcnt vmcnt(9)
    s_barrier
    buffer_store_dword v18, v17, s[16:19], s51 offen offset:0 sc1
    v_mfma_f32_16x16x32_bf16 v[132:135], v[52:55], a[80:83], v[132:135]
    s_waitcnt vmcnt(9)
    v_cmp_ne_u32 vcc, 1, v19
    s_cbranch_vccnz L_poll_5
L_back_6:
    s_waitcnt lgkmcnt(2)
    v_mfma_f32_16x16x32_bf16 v[160:163], v[56:59], a[80:83], v[160:163]
    s_add_u32 m0, s44, 32768
    s_add_u32 s94, s55, 15728640
    v_mfma_f32_16x16x32_bf16 v[168:171], v[56:59], a[84:87], v[168:171]
    ds_read_b64_tr_b16 v[48:49], v14 offset:49152
    ds_read_b64_tr_b16 v[50:51], v14 offset:50176
    v_mfma_f32_16x16x32_bf16 v[176:179], v[56:59], a[88:91], v[176:179]
    buffer_load_dwordx4 v2, s[12:15], s67 offen offset:0 lds
    v_mfma_f32_16x16x32_bf16 v[184:187], v[56:59], a[92:95], v[184:187]
    v_lshrrev_b32 v22, 4, v1
    s_waitcnt lgkmcnt(2)
    v_mfma_f32_16x16x32_bf16 v[188:191], v[60:63], a[92:95], v[188:191]
    ds_read_b64_tr_b16 v[52:53], v15 offset:49152
    ds_read_b64_tr_b16 v[54:55], v15 offset:50176
    v_mfma_f32_16x16x32_bf16 v[180:183], v[60:63], a[88:91], v[180:183]
    buffer_load_dwordx4 v3, s[12:15], s67 offen offset:1024 lds
    v_mfma_f32_16x16x32_bf16 v[172:175], v[60:63], a[84:87], v[172:175]
    buffer_load_dwordx4 v4, s[12:15], s67 offen offset:2048 lds
    v_mfma_f32_16x16x32_bf16 v[164:167], v[60:63], a[80:83], v[164:167]
    v_and_b32 v23, 15, v1
    s_waitcnt lgkmcnt(2)
    v_mfma_f32_16x16x32_bf16 v[128:131], v[48:51], a[96:99], v[128:131]
    buffer_load_dwordx4 a[0:3], v20, s[16:19], s94 offen offset:0 sc1
    v_mfma_f32_16x16x32_bf16 v[136:139], v[48:51], a[100:103], v[136:139]
    ds_read_b64_tr_b16 v[56:57], v42 offset:49152
    ds_read_b64_tr_b16 v[58:59], v42 offset:50176
    v_mfma_f32_16x16x32_bf16 v[144:147], v[48:51], a[104:107], v[144:147]
    buffer_load_dwordx4 v5, s[12:15], s67 offen offset:3072 lds
    v_mfma_f32_16x16x32_bf16 v[152:155], v[48:51], a[108:111], v[152:155]
    v_add_lshl_u32 v26, v22, v45, 15
    s_waitcnt lgkmcnt(2)
    v_mfma_f32_16x16x32_bf16 v[156:159], v[52:55], a[108:111], v[156:159]
    ds_read_b64_tr_b16 v[60:61], v44 offset:49152
    ds_read_b64_tr_b16 v[62:63], v44 offset:50176
    v_mfma_f32_16x16x32_bf16 v[148:151], v[52:55], a[104:107], v[148:151]
    v_lshl_add_u32 v26, v23, 4, v26
    s_add_u32 s56, s36, 0
    v_mfma_f32_16x16x32_bf16 v[140:143], v[52:55], a[100:103], v[140:143]
    buffer_load_dwordx4 a[4:7], v20, s[16:19], s94 offen offset:1024 sc1
    v_mfma_f32_16x16x32_bf16 v[132:135], v[52:55], a[96:99], v[132:135]
    s_and_b32 s56, s56, 3
    s_waitcnt lgkmcnt(2)
    v_mfma_f32_16x16x32_bf16 v[160:163], v[56:59], a[96:99], v[160:163]
    ds_read_b64_tr_b16 v[48:49], v14 offset:57344
    ds_read_b64_tr_b16 v[50:51], v14 offset:58368
    v_mfma_f32_16x16x32_bf16 v[168:171], v[56:59], a[100:103], v[168:171]
    ds_read_b64_tr_b16 v[52:53], v15 offset:57344
    ds_read_b64_tr_b16 v[54:55], v15 offset:58368
    v_mfma_f32_16x16x32_bf16 v[176:179], v[56:59], a[104:107], v[176:179]
    s_lshl_b32 s56, s56, 8
    v_mfma_f32_16x16x32_bf16 v[184:187], v[56:59], a[108:111], v[184:187]
    s_add_u32 s57, s36, 1
    s_waitcnt lgkmcnt(4)
    v_mfma_f32_16x16x32_bf16 v[188:191], v[60:63], a[108:111], v[188:191]
    buffer_load_dwordx4 a[8:11], v20, s[16:19], s94 offen offset:2048 sc1
    v_mfma_f32_16x16x32_bf16 v[180:183], v[60:63], a[104:107], v[180:183]
    ds_read_b64_tr_b16 v[56:57], v42 offset:57344
    ds_read_b64_tr_b16 v[58:59], v42 offset:58368
    v_mfma_f32_16x16x32_bf16 v[172:175], v[60:63], a[100:103], v[172:175]
    s_and_b32 s57, s57, 3
    v_mfma_f32_16x16x32_bf16 v[164:167], v[60:63], a[96:99], v[164:167]
    s_waitcnt lgkmcnt(4)
    v_mfma_f32_16x16x32_bf16 v[128:131], v[48:51], a[112:115], v[128:131]
    ds_read_b64_tr_b16 v[60:61], v44 offset:57344
    ds_read_b64_tr_b16 v[62:63], v44 offset:58368
    v_mfma_f32_16x16x32_bf16 v[136:139], v[48:51], a[116:119], v[136:139]
    s_lshl_b32 s57, s57, 8
    v_mfma_f32_16x16x32_bf16 v[144:147], v[48:51], a[120:123], v[144:147]
    v_mfma_f32_16x16x32_bf16 v[152:155], v[48:51], a[124:127], v[152:155]
    s_add_u32 s58, s36, 2
    s_waitcnt lgkmcnt(4)
    v_mfma_f32_16x16x32_bf16 v[156:159], v[52:55], a[124:127], v[156:159]
    buffer_load_dwordx4 a[12:15], v20, s[16:19], s94 offen offset:3072 sc1
    v_mfma_f32_16x16x32_bf16 v[148:151], v[52:55], a[120:123], v[148:151]
    s_and_b32 s58, s58, 3
    v_mfma_f32_16x16x32_bf16 v[140:143], v[52:55], a[116:119], v[140:143]
    s_barrier
    v_mfma_f32_16x16x32_bf16 v[132:135], v[52:55], a[112:115], v[132:135]
    s_add_u32 m0, s44, 49152
    s_waitcnt lgkmcnt(2)
    v_mfma_f32_16x16x32_bf16 v[160:163], v[56:59], a[112:115], v[160:163]
    ds_read_b64_tr_b16 v[48:49], v10 offset:0
    ds_read_b64_tr_b16 v[50:51], v10 offset:1024
    v_mfma_f32_16x16x32_bf16 v[168:171], v[56:59], a[116:119], v[168:171]
    buffer_load_dwordx4 v2, s[12:15], s68 offen offset:0 lds
    v_mfma_f32_16x16x32_bf16 v[176:179], v[56:59], a[120:123], v[176:179]
    s_add_u32 s94, s55, 15732736
    s_lshl_b32 s58, s58, 8
    v_mfma_f32_16x16x32_bf16 v[184:187], v[56:59], a[124:127], v[184:187]
    s_add_u32 s59, s36, 3
    s_waitcnt lgkmcnt(2)
    v_mfma_f32_16x16x32_bf16 v[188:191], v[60:63], a[124:127], v[188:191]
    ds_read_b64_tr_b16 v[52:53], v11 offset:0
    ds_read_b64_tr_b16 v[54:55], v11 offset:1024
    v_mfma_f32_16x16x32_bf16 v[180:183], v[60:63], a[120:123], v[180:183]
    buffer_load_dwordx4 v3, s[12:15], s68 offen offset:1024 lds
    v_mfma_f32_16x16x32_bf16 v[172:175], v[60:63], a[116:119], v[172:175]
    buffer_load_dwordx4 v4, s[12:15], s68 offen offset:2048 lds
    v_mfma_f32_16x16x32_bf16 v[164:167], v[60:63], a[112:115], v[164:167]
    s_and_b32 s59, s59, 3
    s_waitcnt lgkmcnt(2)
    v_mfma_f32_16x16x32_bf16 v[128:131], v[48:51], a[128:131], v[128:131]
    ds_read_b64_tr_b16 v[56:57], v12 offset:0
    ds_read_b64_tr_b16 v[58:59], v12 offset:1024
    v_mfma_f32_16x16x32_bf16 v[136:139], v[48:51], a[132:135], v[136:139]
    buffer_load_dwordx4 v5, s[12:15], s68 offen offset:3072 lds
    v_mfma_f32_16x16x32_bf16 v[144:147], v[48:51], a[136:139], v[144:147]
    buffer_load_dwordx4 a[16:19], v20, s[16:19], s94 offen offset:0 sc1
    v_mfma_f32_16x16x32_bf16 v[152:155], v[48:51], a[140:143], v[152:155]
    s_lshl_b32 s59, s59, 8
    s_waitcnt lgkmcnt(2)
    v_mfma_f32_16x16x32_bf16 v[156:159], v[52:55], a[140:143], v[156:159]
    ds_read_b64_tr_b16 v[60:61], v13 offset:0
    ds_read_b64_tr_b16 v[62:63], v13 offset:1024
    v_mfma_f32_16x16x32_bf16 v[148:151], v[52:55], a[136:139], v[148:151]
    ds_read_b64_tr_b16 v[48:49], v10 offset:8192
    ds_read_b64_tr_b16 v[50:51], v10 offset:9216
    v_mfma_f32_16x16x32_bf16 v[140:143], v[52:55], a[132:135], v[140:143]
    v_mfma_f32_16x16x32_bf16 v[132:135], v[52:55], a[128:131], v[132:135]
    s_waitcnt lgkmcnt(4)
    v_mfma_f32_16x16x32_bf16 v[160:163], v[56:59], a[128:131], v[160:163]
    buffer_load_dwordx4 a[20:23], v20, s[16:19], s94 offen offset:1024 sc1
    v_mfma_f32_16x16x32_bf16 v[168:171], v[56:59], a[132:135], v[168:171]
    ds_read_b64_tr_b16 v[52:53], v11 offset:8192
    ds_read_b64_tr_b16 v[54:55], v11 offset:9216
    v_mfma_f32_16x16x32_bf16 v[176:179], v[56:59], a[136:139], v[176:179]
    v_mfma_f32_16x16x32_bf16 v[184:187], v[56:59], a[140:143], v[184:187]
    s_waitcnt lgkmcnt(4)
    v_mfma_f32_16x16x32_bf16 v[188:191], v[60:63], a[140:143], v[188:191]
    ds_read_b64_tr_b16 v[56:57], v12 offset:8192
    ds_read_b64_tr_b16 v[58:59], v12 offset:9216
    v_mfma_f32_16x16x32_bf16 v[180:183], v[60:63], a[136:139], v[180:183]
    ds_read2_b32 v[80:81], v40 offset0:64 offset1:65
    v_mfma_f32_16x16x32_bf16 v[172:175], v[60:63], a[132:135], v[172:175]
    v_mfma_f32_16x16x32_bf16 v[164:167], v[60:63], a[128:131], v[164:167]
    ds_read2_b32 v[82:83], v40 offset0:66 offset1:67
    s_waitcnt lgkmcnt(6)
    v_mfma_f32_16x16x32_bf16 v[128:131], v[48:51], a[144:147], v[128:131]
    buffer_load_dwordx4 a[24:27], v20, s[16:19], s94 offen offset:2048 sc1
    v_mfma_f32_16x16x32_bf16 v[136:139], v[48:51], a[148:151], v[136:139]
    ds_read_b64_tr_b16 v[60:61], v13 offset:8192
    ds_read_b64_tr_b16 v[62:63], v13 offset:9216
    v_mfma_f32_16x16x32_bf16 v[144:147], v[48:51], a[152:155], v[144:147]
    v_mfma_f32_16x16x32_bf16 v[152:155], v[48:51], a[156:159], v[152:155]
    ds_read2_b32 v[84:85], v40 offset0:72 offset1:73
    s_waitcnt lgkmcnt(7)
    v_mfma_f32_16x16x32_bf16 v[156:159], v[52:55], a[156:159], v[156:159]
    v_mfma_f32_16x16x32_bf16 v[148:151], v[52:55], a[152:155], v[148:151]
    buffer_load_dwordx4 a[28:31], v20, s[16:19], s94 offen offset:3072 sc1
    v_mfma_f32_16x16x32_bf16 v[140:143], v[52:55], a[148:151], v[140:143]
    s_waitcnt vmcnt(21)
    s_barrier
    v_mfma_f32_16x16x32_bf16 v[132:135], v[52:55], a[144:147], v[132:135]
    ds_read2_b32 v[86:87], v40 offset0:74 offset1:75
    s_waitcnt lgkmcnt(6)
    v_mfma_f32_16x16x32_bf16 v[160:163], v[56:59], a[144:147], v[160:163]
    ds_read_b64_tr_b16 v[48:49], v14 offset:0
    ds_read_b64_tr_b16 v[50:51], v14 offset:1024
    v_mfma_f32_16x16x32_bf16 v[168:171], v[56:59], a[148:151], v[168:171]
    ds_read_b64_tr_b16 v[52:53], v15 offset:0
    ds_read_b64_tr_b16 v[54:55], v15 offset:1024
    v_mfma_f32_16x16x32_bf16 v[176:179], v[56:59], a[152:155], v[176:179]
    v_mfma_f32_16x16x32_bf16 v[184:187], v[56:59], a[156:159], v[184:187]
    ds_read2_b32 v[88:89], v40 offset0:80 offset1:81
    s_waitcnt lgkmcnt(7)
    v_mfma_f32_16x16x32_bf16 v[188:191], v[60:63], a[156:159], v[188:191]
    s_add_u32 s94, s55, 15736832
    v_mfma_f32_16x16x32_bf16 v[180:183], v[60:63], a[152:155], v[180:183]
    ds_read_b64_tr_b16 v[56:57], v42 offset:0
    ds_read_b64_tr_b16 v[58:59], v42 offset:1024
    v_mfma_f32_16x16x32_bf16 v[172:175], v[60:63], a[148:151], v[172:175]
    ds_read2_b32 v[90:91], v40 offset0:82 offset1:83
    v_mfma_f32_16x16x32_bf16 v[164:167], v[60:63], a[144:147], v[164:167]
    s_waitcnt lgkmcnt(6)
    v_mfma_f32_16x16x32_bf16 v[128:131], v[48:51], a[160:163], v[128:131]
    ds_read_b64_tr_b16 v[60:61], v44 offset:0
    ds_read_b64_tr_b16 v[62:63], v44 offset:1024
    v_mfma_f32_16x16x32_bf16 v[136:139], v[48:51], a[164:167], v[136:139]
    v_mfma_f32_16x16x32_bf16 v[144:147], v[48:51], a[168:171], v[144:147]
    ds_read2_b32 v[92:93], v40 offset0:88 offset1:89
    v_mfma_f32_16x16x32_bf16 v[152:155], v[48:51], a[172:175], v[152:155]
    s_waitcnt lgkmcnt(7)
    v_mfma_f32_16x16x32_bf16 v[156:159], v[52:55], a[172:175], v[156:159]
    buffer_load_dwordx4 a[32:35], v20, s[16:19], s94 offen offset:0 sc1
    v_mfma_f32_16x16x32_bf16 v[148:151], v[52:55], a[168:171], v[148:151]
    buffer_load_dword v19, v28, s[16:19], s96 offen offset:0 sc1
    v_mfma_f32_16x16x32_bf16 v[140:143], v[52:55], a[164:167], v[140:143]
    ds_read_b64_tr_b16 v[48:49], v14 offset:8192
    ds_read_b64_tr_b16 v[50:51], v14 offset:9216
    v_mfma_f32_16x16x32_bf16 v[132:135], v[52:55], a[160:163], v[132:135]
    ds_read2_b32 v[94:95], v40 offset0:90 offset1:91
    s_waitcnt lgkmcnt(7)
    v_mfma_f32_16x16x32_bf16 v[160:163], v[56:59], a[160:163], v[160:163]
    ds_read_b64_tr_b16 v[52:53], v15 offset:8192
    ds_read_b64_tr_b16 v[54:55], v15 offset:9216
    v_mfma_f32_16x16x32_bf16 v[168:171], v[56:59], a[164:167], v[168:171]
    v_mfma_f32_16x16x32_bf16 v[176:179], v[56:59], a[168:171], v[176:179]
    buffer_load_dwordx4 a[36:39], v20, s[16:19], s94 offen offset:1024 sc1
    v_mfma_f32_16x16x32_bf16 v[184:187], v[56:59], a[172:175], v[184:187]
    s_waitcnt lgkmcnt(6)
    v_mfma_f32_16x16x32_bf16 v[188:191], v[60:63], a[172:175], v[188:191]
    ds_read_b64_tr_b16 v[56:57], v42 offset:8192
    ds_read_b64_tr_b16 v[58:59], v42 offset:9216
    v_mfma_f32_16x16x32_bf16 v[180:183], v[60:63], a[168:171], v[180:183]
    v_mfma_f32_16x16x32_bf16 v[172:175], v[60:63], a[164:167], v[172:175]
    v_mfma_f32_16x16x32_bf16 v[164:167], v[60:63], a[160:163], v[164:167]
    s_waitcnt lgkmcnt(5)
    v_mfma_f32_16x16x32_bf16 v[128:131], v[48:51], a[176:179], v[128:131]
    ds_read_b64_tr_b16 v[60:61], v44 offset:8192
    ds_read_b64_tr_b16 v[62:63], v44 offset:9216
    v_mfma_f32_16x16x32_bf16 v[136:139], v[48:51], a[180:183], v[136:139]
    buffer_load_dwordx4 a[40:43], v20, s[16:19], s94 offen offset:2048 sc1
    v_mfma_f32_16x16x32_bf16 v[144:147], v[48:51], a[184:187], v[144:147]
    v_mfma_f32_16x16x32_bf16 v[152:155], v[48:51], a[188:191], v[152:155]
    s_waitcnt lgkmcnt(4)
    v_mfma_f32_16x16x32_bf16 v[156:159], v[52:55], a[188:191], v[156:159]
    v_mfma_f32_16x16x32_bf16 v[148:151], v[52:55], a[184:187], v[148:151]
    v_mfma_f32_16x16x32_bf16 v[140:143], v[52:55], a[180:183], v[140:143]
    s_waitcnt vmcnt(8)
    s_barrier
    v_mfma_f32_16x16x32_bf16 v[132:135], v[52:55], a[176:179], v[132:135]
    s_add_u32 m0, s44, 0
    s_waitcnt lgkmcnt(2)
    v_mfma_f32_16x16x32_bf16 v[160:163], v[56:59], a[176:179], v[160:163]
    ds_read_b64_tr_b16 v[48:49], v10 offset:16384
    ds_read_b64_tr_b16 v[50:51], v10 offset:17408
    v_mfma_f32_16x16x32_bf16 v[168:171], v[56:59], a[180:183], v[168:171]
    buffer_load_dwordx4 v2, s[12:15], s69 offen offset:0 lds
    v_mfma_f32_16x16x32_bf16 v[176:179], v[56:59], a[184:187], v[176:179]
    buffer_load_dwordx4 a[44:47], v20, s[16:19], s94 offen offset:3072 sc1
    v_mfma_f32_16x16x32_bf16 v[184:187], v[56:59], a[188:191], v[184:187]
    s_waitcnt lgkmcnt(2)
    v_mfma_f32_16x16x32_bf16 v[188:191], v[60:63], a[188:191], v[188:191]
    ds_read_b64_tr_b16 v[52:53], v11 offset:16384
    ds_read_b64_tr_b16 v[54:55], v11 offset:17408
    v_mfma_f32_16x16x32_bf16 v[180:183], v[60:63], a[184:187], v[180:183]
    buffer_load_dwordx4 v3, s[12:15], s69 offen offset:1024 lds
    v_mfma_f32_16x16x32_bf16 v[172:175], v[60:63], a[180:183], v[172:175]
    buffer_load_dwordx4 v4, s[12:15], s69 offen offset:2048 lds
    v_mfma_f32_16x16x32_bf16 v[164:167], v[60:63], a[176:179], v[164:167]
    s_add_u32 s94, s55, 15740928
    s_waitcnt lgkmcnt(2)
    v_mfma_f32_16x16x32_bf16 v[128:131], v[48:51], a[192:195], v[128:131]
    ds_read_b64_tr_b16 v[56:57], v10 offset:24576
    ds_read_b64_tr_b16 v[58:59], v10 offset:25600
    v_mfma_f32_16x16x32_bf16 v[136:139], v[48:51], a[196:199], v[136:139]
    buffer_load_dwordx4 v5, s[12:15], s69 offen offset:3072 lds
    v_mfma_f32_16x16x32_bf16 v[144:147], v[48:51], a[200:203], v[144:147]
    ds_read_b64_tr_b16 v[60:61], v11 offset:24576
    ds_read_b64_tr_b16 v[62:63], v11 offset:25600
    v_mfma_f32_16x16x32_bf16 v[152:155], v[48:51], a[204:207], v[152:155]
    s_waitcnt lgkmcnt(4)
    v_mfma_f32_16x16x32_bf16 v[156:159], v[52:55], a[204:207], v[156:159]
    ds_read_b64_tr_b16 v[48:49], v10 offset:32768
    ds_read_b64_tr_b16 v[50:51], v10 offset:33792
    v_mfma_f32_16x16x32_bf16 v[148:151], v[52:55], a[200:203], v[148:151]
    v_mfma_f32_16x16x32_bf16 v[140:143], v[52:55], a[196:199], v[140:143]
    buffer_load_dwordx4 a[48:51], v20, s[16:19], s94 offen offset:0 sc1
    v_mfma_f32_16x16x32_bf16 v[132:135], v[52:55], a[192:195], v[132:135]
    s_waitcnt lgkmcnt(4)
    v_mfma_f32_16x16x32_bf16 v[128:131], v[56:59], a[208:211], v[128:131]
    ds_read_b64_tr_b16 v[52:53], v11 offset:32768
    ds_read_b64_tr_b16 v[54:55], v11 offset:33792
    v_mfma_f32_16x16x32_bf16 v[136:139], v[56:59], a[212:215], v[136:139]
    v_mfma_f32_16x16x32_bf16 v[144:147], v[56:59], a[216:219], v[144:147]
    v_mfma_f32_16x16x32_bf16 v[152:155], v[56:59], a[220:223], v[152:155]
    s_waitcnt vmcnt(8)
    v_cmp_ne_u32 vcc, 1, v19
    s_cbranch_vccnz L_poll_1
L_back_2:
    s_waitcnt lgkmcnt(4)
    v_mfma_f32_16x16x32_bf16 v[156:159], v[60:63], a[220:223], v[156:159]
    s_add_u32 m0, s88, 81920
    s_add_u32 s93, s86, 2617344
    v_mfma_f32_16x16x32_bf16 v[148:151], v[60:63], a[216:219], v[148:151]
    buffer_load_dwordx4 a[52:55], v20, s[16:19], s94 offen offset:1024 sc1
    v_mfma_f32_16x16x32_bf16 v[140:143], v[60:63], a[212:215], v[140:143]
    buffer_load_dwordx4 v6, s[16:19], s93 offen sc1 lds
    v_mfma_f32_16x16x32_bf16 v[132:135], v[60:63], a[208:211], v[132:135]
    s_waitcnt lgkmcnt(2)
    v_mfma_f32_16x16x32_bf16 v[128:131], v[48:51], a[224:227], v[128:131]
    ds_read_b64_tr_b16 v[56:57], v10 offset:40960
    ds_read_b64_tr_b16 v[58:59], v10 offset:41984
    v_mfma_f32_16x16x32_bf16 v[136:139], v[48:51], a[228:231], v[136:139]
    buffer_load_dwordx4 v6, s[16:19], s93 offen offset:1024 sc1 lds
    v_mfma_f32_16x16x32_bf16 v[144:147], v[48:51], a[232:235], v[144:147]
    ds_read_b64_tr_b16 v[60:61], v11 offset:40960
    ds_read_b64_tr_b16 v[62:63], v11 offset:41984
    v_mfma_f32_16x16x32_bf16 v[152:155], v[48:51], a[236:239], v[152:155]
    v_add_u32 v2, s56, v26
    s_waitcnt lgkmcnt(4)
    v_mfma_f32_16x16x32_bf16 v[156:159], v[52:55], a[236:239], v[156:159]
    s_add_u32 m0, s88, 90176
    s_add_u32 s93, s86, 2650112
    v_mfma_f32_16x16x32_bf16 v[148:151], v[52:55], a[232:235], v[148:151]
    buffer_load_dwordx4 a[56:59], v20, s[16:19], s94 offen offset:2048 sc1
    v_mfma_f32_16x16x32_bf16 v[140:143], v[52:55], a[228:231], v[140:143]
    buffer_load_dwordx4 v6, s[16:19], s93 offen sc1 lds
    v_mfma_f32_16x16x32_bf16 v[132:135], v[52:55], a[224:227], v[132:135]
    v_add_u32 v3, s57, v26
    s_waitcnt lgkmcnt(2)
    v_mfma_f32_16x16x32_bf16 v[128:131], v[56:59], a[240:243], v[128:131]
    buffer_load_dwordx4 v6, s[16:19], s93 offen offset:1024 sc1 lds
    v_mfma_f32_16x16x32_bf16 v[136:139], v[56:59], a[244:247], v[136:139]
    ds_read_b64_tr_b16 v[48:49], v10 offset:49152
    ds_read_b64_tr_b16 v[50:51], v10 offset:50176
    v_mfma_f32_16x16x32_bf16 v[144:147], v[56:59], a[248:251], v[144:147]
    s_add_u32 m0, s88, 98432
    s_add_u32 s93, s87, 2617344
    v_mfma_f32_16x16x32_bf16 v[152:155], v[56:59], a[252:255], v[152:155]
    v_add_u32 v4, s58, v26
    s_waitcnt lgkmcnt(2)
    v_mfma_f32_16x16x32_bf16 v[156:159], v[60:63], a[252:255], v[156:159]
    buffer_load_dwordx4 a[60:63], v20, s[16:19], s94 offen offset:3072 sc1
    v_mfma_f32_16x16x32_bf16 v[148:151], v[60:63], a[248:251], v[148:151]
    ds_read_b64_tr_b16 v[52:53], v11 offset:49152
    ds_read_b64_tr_b16 v[54:55], v11 offset:50176
    v_mfma_f32_16x16x32_bf16 v[140:143], v[60:63], a[244:247], v[140:143]
    buffer_load_dwordx4 v6, s[16:19], s93 offen sc1 lds
    v_mfma_f32_16x16x32_bf16 v[132:135], v[60:63], a[240:243], v[132:135]
    v_add_u32 v5, s59, v26
    s_waitcnt lgkmcnt(2)
    v_mfma_f32_16x16x32_bf16 v[128:131], v[48:51], v[192:195], v[128:131]
    buffer_load_dwordx4 v6, s[16:19], s93 offen offset:1024 sc1 lds
    v_mfma_f32_16x16x32_bf16 v[136:139], v[48:51], v[196:199], v[136:139]
    ds_read_b64_tr_b16 v[56:57], v10 offset:57344
    ds_read_b64_tr_b16 v[58:59], v10 offset:58368
    v_mfma_f32_16x16x32_bf16 v[144:147], v[48:51], v[200:203], v[144:147]
    s_add_u32 m0, s88, 106688
    s_add_u32 s93, s86, 5238784
    v_mfma_f32_16x16x32_bf16 v[152:155], v[48:51], v[204:207], v[152:155]
    s_add_u32 s94, s55, 15745024
    s_waitcnt lgkmcnt(2)
    v_mfma_f32_16x16x32_bf16 v[156:159], v[52:55], v[204:207], v[156:159]
    buffer_load_dwordx4 v6, s[16:19], s93 offen sc1 lds
    v_mfma_f32_16x16x32_bf16 v[148:151], v[52:55], v[200:203], v[148:151]
    ds_read_b64_tr_b16 v[60:61], v11 offset:57344
    ds_read_b64_tr_b16 v[62:63], v11 offset:58368
    v_mfma_f32_16x16x32_bf16 v[140:143], v[52:55], v[196:199], v[140:143]
    s_waitcnt vmcnt(11)
    s_barrier
    v_mfma_f32_16x16x32_bf16 v[132:135], v[52:55], v[192:195], v[132:135]
    s_waitcnt lgkmcnt(2)
    v_mfma_f32_16x16x32_bf16 v[128:131], v[56:59], v[208:211], v[128:131]
    buffer_load_dwordx4 v6, s[16:19], s93 offen offset:1024 sc1 lds
    v_mfma_f32_16x16x32_bf16 v[136:139], v[56:59], v[212:215], v[136:139]
    ds_read_b64_tr_b16 v[48:49], v10 offset:0
    ds_read_b64_tr_b16 v[50:51], v10 offset:1024
    v_mfma_f32_16x16x32_bf16 v[144:147], v[56:59], v[216:219], v[144:147]
    s_add_u32 m0, s88, 114944
    s_add_u32 s93, s86, 5271552
    v_mfma_f32_16x16x32_bf16 v[152:155], v[56:59], v[220:223], v[152:155]
    s_waitcnt lgkmcnt(2)
    v_mfma_f32_16x16x32_bf16 v[156:159], v[60:63], v[220:223], v[156:159]
    buffer_load_dwordx4 a[64:67], v20, s[16:19], s94 offen offset:0 sc1
    v_mfma_f32_16x16x32_bf16 v[148:151], v[60:63], v[216:219], v[148:151]
    buffer_load_dwordx4 v6, s[16:19], s93 offen sc1 lds
    v_mfma_f32_16x16x32_bf16 v[140:143], v[60:63], v[212:215], v[140:143]
    ds_read_b64_tr_b16 v[52:53], v11 offset:0
    ds_read_b64_tr_b16 v[54:55], v11 offset:1024
    v_mfma_f32_16x16x32_bf16 v[132:135], v[60:63], v[208:211], v[132:135]
    s_waitcnt lgkmcnt(2)
    v_mfma_f32_16x16x32_bf16 v[128:131], v[48:51], v[224:227], v[128:131]
    buffer_load_dwordx4 v6, s[16:19], s93 offen offset:1024 sc1 lds
    v_mfma_f32_16x16x32_bf16 v[136:139], v[48:51], v[228:231], v[136:139]
    s_add_u32 m0, s88, 123200
    s_add_u32 s93, s87, 5238784
    v_mfma_f32_16x16x32_bf16 v[144:147], v[48:51], v[232:235], v[144:147]
    ds_read_b64_tr_b16 v[56:57], v10 offset:8192
    ds_read_b64_tr_b16 v[58:59], v10 offset:9216
    v_mfma_f32_16x16x32_bf16 v[152:155], v[48:51], v[236:239], v[152:155]
    s_waitcnt lgkmcnt(2)
    v_mfma_f32_16x16x32_bf16 v[156:159], v[52:55], v[236:239], v[156:159]
    buffer_load_dwordx4 a[68:71], v20, s[16:19], s94 offen offset:1024 sc1
    v_mfma_f32_16x16x32_bf16 v[148:151], v[52:55], v[232:235], v[148:151]
    buffer_load_dwordx4 v6, s[16:19], s93 offen sc1 lds
    v_mfma_f32_16x16x32_bf16 v[140:143], v[52:55], v[228:231], v[140:143]
    buffer_load_dwordx4 v6, s[16:19], s93 offen offset:1024 sc1 lds
    v_mfma_f32_16x16x32_bf16 v[132:135], v[52:55], v[224:227], v[132:135]
    s_waitcnt lgkmcnt(0)
    v_mfma_f32_16x16x32_bf16 v[128:131], v[56:59], v[240:243], v[128:131]
    ds_read_b64_tr_b16 v[60:61], v11 offset:8192
    ds_read_b64_tr_b16 v[62:63], v11 offset:9216
    v_mfma_f32_16x16x32_bf16 v[136:139], v[56:59], v[244:247], v[136:139]
    buffer_load_dwordx4 v[96:99], v31, s[16:19], s84 offen sc1
    v_mfma_f32_16x16x32_bf16 v[144:147], v[56:59], v[248:251], v[144:147]
    buffer_load_dwordx4 a[72:75], v20, s[16:19], s94 offen offset:2048 sc1
    v_mfma_f32_16x16x32_bf16 v[152:155], v[56:59], v[252:255], v[152:155]
    s_waitcnt lgkmcnt(0)
    v_mfma_f32_16x16x32_bf16 v[156:159], v[60:63], v[252:255], v[156:159]
    ds_read_b64_tr_b16 v[48:49], v12 offset:16384
    ds_read_b64_tr_b16 v[50:51], v12 offset:17408
    buffer_load_dwordx2 v[104:105], v32, s[16:19], s85 offen sc1
    v_mfma_f32_16x16x32_bf16 v[148:151], v[60:63], v[248:251], v[148:151]
    buffer_load_dwordx2 v[106:107], v33, s[16:19], s85 offen sc1
    v_mfma_f32_16x16x32_bf16 v[140:143], v[60:63], v[244:247], v[140:143]
    ds_read_b64_tr_b16 v[52:53], v13 offset:16384
    ds_read_b64_tr_b16 v[54:55], v13 offset:17408
    v_mfma_f32_16x16x32_bf16 v[132:135], v[60:63], v[240:243], v[132:135]
    s_waitcnt lgkmcnt(2)
    v_mfma_f32_16x16x32_bf16 v[160:163], v[48:51], a[192:195], v[160:163]
    buffer_load_dwordx4 v[100:103], v31, s[16:19], s84 offen offset:512 sc1
    v_mfma_f32_16x16x32_bf16 v[168:171], v[48:51], a[196:199], v[168:171]
    buffer_load_dwordx4 a[76:79], v20, s[16:19], s94 offen offset:3072 sc1
    v_mfma_f32_16x16x32_bf16 v[176:179], v[48:51], a[200:203], v[176:179]
    buffer_load_dwordx2 v[108:109], v32, s[16:19], s85 offen offset:512 sc1
    v_mfma_f32_16x16x32_bf16 v[184:187], v[48:51], a[204:207], v[184:187]
    s_add_u32 s92, s41, 7864320
    s_waitcnt lgkmcnt(0)
    v_mfma_f32_16x16x32_bf16 v[188:191], v[52:55], a[204:207], v[188:191]
    ds_read_b64_tr_b16 v[56:57], v12 offset:24576
    ds_read_b64_tr_b16 v[58:59], v12 offset:25600
    v_mul_f32 v128, s42, v128
    v_mfma_f32_16x16x32_bf16 v[180:183], v[52:55], a[200:203], v[180:183]
    buffer_load_dwordx2 v[110:111], v33, s[16:19], s85 offen offset:512 sc1
    v_mul_f32 v129, s42, v129
    v_mfma_f32_16x16x32_bf16 v[172:175], v[52:55], a[196:199], v[172:175]
    v_mul_f32 v130, s42, v130
    v_mul_f32 v131, s42, v131
    v_mfma_f32_16x16x32_bf16 v[164:167], v[52:55], a[192:195], v[164:167]
    v_mul_f32 v132, s42, v132
    s_waitcnt lgkmcnt(0)
    v_mfma_f32_16x16x32_bf16 v[160:163], v[56:59], a[208:211], v[160:163]
    ds_read_b64_tr_b16 v[60:61], v13 offset:24576
    ds_read_b64_tr_b16 v[62:63], v13 offset:25600
    v_mfma_f32_16x16x32_bf16 v[168:171], v[56:59], a[212:215], v[168:171]
    v_mul_f32 v133, s42, v133
    v_mul_f32 v134, s42, v134
    v_mfma_f32_16x16x32_bf16 v[176:179], v[56:59], a[216:219], v[176:179]
    v_mul_f32 v135, s42, v135
    v_cvt_pk_bf16_f32 v128, v128, v129
    v_mfma_f32_16x16x32_bf16 v[184:187], v[56:59], a[220:223], v[184:187]
    v_cvt_pk_bf16_f32 v129, v130, v131
    s_waitcnt lgkmcnt(0)
    v_mfma_f32_16x16x32_bf16 v[188:191], v[60:63], a[220:223], v[188:191]
    ds_read_b64_tr_b16 v[48:49], v12 offset:32768
    ds_read_b64_tr_b16 v[50:51], v12 offset:33792
    v_mfma_f32_16x16x32_bf16 v[180:183], v[60:63], a[216:219], v[180:183]
    v_cvt_pk_bf16_f32 v130, v132, v133
    v_cvt_pk_bf16_f32 v131, v134, v135
    v_mfma_f32_16x16x32_bf16 v[172:175], v[60:63], a[212:215], v[172:175]
    v_mul_f32 v136, s42, v136
    v_mul_f32 v137, s42, v137
    v_mfma_f32_16x16x32_bf16 v[164:167], v[60:63], a[208:211], v[164:167]
    v_mul_f32 v138, s42, v138
    s_waitcnt lgkmcnt(0)
    v_mfma_f32_16x16x32_bf16 v[160:163], v[48:51], a[224:227], v[160:163]
    ds_read_b64_tr_b16 v[52:53], v13 offset:32768
    ds_read_b64_tr_b16 v[54:55], v13 offset:33792
    v_mfma_f32_16x16x32_bf16 v[168:171], v[48:51], a[228:231], v[168:171]
    v_mul_f32 v139, s42, v139
    v_mul_f32 v140, s42, v140
    v_mfma_f32_16x16x32_bf16 v[176:179], v[48:51], a[232:235], v[176:179]
    v_mul_f32 v141, s42, v141
    v_mul_f32 v142, s42, v142
    v_mfma_f32_16x16x32_bf16 v[184:187], v[48:51], a[236:239], v[184:187]
    v_mul_f32 v143, s42, v143
    s_waitcnt lgkmcnt(0)
    v_mfma_f32_16x16x32_bf16 v[188:191], v[52:55], a[236:239], v[188:191]
    ds_read_b64_tr_b16 v[56:57], v12 offset:40960
    ds_read_b64_tr_b16 v[58:59], v12 offset:41984
    v_mfma_f32_16x16x32_bf16 v[180:183], v[52:55], a[232:235], v[180:183]
    v_cvt_pk_bf16_f32 v136, v136, v137
    v_cvt_pk_bf16_f32 v137, v138, v139
    v_mfma_f32_16x16x32_bf16 v[172:175], v[52:55], a[228:231], v[172:175]
    v_cvt_pk_bf16_f32 v138, v140, v141
    v_cvt_pk_bf16_f32 v139, v142, v143
    v_mfma_f32_16x16x32_bf16 v[164:167], v[52:55], a[224:227], v[164:167]
    v_permlane16_swap_b32 v128, v130
    s_waitcnt lgkmcnt(0)
    v_mfma_f32_16x16x32_bf16 v[160:163], v[56:59], a[240:243], v[160:163]
    ds_read_b64_tr_b16 v[60:61], v13 offset:40960
    ds_read_b64_tr_b16 v[62:63], v13 offset:41984
    v_mfma_f32_16x16x32_bf16 v[168:171], v[56:59], a[244:247], v[168:171]
    v_permlane16_swap_b32 v129, v131
    v_and_b32 v128, s52, v128
    v_mfma_f32_16x16x32_bf16 v[176:179], v[56:59], a[248:251], v[176:179]
    buffer_store_dwordx4 v[128:131], v16, s[16:19], s92 offen offset:0 sc1
    v_mfma_f32_16x16x32_bf16 v[184:187], v[56:59], a[252:255], v[184:187]
    v_permlane16_swap_b32 v136, v138
    s_waitcnt lgkmcnt(0)
    v_mfma_f32_16x16x32_bf16 v[188:191], v[60:63], a[252:255], v[188:191]
    ds_read_b64_tr_b16 v[48:49], v12 offset:49152
    ds_read_b64_tr_b16 v[50:51], v12 offset:50176
    v_mfma_f32_16x16x32_bf16 v[180:183], v[60:63], a[248:251], v[180:183]
    v_permlane16_swap_b32 v137, v139
    v_and_b32 v136, s52, v136
    v_mfma_f32_16x16x32_bf16 v[172:175], v[60:63], a[244:247], v[172:175]
    buffer_store_dwordx4 v[136:139], v16, s[16:19], s92 offen offset:256 sc1
    v_mfma_f32_16x16x32_bf16 v[164:167], v[60:63], a[240:243], v[164:167]
    v_mul_f32 v144, s42, v144
    s_waitcnt lgkmcnt(0)
    v_mfma_f32_16x16x32_bf16 v[160:163], v[48:51], v[192:195], v[160:163]
    ds_read_b64_tr_b16 v[52:53], v13 offset:49152
    ds_read_b64_tr_b16 v[54:55], v13 offset:50176
    v_mul_f32 v145, s42, v145
    v_mfma_f32_16x16x32_bf16 v[168:171], v[48:51], v[196:199], v[168:171]
    v_mul_f32 v146, s42, v146
    v_mul_f32 v147, s42, v147
    v_mfma_f32_16x16x32_bf16 v[176:179], v[48:51], v[200:203], v[176:179]
    v_mul_f32 v148, s42, v148
    v_mul_f32 v149, s42, v149
    v_mfma_f32_16x16x32_bf16 v[184:187], v[48:51], v[204:207], v[184:187]
    v_accvgpr_write_b32 a210, 0
    s_waitcnt lgkmcnt(0)
    v_mfma_f32_16x16x32_bf16 v[188:191], v[52:55], v[204:207], v[188:191]
    ds_read_b64_tr_b16 v[56:57], v12 offset:57344
    ds_read_b64_tr_b16 v[58:59], v12 offset:58368
    v_mfma_f32_16x16x32_bf16 v[180:183], v[52:55], v[200:203], v[180:183]
    v_mul_f32 v150, s42, v150
    v_accvgpr_write_b32 a211, 0
    v_mfma_f32_16x16x32_bf16 v[172:175], v[52:55], v[196:199], v[172:175]
    v_mul_f32 v151, s42, v151
    v_accvgpr_write_b32 a214, 0
    v_mfma_f32_16x16x32_bf16 v[164:167], v[52:55], v[192:195], v[164:167]
    v_cvt_pk_bf16_f32 v144, v144, v145
    v_cvt_pk_bf16_f32 v145, v146, v147
    v_accvgpr_write_b32 a215, 0
    s_waitcnt lgkmcnt(0)
    v_mfma_f32_16x16x32_bf16 v[160:163], v[56:59], v[208:211], v[160:163]
    ds_read_b64_tr_b16 v[60:61], v13 offset:57344
    ds_read_b64_tr_b16 v[62:63], v13 offset:58368
    v_cvt_pk_bf16_f32 v146, v148, v149
    v_accvgpr_write_b32 a234, 0
    v_mfma_f32_16x16x32_bf16 v[168:171], v[56:59], v[212:215], v[168:171]
    v_cvt_pk_bf16_f32 v147, v150, v151
    v_accvgpr_write_b32 a235, 0
    v_mfma_f32_16x16x32_bf16 v[176:179], v[56:59], v[216:219], v[176:179]
    v_mul_f32 v152, s42, v152
    v_accvgpr_write_b32 a238, 0
    v_mfma_f32_16x16x32_bf16 v[184:187], v[56:59], v[220:223], v[184:187]
    v_mul_f32 v153, s42, v153
    v_accvgpr_write_b32 a239, 0
    s_waitcnt lgkmcnt(0)
    v_mfma_f32_16x16x32_bf16 v[188:191], v[60:63], v[220:223], v[188:191]
    ds_read_b64_tr_b16 v[48:49], v12 offset:0
    ds_read_b64_tr_b16 v[50:51], v12 offset:1024
    v_mul_f32 v154, s42, v154
    v_mov_b32 v112, 0
    v_mfma_f32_16x16x32_bf16 v[180:183], v[60:63], v[216:219], v[180:183]
    v_mul_f32 v155, s42, v155
    v_mov_b32 v113, 0
    v_mfma_f32_16x16x32_bf16 v[172:175], v[60:63], v[212:215], v[172:175]
    ds_read_b64_tr_b16 v[52:53], v13 offset:0
    ds_read_b64_tr_b16 v[54:55], v13 offset:1024
    v_mul_f32 v156, s42, v156
    v_mul_f32 v157, s42, v157
    v_mfma_f32_16x16x32_bf16 v[164:167], v[60:63], v[208:211], v[164:167]
    v_mul_f32 v158, s42, v158
    s_waitcnt lgkmcnt(2)
    v_mfma_f32_16x16x32_bf16 v[160:163], v[48:51], v[224:227], v[160:163]
    s_waitcnt vmcnt(10)
    s_barrier
    ds_read_b64_tr_b16 v[56:57], v12 offset:8192
    ds_read_b64_tr_b16 v[58:59], v12 offset:9216
    v_mul_f32 v159, s42, v159
    v_mfma_f32_16x16x32_bf16 v[168:171], v[48:51], v[228:231], v[168:171]
    v_cvt_pk_bf16_f32 v152, v152, v153
    s_waitcnt lgkmcnt(2)
    v_mfma_f32_16x16x32_bf16 v[164:167], v[52:55], v[224:227], v[164:167]
    ds_read_b64_tr_b16 v[60:61], v13 offset:8192
    ds_read_b64_tr_b16 v[62:63], v13 offset:9216
    ds_read_b128 a[200:203], v34 offset:0
    v_cvt_pk_bf16_f32 v153, v154, v155
    v_mfma_f32_16x16x32_bf16 v[172:175], v[52:55], v[228:231], v[172:175]
    ds_read_b64 a[208:209], v9 offset:0
    v_cvt_pk_bf16_f32 v154, v156, v157
    s_waitcnt lgkmcnt(4)
    v_mfma_f32_16x16x32_bf16 v[160:163], v[56:59], v[240:243], v[160:163]
    ds_read_b64_tr_b16 v[48:49], v12 offset:0
    ds_read_b64_tr_b16 v[50:51], v12 offset:1024
    v_cvt_pk_bf16_f32 v155, v158, v159
    v_mfma_f32_16x16x32_bf16 v[168:171], v[56:59], v[244:247], v[168:171]
    ds_read_b128 a[204:207], v34 offset:512
    v_permlane16_swap_b32 v144, v146
    v_permlane16_swap_b32 v145, v147
    s_waitcnt lgkmcnt(5)
    v_mfma_f32_16x16x32_bf16 v[164:167], v[60:63], v[240:243], v[164:167]
    ds_read_b64_tr_b16 v[52:53], v13 offset:0
    ds_read_b64_tr_b16 v[54:55], v13 offset:1024
    v_and_b32 v144, s52, v144
    v_mfma_f32_16x16x32_bf16 v[172:175], v[60:63], v[244:247], v[172:175]
    buffer_store_dwordx4 v[144:147], v16, s[16:19], s92 offen offset:512 sc1
    ds_read_b64_tr_b16 a[216:217], v35 offset:0
    s_waitcnt lgkmcnt(4)
    v_mfma_f32_16x16x32_bf16 v[176:179], v[48:51], v[232:235], v[176:179]
    ds_read_b64_tr_b16 v[56:57], v12 offset:8192
    ds_read_b64_tr_b16 v[58:59], v12 offset:9216
    ds_read_b64_tr_b16 a[218:219], v35 offset:128
    v_permlane16_swap_b32 v152, v154
    v_mfma_f32_16x16x32_bf16 v[184:187], v[48:51], v[236:239], v[184:187]
    v_permlane16_swap_b32 v153, v155
    s_waitcnt lgkmcnt(4)
    v_mfma_f32_16x16x32_bf16 v[180:183], v[52:55], v[232:235], v[180:183]
    ds_read_b64_tr_b16 v[60:61], v13 offset:8192
    ds_read_b64_tr_b16 v[62:63], v13 offset:9216
    ds_read_b64_tr_b16 a[220:221], v35 offset:256
    v_and_b32 v152, s52, v152
    v_mfma_f32_16x16x32_bf16 v[188:191], v[52:55], v[236:239], v[188:191]
    buffer_store_dwordx4 v[152:155], v16, s[16:19], s92 offen offset:768 sc1
    s_waitcnt lgkmcnt(4)
    v_mfma_f32_16x16x32_bf16 v[176:179], v[56:59], v[248:251], v[176:179]
    ds_read_b64_tr_b16 a[222:223], v35 offset:384
    s_add_u32 s92, s41, 7995392
    v_mfma_f32_16x16x32_bf16 v[184:187], v[56:59], v[252:255], v[184:187]
    v_mul_f32 v160, s42, v160
    s_waitcnt lgkmcnt(2)
    v_mfma_f32_16x16x32_bf16 v[180:183], v[60:63], v[248:251], v[180:183]
    v_mul_f32 v161, s42, v161
    v_mul_f32 v162, s42, v162
    v_mfma_f32_16x16x32_bf16 v[188:191], v[60:63], v[252:255], v[188:191]
    v_mul_f32 v163, s42, v163
    v_mul_f32 v164, s42, v164
    v_mul_f32 v165, s42, v165
    v_mul_f32 v166, s42, v166
    v_mul_f32 v167, s42, v167
    v_cvt_pk_bf16_f32 v160, v160, v161
    v_cvt_pk_bf16_f32 v161, v162, v163
    v_cvt_pk_bf16_f32 v162, v164, v165
    v_cvt_pk_bf16_f32 v163, v166, v167
    v_mul_f32 v168, s42, v168
    v_mul_f32 v169, s42, v169
    v_mul_f32 v170, s42, v170
    v_mul_f32 v171, s42, v171
    v_mul_f32 v172, s42, v172
    v_mul_f32 v173, s42, v173
    v_mul_f32 v174, s42, v174
    v_mul_f32 v175, s42, v175
    v_cvt_pk_bf16_f32 v168, v168, v169
    v_cvt_pk_bf16_f32 v169, v170, v171
    v_cvt_pk_bf16_f32 v170, v172, v173
    v_cvt_pk_bf16_f32 v171, v174, v175
    v_permlane16_swap_b32 v160, v162
    v_permlane16_swap_b32 v161, v163
    v_and_b32 v160, s52, v160
    buffer_store_dwordx4 v[160:163], v16, s[16:19], s92 offen offset:0 sc1
    v_permlane16_swap_b32 v168, v170
    v_permlane16_swap_b32 v169, v171
    v_and_b32 v168, s52, v168
    buffer_store_dwordx4 v[168:171], v16, s[16:19], s92 offen offset:256 sc1
    s_waitcnt vmcnt(13)
    v_mfma_f32_32x32x16_bf16 v[64:79], a[200:203], v[96:99], v[80:95]
    s_waitcnt vmcnt(10)
    v_mfma_f32_32x32x16_bf16 v[64:79], a[208:211], v[104:107], v[64:79]
    ds_read2_b32 v[208:209], v40 offset0:0 offset1:1
    ds_read2_b32 v[210:211], v40 offset0:2 offset1:3
    ds_read2_b32 v[212:213], v40 offset0:8 offset1:9
    ds_read2_b32 v[214:215], v40 offset0:10 offset1:11
    ds_read2_b32 v[216:217], v40 offset0:16 offset1:17
    ds_read2_b32 v[218:219], v40 offset0:18 offset1:19
    ds_read2_b32 v[220:221], v40 offset0:24 offset1:25
    ds_read2_b32 v[222:223], v40 offset0:26 offset1:27
    v_mul_f32 v176, s42, v176
    v_mul_f32 v177, s42, v177
    v_mul_f32 v178, s42, v178
    v_mul_f32 v179, s42, v179
    v_mul_f32 v180, s42, v180
    v_mul_f32 v181, s42, v181
    v_mul_f32 v182, s42, v182
    v_mul_f32 v183, s42, v183
    v_cvt_pk_bf16_f32 v176, v176, v177
    v_cvt_pk_bf16_f32 v177, v178, v179
    v_cvt_pk_bf16_f32 v178, v180, v181
    v_cvt_pk_bf16_f32 v179, v182, v183
    v_mul_f32 v184, s42, v184
    v_mul_f32 v185, s42, v185
    v_mul_f32 v186, s42, v186
    v_mul_f32 v187, s42, v187
    v_mul_f32 v188, s42, v188
    v_mul_f32 v189, s42, v189
    v_mul_f32 v190, s42, v190
    v_mul_f32 v191, s42, v191
    v_cvt_pk_bf16_f32 v184, v184, v185
    v_cvt_pk_bf16_f32 v185, v186, v187
    v_cvt_pk_bf16_f32 v186, v188, v189
    v_cvt_pk_bf16_f32 v187, v190, v191
    v_permlane16_swap_b32 v176, v178
    v_permlane16_swap_b32 v177, v179
    v_and_b32 v176, s52, v176
    buffer_store_dwordx4 v[176:179], v16, s[16:19], s92 offen offset:512 sc1
    v_permlane16_swap_b32 v184, v186
    v_permlane16_swap_b32 v185, v187
    v_and_b32 v184, s52, v184
    buffer_store_dwordx4 v[184:187], v16, s[16:19], s92 offen offset:768 sc1
L_join:
    v_mfma_f32_32x32x16_bf16 v[192:207], a[204:207], v[96:99], 0
    ds_read_b64_tr_b16 a[224:225], v35 offset:512
    ds_read_b64_tr_b16 a[226:227], v35 offset:640
    v_exp_f32 v48, v64
    v_exp_f32 v49, v65
    v_exp_f32 v50, v66
    v_exp_f32 v51, v67
    s_add_u32 s51, s51, 32768
    ds_read_b64_tr_b16 a[228:229], v35 offset:768
    ds_read_b64_tr_b16 a[230:231], v35 offset:896
    v_cvt_pk_bf16_f32 v56, v48, v49
    v_cvt_pk_bf16_f32 v57, v50, v51
    v_exp_f32 v52, v68
    v_exp_f32 v53, v69
    v_exp_f32 v54, v70
    v_exp_f32 v55, v71
    s_add_u32 s94, s55, 15749120
    s_waitcnt vmcnt(9)
    v_mfma_f32_32x32x16_bf16 v[192:207], a[208:211], v[106:109], v[192:207]
    buffer_load_dwordx4 a[80:83], v20, s[16:19], s94 offen offset:0 sc1
    v_cvt_pk_bf16_f32 v58, v52, v53
    v_cvt_pk_bf16_f32 v59, v54, v55
    v_exp_f32 v48, v72
    v_exp_f32 v49, v73
    v_exp_f32 v50, v74
    v_exp_f32 v51, v75
    v_mfma_f32_32x32x16_bf16 v[224:239], a[216:219], v[56:59], 0
    ds_read_b128 a[200:203], v34 offset:1024
    ds_read_b64 a[212:213], v9 offset:1024
    buffer_load_dwordx4 a[84:87], v20, s[16:19], s94 offen offset:1024 sc1
    v_cvt_pk_bf16_f32 v60, v48, v49
    v_cvt_pk_bf16_f32 v61, v50, v51
    v_exp_f32 v52, v76
    v_exp_f32 v53, v77
    v_exp_f32 v54, v78
    v_exp_f32 v55, v79
    v_mfma_f32_32x32x16_bf16 v[64:79], a[204:207], v[100:103], v[80:95]
    ds_read2_b32 v[160:161], v40 offset0:159 offset1:160
    buffer_load_dwordx4 a[88:91], v20, s[16:19], s94 offen offset:2048 sc1
    v_cvt_pk_bf16_f32 v62, v52, v53
    v_cvt_pk_bf16_f32 v63, v54, v55
    v_exp_f32 v48, v192
    v_exp_f32 v49, v193
    v_exp_f32 v50, v194
    v_exp_f32 v51, v195
    s_waitcnt lgkmcnt(15)
    v_mfma_f32_32x32x16_bf16 v[224:239], a[220:223], v[60:63], v[224:239]
    ds_read_b64_tr_b16 a[216:217], v35 offset:1024
    ds_read_b64_tr_b16 a[218:219], v35 offset:1152
    buffer_load_dwordx4 a[92:95], v20, s[16:19], s94 offen offset:3072 sc1
    v_cvt_pk_bf16_f32 v56, v48, v49
    v_cvt_pk_bf16_f32 v57, v50, v51
    v_exp_f32 v52, v196
    v_exp_f32 v53, v197
    v_exp_f32 v54, v198
    v_exp_f32 v55, v199
    s_waitcnt vmcnt(12)
    v_mfma_f32_32x32x16_bf16 v[64:79], a[208:211], v[110:113], v[64:79]
    ds_read_b64_tr_b16 a[220:221], v35 offset:1280
    ds_read_b64_tr_b16 a[222:223], v35 offset:1408
    ds_read2_b32 v[162:163], v40 offset0:161 offset1:162
    v_cvt_pk_bf16_f32 v58, v52, v53
    v_cvt_pk_bf16_f32 v59, v54, v55
    v_exp_f32 v48, v200
    v_exp_f32 v49, v201
    v_exp_f32 v50, v202
    v_exp_f32 v51, v203
    s_add_u32 s94, s55, 15753216
    s_waitcnt lgkmcnt(6)
    v_mfma_f32_32x32x16_bf16 v[224:239], a[224:227], v[56:59], v[224:239]
    v_cvt_pk_bf16_f32 v60, v48, v49
    v_cvt_pk_bf16_f32 v61, v50, v51
    v_exp_f32 v52, v204
    v_exp_f32 v53, v205
    v_exp_f32 v54, v206
    v_exp_f32 v55, v207
    v_mfma_f32_32x32x16_bf16 v[192:207], a[200:203], v[96:99], 0
    ds_read_b128 a[204:207], v34 offset:1536
    ds_read2_b32 v[164:165], v40 offset0:167 offset1:168
    buffer_load_dwordx4 a[96:99], v20, s[16:19], s94 offen offset:0 sc1
    v_cvt_pk_bf16_f32 v62, v52, v53
    v_cvt_pk_bf16_f32 v63, v54, v55
    v_exp_f32 v48, v64
    v_exp_f32 v49, v65
    v_exp_f32 v50, v66
    v_exp_f32 v51, v67
    v_mfma_f32_32x32x16_bf16 v[224:239], a[228:231], v[60:63], v[224:239]
    v_cvt_pk_bf16_f32 v56, v48, v49
    v_cvt_pk_bf16_f32 v57, v50, v51
    v_exp_f32 v52, v68
    v_exp_f32 v53, v69
    v_exp_f32 v54, v70
    v_exp_f32 v55, v71
    s_add_u32 s94, s55, 16547840
    v_mfma_f32_32x32x16_bf16 v[192:207], a[212:215], v[104:107], v[192:207]
    ds_read2_b32 v[166:167], v40 offset0:169 offset1:170
    buffer_load_dwordx4 a[100:103], v20, s[16:19], s94 offen offset:0 sc1
    v_cvt_pk_bf16_f32 v58, v52, v53
    v_cvt_pk_bf16_f32 v59, v54, v55
    v_exp_f32 v48, v72
    v_exp_f32 v49, v73
    v_exp_f32 v50, v74
    v_exp_f32 v51, v75
    v_mfma_f32_32x32x16_bf16 v[240:255], a[224:227], v[56:59], 0
    buffer_load_dwordx4 a[104:107], v20, s[16:19], s94 offen offset:1024 sc1
    v_cvt_pk_bf16_f32 v60, v48, v49
    v_cvt_pk_bf16_f32 v61, v50, v51
    v_exp_f32 v52, v76
    v_exp_f32 v53, v77
    v_exp_f32 v54, v78
    v_exp_f32 v55, v79
    v_mfma_f32_32x32x16_bf16 v[64:79], a[200:203], v[100:103], 0
    ds_read2_b32 v[168:169], v40 offset0:175 offset1:176
    buffer_load_dwordx4 a[108:111], v20, s[16:19], s94 offen offset:2048 sc1
    v_cvt_pk_bf16_f32 v62, v52, v53
    v_cvt_pk_bf16_f32 v63, v54, v55
    v_exp_f32 v48, v192
    v_exp_f32 v49, v193
    v_exp_f32 v50, v194
    v_exp_f32 v51, v195
    v_mfma_f32_32x32x16_bf16 v[240:255], a[228:231], v[60:63], v[240:255]
    ds_read_b64_tr_b16 a[224:225], v35 offset:1536
    ds_read_b64_tr_b16 a[226:227], v35 offset:1664
    buffer_load_dwordx4 a[112:115], v20, s[16:19], s94 offen offset:3072 sc1
    v_cvt_pk_bf16_f32 v56, v48, v49
    v_cvt_pk_bf16_f32 v57, v50, v51
    v_exp_f32 v52, v196
    v_exp_f32 v53, v197
    v_exp_f32 v54, v198
    v_exp_f32 v55, v199
    v_mfma_f32_32x32x16_bf16 v[64:79], a[212:215], v[108:111], v[64:79]
    ds_read_b64_tr_b16 a[228:229], v35 offset:1792
    ds_read_b64_tr_b16 a[230:231], v35 offset:1920
    ds_read2_b32 v[170:171], v40 offset0:177 offset1:178
    v_cvt_pk_bf16_f32 v58, v52, v53
    v_cvt_pk_bf16_f32 v59, v54, v55
    v_exp_f32 v48, v200
    v_exp_f32 v49, v201
    v_exp_f32 v50, v202
    v_exp_f32 v51, v203
    s_waitcnt lgkmcnt(8)
    v_mfma_f32_32x32x16_bf16 v[224:239], a[216:219], v[56:59], v[224:239]
    v_cvt_pk_bf16_f32 v60, v48, v49
    v_cvt_pk_bf16_f32 v61, v50, v51
    v_exp_f32 v52, v204
    v_exp_f32 v53, v205
    v_exp_f32 v54, v206
    v_exp_f32 v55, v207
    s_waitcnt vmcnt(9)
    s_barrier
    buffer_store_dword v18, v17, s[16:19], s51 offen offset:0 sc1
    s_add_u32 s94, s55, 16551936
    v_mfma_f32_32x32x16_bf16 v[192:207], a[204:207], v[96:99], 0
    ds_read_b128 a[200:203], v34 offset:2048
    ds_read_b64 a[208:209], v9 offset:2048
    ds_read2_b32 v[172:173], v40 offset0:183 offset1:184
    buffer_load_dwordx4 a[116:119], v20, s[16:19], s94 offen offset:0 sc1
    v_cvt_pk_bf16_f32 v62, v52, v53
    v_cvt_pk_bf16_f32 v63, v54, v55
    v_exp_f32 v48, v64
    v_exp_f32 v49, v65
    v_exp_f32 v50, v66
    v_exp_f32 v51, v67
    v_mfma_f32_32x32x16_bf16 v[224:239], a[220:223], v[60:63], v[224:239]
    buffer_load_dwordx4 a[120:123], v20, s[16:19], s94 offen offset:1024 sc1
    v_cvt_pk_bf16_f32 v56, v48, v49
    v_cvt_pk_bf16_f32 v57, v50, v51
    v_exp_f32 v52, v68
    v_exp_f32 v53, v69
    v_exp_f32 v54, v70
    v_exp_f32 v55, v71
    v_mfma_f32_32x32x16_bf16 v[192:207], a[212:215], v[106:109], v[192:207]
    ds_read2_b32 v[174:175], v40 offset0:185 offset1:186
    buffer_load_dwordx4 a[124:127], v20, s[16:19], s94 offen offset:2048 sc1
    v_cvt_pk_bf16_f32 v58, v52, v53
    v_cvt_pk_bf16_f32 v59, v54, v55
    v_exp_f32 v48, v72
    v_exp_f32 v49, v73
    v_exp_f32 v50, v74
    v_exp_f32 v51, v75
    v_mfma_f32_32x32x16_bf16 v[240:255], a[216:219], v[56:59], v[240:255]
    buffer_load_dwordx4 a[128:131], v20, s[16:19], s94 offen offset:3072 sc1
    v_cvt_pk_bf16_f32 v60, v48, v49
    v_cvt_pk_bf16_f32 v61, v50, v51
    v_exp_f32 v52, v76
    v_exp_f32 v53, v77
    v_exp_f32 v54, v78
    v_exp_f32 v55, v79
    v_mfma_f32_32x32x16_bf16 v[64:79], a[204:207], v[100:103], 0
    ds_read2_b32 v[176:177], v40 offset0:143 offset1:144
    v_cvt_pk_bf16_f32 v62, v52, v53
    v_cvt_pk_bf16_f32 v63, v54, v55
    v_exp_f32 v48, v192
    v_exp_f32 v49, v193
    v_exp_f32 v50, v194
    v_exp_f32 v51, v195
    s_add_u32 s94, s55, 16556032
    v_mfma_f32_32x32x16_bf16 v[240:255], a[220:223], v[60:63], v[240:255]
    ds_read_b64_tr_b16 a[216:217], v35 offset:2048
    ds_read_b64_tr_b16 a[218:219], v35 offset:2176
    v_cvt_pk_bf16_f32 v56, v48, v49
    v_cvt_pk_bf16_f32 v57, v50, v51
    v_exp_f32 v52, v196
    v_exp_f32 v53, v197
    v_exp_f32 v54, v198
    v_exp_f32 v55, v199
    v_mfma_f32_32x32x16_bf16 v[64:79], a[212:215], v[110:113], v[64:79]
    ds_read_b64_tr_b16 a[220:221], v35 offset:2304
    ds_read_b64_tr_b16 a[222:223], v35 offset:2432
    ds_read2_b32 v[178:179], v40 offset0:145 offset1:146
    buffer_load_dwordx4 a[132:135], v20, s[16:19], s94 offen offset:0 sc1
    v_cvt_pk_bf16_f32 v58, v52, v53
    v_cvt_pk_bf16_f32 v59, v54, v55
    v_exp_f32 v48, v200
    v_exp_f32 v49, v201
    v_exp_f32 v50, v202
    v_exp_f32 v51, v203
    s_waitcnt lgkmcnt(8)
    v_mfma_f32_32x32x16_bf16 v[224:239], a[224:227], v[56:59], v[224:239]
    buffer_load_dwordx4 a[136:139], v20, s[16:19], s94 offen offset:1024 sc1
    v_cvt_pk_bf16_f32 v60, v48, v49
    v_cvt_pk_bf16_f32 v61, v50, v51
    v_exp_f32 v52, v204
    v_exp_f32 v53, v205
    v_exp_f32 v54, v206
    v_exp_f32 v55, v207
    v_mfma_f32_32x32x16_bf16 v[192:207], a[200:203], v[96:99], 0
    ds_read_b128 a[204:207], v34 offset:2560
    ds_read2_b32 v[180:181], v40 offset0:151 offset1:152
    buffer_load_dwordx4 a[140:143], v20, s[16:19], s94 offen offset:2048 sc1
    v_cvt_pk_bf16_f32 v62, v52, v53
    v_cvt_pk_bf16_f32 v63, v54, v55
    v_exp_f32 v48, v64
    v_exp_f32 v49, v65
    v_exp_f32 v50, v66
    v_exp_f32 v51, v67
    v_mfma_f32_32x32x16_bf16 v[224:239], a[228:231], v[60:63], v[224:239]
    buffer_load_dwordx4 a[144:147], v20, s[16:19], s94 offen offset:3072 sc1
    v_cvt_pk_bf16_f32 v56, v48, v49
    v_cvt_pk_bf16_f32 v57, v50, v51
    v_exp_f32 v52, v68
    v_exp_f32 v53, v69
    v_exp_f32 v54, v70
    v_exp_f32 v55, v71
    v_mfma_f32_32x32x16_bf16 v[192:207], a[208:211], v[104:107], v[192:207]
    ds_read2_b32 v[182:183], v40 offset0:153 offset1:154
    v_cvt_pk_bf16_f32 v58, v52, v53
    v_cvt_pk_bf16_f32 v59, v54, v55
    v_exp_f32 v48, v72
    v_exp_f32 v49, v73
    v_exp_f32 v50, v74
    v_exp_f32 v51, v75
    s_add_u32 s94, s55, 16560128
    v_mfma_f32_32x32x16_bf16 v[240:255], a[224:227], v[56:59], v[240:255]
    buffer_load_dwordx4 a[148:151], v20, s[16:19], s94 offen offset:0 sc1
    v_cvt_pk_bf16_f32 v60, v48, v49
    v_cvt_pk_bf16_f32 v61, v50, v51
    v_exp_f32 v52, v76
    v_exp_f32 v53, v77
    v_exp_f32 v54, v78
    v_exp_f32 v55, v79
    v_mfma_f32_32x32x16_bf16 v[64:79], a[200:203], v[100:103], 0
    ds_read2_b32 v[184:185], v41 offset0:143 offset1:144
    v_cvt_pk_bf16_f32 v62, v52, v53
    v_cvt_pk_bf16_f32 v63, v54, v55
    v_exp_f32 v48, v192
    v_exp_f32 v49, v193
    v_exp_f32 v50, v194
    v_exp_f32 v51, v195
    v_mfma_f32_32x32x16_bf16 v[240:255], a[228:231], v[60:63], v[240:255]
    ds_read_b64_tr_b16 a[224:225], v35 offset:2560
    ds_read_b64_tr_b16 a[226:227], v35 offset:2688
    buffer_load_dwordx4 a[152:155], v20, s[16:19], s94 offen offset:1024 sc1
    v_cvt_pk_bf16_f32 v56, v48, v49
    v_cvt_pk_bf16_f32 v57, v50, v51
    v_exp_f32 v52, v196
    v_exp_f32 v53, v197
    v_exp_f32 v54, v198
    v_exp_f32 v55, v199
    v_mfma_f32_32x32x16_bf16 v[64:79], a[208:211], v[108:111], v[64:79]
    ds_read_b64_tr_b16 a[228:229], v35 offset:2816
    ds_read_b64_tr_b16 a[230:231], v35 offset:2944
    ds_read2_b32 v[186:187], v41 offset0:145 offset1:146
    buffer_load_dwordx4 a[156:159], v20, s[16:19], s94 offen offset:2048 sc1
    v_cvt_pk_bf16_f32 v58, v52, v53
    v_cvt_pk_bf16_f32 v59, v54, v55
    v_exp_f32 v48, v200
    v_exp_f32 v49, v201
    v_exp_f32 v50, v202
    v_exp_f32 v51, v203
    s_waitcnt lgkmcnt(8)
    v_mfma_f32_32x32x16_bf16 v[224:239], a[216:219], v[56:59], v[224:239]
    buffer_load_dwordx4 a[160:163], v20, s[16:19], s94 offen offset:3072 sc1
    v_cvt_pk_bf16_f32 v60, v48, v49
    v_cvt_pk_bf16_f32 v61, v50, v51
    v_exp_f32 v52, v204
    v_exp_f32 v53, v205
    v_exp_f32 v54, v206
    v_exp_f32 v55, v207
    v_mfma_f32_32x32x16_bf16 v[192:207], a[204:207], v[96:99], 0
    ds_read_b128 a[200:203], v34 offset:3072
    ds_read_b64 a[212:213], v9 offset:3072
    ds_read2_b32 v[188:189], v41 offset0:151 offset1:152
    v_cvt_pk_bf16_f32 v62, v52, v53
    v_cvt_pk_bf16_f32 v63, v54, v55
    v_exp_f32 v48, v64
    v_exp_f32 v49, v65
    v_exp_f32 v50, v66
    v_exp_f32 v51, v67
    s_add_u32 s94, s55, 16564224
    v_mfma_f32_32x32x16_bf16 v[224:239], a[220:223], v[60:63], v[224:239]
    buffer_load_dwordx4 a[164:167], v20, s[16:19], s94 offen offset:0 sc1
    v_cvt_pk_bf16_f32 v56, v48, v49
    v_cvt_pk_bf16_f32 v57, v50, v51
    v_exp_f32 v52, v68
    v_exp_f32 v53, v69
    v_exp_f32 v54, v70
    v_exp_f32 v55, v71
    v_mfma_f32_32x32x16_bf16 v[192:207], a[208:211], v[106:109], v[192:207]
    ds_read2_b32 v[190:191], v41 offset0:153 offset1:154
    v_cvt_pk_bf16_f32 v58, v52, v53
    v_cvt_pk_bf16_f32 v59, v54, v55
    v_exp_f32 v48, v72
    v_exp_f32 v49, v73
    v_exp_f32 v50, v74
    v_exp_f32 v51, v75
    v_mfma_f32_32x32x16_bf16 v[240:255], a[216:219], v[56:59], v[240:255]
    buffer_load_dword v19, v30, s[16:19], s97 offen offset:0 sc1
    v_cvt_pk_bf16_f32 v60, v48, v49
    v_cvt_pk_bf16_f32 v61, v50, v51
    v_exp_f32 v52, v76
    v_exp_f32 v53, v77
    v_exp_f32 v54, v78
    v_exp_f32 v55, v79
    v_mfma_f32_32x32x16_bf16 v[64:79], a[204:207], v[100:103], 0
    v_cvt_pk_bf16_f32 v62, v52, v53
    v_cvt_pk_bf16_f32 v63, v54, v55
    v_exp_f32 v48, v192
    v_exp_f32 v49, v193
    v_exp_f32 v50, v194
    v_exp_f32 v51, v195
    v_mfma_f32_32x32x16_bf16 v[240:255], a[220:223], v[60:63], v[240:255]
    ds_read_b64_tr_b16 a[216:217], v35 offset:3072
    ds_read_b64_tr_b16 a[218:219], v35 offset:3200
    v_cvt_pk_bf16_f32 v56, v48, v49
    v_cvt_pk_bf16_f32 v57, v50, v51
    v_exp_f32 v52, v196
    v_exp_f32 v53, v197
    v_exp_f32 v54, v198
    v_exp_f32 v55, v199
    v_mfma_f32_32x32x16_bf16 v[64:79], a[208:211], v[110:113], v[64:79]
    ds_read_b64_tr_b16 a[220:221], v35 offset:3328
    ds_read_b64_tr_b16 a[222:223], v35 offset:3456
    v_cvt_pk_bf16_f32 v58, v52, v53
    v_cvt_pk_bf16_f32 v59, v54, v55
    v_exp_f32 v48, v200
    v_exp_f32 v49, v201
    v_exp_f32 v50, v202
    v_exp_f32 v51, v203
    s_waitcnt lgkmcnt(6)
    v_mfma_f32_32x32x16_bf16 v[224:239], a[224:227], v[56:59], v[224:239]
    v_cvt_pk_bf16_f32 v60, v48, v49
    v_cvt_pk_bf16_f32 v61, v50, v51
    v_exp_f32 v52, v204
    v_exp_f32 v53, v205
    v_exp_f32 v54, v206
    v_exp_f32 v55, v207
    v_mfma_f32_32x32x16_bf16 v[192:207], a[200:203], v[96:99], 0
    ds_read_b128 a[204:207], v34 offset:3584
    v_cvt_pk_bf16_f32 v62, v52, v53
    v_cvt_pk_bf16_f32 v63, v54, v55
    v_exp_f32 v48, v64
    v_exp_f32 v49, v65
    v_exp_f32 v50, v66
    v_exp_f32 v51, v67
    v_mfma_f32_32x32x16_bf16 v[224:239], a[228:231], v[60:63], v[224:239]
    v_cvt_pk_bf16_f32 v56, v48, v49
    v_cvt_pk_bf16_f32 v57, v50, v51
    v_exp_f32 v52, v68
    v_exp_f32 v53, v69
    v_exp_f32 v54, v70
    v_exp_f32 v55, v71
    s_add_u32 s64, s84, 13107200
    s_add_u32 s65, s84, 13138880
    s_add_u32 s66, s85, 13105024
    s_mov_b32 m0, s89
    v_mfma_f32_32x32x16_bf16 v[192:207], a[212:215], v[104:107], v[192:207]
    v_cvt_pk_bf16_f32 v58, v52, v53
    v_cvt_pk_bf16_f32 v59, v54, v55
    v_exp_f32 v48, v72
    v_exp_f32 v49, v73
    v_exp_f32 v50, v74
    v_exp_f32 v51, v75
    s_add_u32 s60, s84, 7864320
    s_add_u32 s61, s85, 7864320
    s_add_u32 s62, s84, 10485248
    s_add_u32 s63, s85, 10485248
    v_mfma_f32_32x32x16_bf16 v[240:255], a[224:227], v[56:59], v[240:255]
    v_cvt_pk_bf16_f32 v60, v48, v49
    v_cvt_pk_bf16_f32 v61, v50, v51
    v_exp_f32 v52, v76
    v_exp_f32 v53, v77
    v_exp_f32 v54, v78
    v_exp_f32 v55, v79
    s_waitcnt vmcnt(0)
    v_cmp_ne_u32 vcc, 1, v19
    s_cbranch_vccnz L_poll_7
L_back_8:
    v_mfma_f32_32x32x16_bf16 v[64:79], a[200:203], v[100:103], 0
    buffer_load_dword v46, v7, s[16:19], s90 offen sc1
    buffer_load_dword v47, v7, s[16:19], s90 offen offset:128 sc1
    v_cvt_pk_bf16_f32 v62, v52, v53
    v_cvt_pk_bf16_f32 v63, v54, v55
    v_exp_f32 v48, v192
    v_exp_f32 v49, v193
    v_exp_f32 v50, v194
    v_exp_f32 v51, v195
    v_mfma_f32_32x32x16_bf16 v[240:255], a[228:231], v[60:63], v[240:255]
    ds_read_b64_tr_b16 a[224:225], v35 offset:3584
    ds_read_b64_tr_b16 a[226:227], v35 offset:3712
    buffer_load_dwordx4 v[128:131], v31, s[16:19], s60 offen sc1
    v_cvt_pk_bf16_f32 v56, v48, v49
    v_cvt_pk_bf16_f32 v57, v50, v51
    v_exp_f32 v52, v196
    v_exp_f32 v53, v197
    v_exp_f32 v54, v198
    v_exp_f32 v55, v199
    v_mfma_f32_32x32x16_bf16 v[64:79], a[212:215], v[108:111], v[64:79]
    ds_read_b64_tr_b16 a[228:229], v35 offset:3840
    ds_read_b64_tr_b16 a[230:231], v35 offset:3968
    buffer_load_dwordx4 v[144:147], v8, s[16:19], s62 offen sc1
    v_cvt_pk_bf16_f32 v58, v52, v53
    v_cvt_pk_bf16_f32 v59, v54, v55
    v_exp_f32 v48, v200
    v_exp_f32 v49, v201
    v_exp_f32 v50, v202
    v_exp_f32 v51, v203
    s_waitcnt lgkmcnt(4)
    v_mfma_f32_32x32x16_bf16 v[224:239], a[216:219], v[56:59], v[224:239]
    buffer_load_dwordx2 v[136:137], v32, s[16:19], s61 offen sc1
    buffer_load_dwordx2 v[138:139], v33, s[16:19], s61 offen sc1
    v_cvt_pk_bf16_f32 v60, v48, v49
    v_cvt_pk_bf16_f32 v61, v50, v51
    v_exp_f32 v52, v204
    v_exp_f32 v53, v205
    v_exp_f32 v54, v206
    v_exp_f32 v55, v207
    v_mfma_f32_32x32x16_bf16 v[192:207], a[204:207], v[96:99], 0
    ds_read_b128 a[200:203], v34 offset:4096
    ds_read_b64 a[208:209], v9 offset:4096
    buffer_load_dwordx2 a[232:233], v38, s[16:19], s63 offen sc1
    v_cvt_pk_bf16_f32 v62, v52, v53
    v_cvt_pk_bf16_f32 v63, v54, v55
    v_exp_f32 v48, v64
    v_exp_f32 v49, v65
    v_exp_f32 v50, v66
    v_exp_f32 v51, v67
    v_mfma_f32_32x32x16_bf16 v[224:239], a[220:223], v[60:63], v[224:239]
    buffer_load_dwordx4 v[148:151], v31, s[16:19], s62 offen offset:512 sc1
    v_cvt_pk_bf16_f32 v56, v48, v49
    v_cvt_pk_bf16_f32 v57, v50, v51
    v_exp_f32 v52, v68
    v_exp_f32 v53, v69
    v_exp_f32 v54, v70
    v_exp_f32 v55, v71
    v_mfma_f32_32x32x16_bf16 v[192:207], a[212:215], v[106:109], v[192:207]
    buffer_load_dwordx4 v[132:135], v31, s[16:19], s60 offen offset:512 sc1
    buffer_load_dwordx2 v[140:141], v33, s[16:19], s61 offen offset:512 sc1
    v_cvt_pk_bf16_f32 v58, v52, v53
    v_cvt_pk_bf16_f32 v59, v54, v55
    v_exp_f32 v48, v72
    v_exp_f32 v49, v73
    v_exp_f32 v50, v74
    v_exp_f32 v51, v75
    v_mfma_f32_32x32x16_bf16 v[240:255], a[216:219], v[56:59], v[240:255]
    buffer_load_dwordx4 v[152:155], v31, s[16:19], s62 offen offset:1024 sc1
    v_cvt_pk_bf16_f32 v60, v48, v49
    v_cvt_pk_bf16_f32 v61, v50, v51
    v_exp_f32 v52, v76
    v_exp_f32 v53, v77
    v_exp_f32 v54, v78
    v_exp_f32 v55, v79
    v_mfma_f32_32x32x16_bf16 v[64:79], a[204:207], v[100:103], 0
    buffer_load_dwordx2 a[236:237], v33, s[16:19], s63 offen offset:1024 sc1
    v_cvt_pk_bf16_f32 v62, v52, v53
    v_cvt_pk_bf16_f32 v63, v54, v55
    v_exp_f32 v48, v192
    v_exp_f32 v49, v193
    v_exp_f32 v50, v194
    v_exp_f32 v51, v195
    v_mfma_f32_32x32x16_bf16 v[240:255], a[220:223], v[60:63], v[240:255]
    ds_read_b64_tr_b16 a[216:217], v35 offset:4096
    ds_read_b64_tr_b16 a[218:219], v35 offset:4224
    buffer_load_dwordx4 v20, s[16:19], s64 offen sc1 lds
    buffer_load_dwordx4 v20, s[16:19], s65 offen offset:1088 sc1 lds
    v_cvt_pk_bf16_f32 v56, v48, v49
    v_cvt_pk_bf16_f32 v57, v50, v51
    v_exp_f32 v52, v196
    v_exp_f32 v53, v197
    v_exp_f32 v54, v198
    v_exp_f32 v55, v199
    v_mfma_f32_32x32x16_bf16 v[64:79], a[212:215], v[110:113], v[64:79]
    ds_read_b64_tr_b16 a[220:221], v35 offset:4352
    ds_read_b64_tr_b16 a[222:223], v35 offset:4480
    buffer_load_dwordx4 v20, s[16:19], s66 offen offset:2176 sc1 lds
    v_cvt_pk_bf16_f32 v58, v52, v53
    v_cvt_pk_bf16_f32 v59, v54, v55
    v_exp_f32 v48, v200
    v_exp_f32 v49, v201
    v_exp_f32 v50, v202
    v_exp_f32 v51, v203
    s_waitcnt lgkmcnt(4)
    v_mfma_f32_32x32x16_bf16 v[224:239], a[224:227], v[56:59], v[224:239]
    v_cvt_pk_bf16_f32 v60, v48, v49
    v_cvt_pk_bf16_f32 v61, v50, v51
    v_exp_f32 v52, v204
    v_exp_f32 v53, v205
    v_exp_f32 v54, v206
    v_exp_f32 v55, v207
    s_add_u32 m0, s89, 3264
    s_nop 0
    buffer_load_dwordx4 v39, s[16:19], 0 offen sc1 lds
    v_mov_b32 v142, 0
    v_mov_b32 v143, 0
    v_mfma_f32_32x32x16_bf16 v[192:207], a[200:203], v[96:99], v[208:223]
    ds_read_b128 a[204:207], v34 offset:4608
    v_cvt_pk_bf16_f32 v62, v52, v53
    v_cvt_pk_bf16_f32 v63, v54, v55
    v_exp_f32 v48, v64
    v_exp_f32 v49, v65
    v_exp_f32 v50, v66
    v_exp_f32 v51, v67
    v_mfma_f32_32x32x16_bf16 v[224:239], a[228:231], v[60:63], v[224:239]
    v_cvt_pk_bf16_f32 v56, v48, v49
    v_cvt_pk_bf16_f32 v57, v50, v51
    v_exp_f32 v52, v68
    v_exp_f32 v53, v69
    v_exp_f32 v54, v70
    v_exp_f32 v55, v71
    v_mfma_f32_32x32x16_bf16 v[192:207], a[208:211], v[104:107], v[192:207]
    v_cvt_pk_bf16_f32 v58, v52, v53
    v_cvt_pk_bf16_f32 v59, v54, v55
    v_exp_f32 v48, v72
    v_exp_f32 v49, v73
    v_exp_f32 v50, v74
    v_exp_f32 v51, v75
    v_mfma_f32_32x32x16_bf16 v[240:255], a[224:227], v[56:59], v[240:255]
    v_cvt_pk_bf16_f32 v60, v48, v49
    v_cvt_pk_bf16_f32 v61, v50, v51
    v_exp_f32 v52, v76
    v_exp_f32 v53, v77
    v_exp_f32 v54, v78
    v_exp_f32 v55, v79
    v_mfma_f32_32x32x16_bf16 v[64:79], a[200:203], v[100:103], 0
    v_cvt_pk_bf16_f32 v62, v52, v53
    v_cvt_pk_bf16_f32 v63, v54, v55
    v_exp_f32 v48, v192
    v_exp_f32 v49, v193
    v_exp_f32 v50, v194
    v_exp_f32 v51, v195
    v_mfma_f32_32x32x16_bf16 v[240:255], a[228:231], v[60:63], v[240:255]
    ds_read_b64_tr_b16 a[224:225], v35 offset:4608
    ds_read_b64_tr_b16 a[226:227], v35 offset:4736
    v_cvt_pk_bf16_f32 v56, v48, v49
    v_cvt_pk_bf16_f32 v57, v50, v51
    v_exp_f32 v52, v196
    v_exp_f32 v53, v197
    v_exp_f32 v54, v198
    v_exp_f32 v55, v199
    v_mfma_f32_32x32x16_bf16 v[64:79], a[208:211], v[108:111], v[64:79]
    ds_read_b64_tr_b16 a[228:229], v35 offset:4864
    ds_read_b64_tr_b16 a[230:231], v35 offset:4992
    v_cvt_pk_bf16_f32 v58, v52, v53
    v_cvt_pk_bf16_f32 v59, v54, v55
    v_exp_f32 v48, v200
    v_exp_f32 v49, v201
    v_exp_f32 v50, v202
    v_exp_f32 v51, v203
    s_waitcnt lgkmcnt(4)
    v_mfma_f32_32x32x16_bf16 v[224:239], a[216:219], v[56:59], v[224:239]
    v_cvt_pk_bf16_f32 v60, v48, v49
    v_cvt_pk_bf16_f32 v61, v50, v51
    v_exp_f32 v52, v204
    v_exp_f32 v53, v205
    v_exp_f32 v54, v206
    v_exp_f32 v55, v207
    v_mfma_f32_32x32x16_bf16 v[192:207], a[204:207], v[100:103], v[208:223]
    v_cvt_pk_bf16_f32 v62, v52, v53
    v_cvt_pk_bf16_f32 v63, v54, v55
    v_exp_f32 v48, v64
    v_exp_f32 v49, v65
    v_exp_f32 v50, v66
    v_exp_f32 v51, v67
    v_mfma_f32_32x32x16_bf16 v[224:239], a[220:223], v[60:63], v[224:239]
    v_cvt_pk_bf16_f32 v56, v48, v49
    v_cvt_pk_bf16_f32 v57, v50, v51
    v_exp_f32 v52, v68
    v_exp_f32 v53, v69
    v_exp_f32 v54, v70
    v_exp_f32 v55, v71
    v_mfma_f32_32x32x16_bf16 v[192:207], a[208:211], v[110:113], v[192:207]
    v_cvt_pk_bf16_f32 v58, v52, v53
    v_cvt_pk_bf16_f32 v59, v54, v55
    v_exp_f32 v48, v72
    v_exp_f32 v49, v73
    v_exp_f32 v50, v74
    v_exp_f32 v51, v75
    v_mfma_f32_32x32x16_bf16 v[240:255], a[216:219], v[56:59], v[240:255]
    v_cvt_pk_bf16_f32 v60, v48, v49
    v_cvt_pk_bf16_f32 v61, v50, v51
    v_exp_f32 v52, v76
    v_exp_f32 v53, v77
    v_exp_f32 v54, v78
    v_exp_f32 v55, v79
    v_cvt_pk_bf16_f32 v62, v52, v53
    v_cvt_pk_bf16_f32 v63, v54, v55
    v_exp_f32 v48, v192
    v_exp_f32 v49, v193
    v_exp_f32 v50, v194
    v_exp_f32 v51, v195
    v_mfma_f32_32x32x16_bf16 v[240:255], a[220:223], v[60:63], v[240:255]
    v_cvt_pk_bf16_f32 v56, v48, v49
    v_cvt_pk_bf16_f32 v57, v50, v51
    v_exp_f32 v52, v196
    v_exp_f32 v53, v197
    v_exp_f32 v54, v198
    v_exp_f32 v55, v199
    v_cvt_pk_bf16_f32 v58, v52, v53
    v_cvt_pk_bf16_f32 v59, v54, v55
    v_exp_f32 v48, v200
    v_exp_f32 v49, v201
    v_exp_f32 v50, v202
    v_exp_f32 v51, v203
    s_waitcnt lgkmcnt(0)
    v_mfma_f32_32x32x16_bf16 v[240:255], a[224:227], v[56:59], v[240:255]
    v_cvt_pk_bf16_f32 v60, v48, v49
    v_cvt_pk_bf16_f32 v61, v50, v51
    v_exp_f32 v52, v204
    v_exp_f32 v53, v205
    v_exp_f32 v54, v206
    v_exp_f32 v55, v207
    v_cvt_pk_bf16_f32 v62, v52, v53
    v_cvt_pk_bf16_f32 v63, v54, v55
    s_nop 1
    v_mfma_f32_32x32x16_bf16 v[240:255], a[228:231], v[60:63], v[240:255]
    s_lshl_b32 s37, s100, 10
    s_mul_i32 s38, s36, 655360
    s_add_u32 s70, s37, s38
    s_mov_b32 s52, 0xfffe0000
    s_mov_b32 s90, 0
    s_mov_b32 s91, -1
    s_add_u32 s61, s53, 524288
    s_add_u32 s71, s70, 163840
    s_add_u32 s72, s70, 327680
    s_add_u32 s73, s70, 491520
    s_mov_b32 s38, 0x20000000
    v_subrev_u32 v22, 0x2f800000, v236
    v_subrev_u32 v23, 0x2f800000, v252
    v_max_u32 v22, v22, v23
    v_cmp_le_u32 vcc, s38, v22
    s_cbranch_vccnz L_truemax
L_Aok:
    v_rcp_f32 v22, v236
    s_waitcnt vmcnt(15)
    v_mul_f32 v22, v46, v22
    v_pk_mul_f32 v[224:225], v[224:225], v[22:23] op_sel_hi:[1,0]
    v_pk_mul_f32 v[226:227], v[226:227], v[22:23] op_sel_hi:[1,0]
    v_pk_mul_f32 v[228:229], v[228:229], v[22:23] op_sel_hi:[1,0]
    v_pk_mul_f32 v[230:231], v[230:231], v[22:23] op_sel_hi:[1,0]
    v_pk_mul_f32 v[232:233], v[232:233], v[22:23] op_sel_hi:[1,0]
    v_pk_mul_f32 v[234:235], v[234:235], v[22:23] op_sel_hi:[1,0]
    v_and_or_b32 v224, v224, s52, v43
    v_and_or_b32 v232, v232, s52, v43
    v_cvt_pk_bf16_f32 v224, v224, v225
    v_cvt_pk_bf16_f32 v225, v226, v227
    v_cvt_pk_bf16_f32 v226, v228, v229
    v_cvt_pk_bf16_f32 v227, v230, v231
    v_cvt_pk_bf16_f32 v228, v232, v233
    v_cvt_pk_bf16_f32 v229, v234, v235
    buffer_store_dwordx4 v[224:227], v31, s[16:19], s84 offen offset:0 sc1
    v_rcp_f32 v22, v252
    s_waitcnt vmcnt(15)
    v_mul_f32 v22, v47, v22
    v_pk_mul_f32 v[240:241], v[240:241], v[22:23] op_sel_hi:[1,0]
    v_pk_mul_f32 v[242:243], v[242:243], v[22:23] op_sel_hi:[1,0]
    v_pk_mul_f32 v[244:245], v[244:245], v[22:23] op_sel_hi:[1,0]
    v_pk_mul_f32 v[246:247], v[246:247], v[22:23] op_sel_hi:[1,0]
    v_pk_mul_f32 v[248:249], v[248:249], v[22:23] op_sel_hi:[1,0]
    v_pk_mul_f32 v[250:251], v[250:251], v[22:23] op_sel_hi:[1,0]
    v_and_or_b32 v240, v240, s52, v43
    v_and_or_b32 v248, v248, s52, v43
    v_cvt_pk_bf16_f32 v240, v240, v241
    v_cvt_pk_bf16_f32 v241, v242, v243
    v_cvt_pk_bf16_f32 v242, v244, v245
    v_cvt_pk_bf16_f32 v243, v246, v247
    v_cvt_pk_bf16_f32 v244, v248, v249
    v_cvt_pk_bf16_f32 v245, v250, v251
    v_cndmask_b32 v244, v228, v244, s[90:91]
    v_cndmask_b32 v245, v229, v245, s[90:91]
    buffer_store_dwordx4 v[240:243], v31, s[16:19], s84 offen offset:512 sc1
    buffer_store_dwordx2 v[244:245], v27, s[16:19], s53 offen sc1
    s_waitcnt vmcnt(15)
    v_mfma_f32_32x32x16_bf16 v[64:79], v[144:147], v[128:131], v[176:191]
    s_add_u32 s94, s55, 16564224
    buffer_load_dwordx4 a[168:171], v20, s[16:19], s94 offen offset:1024 sc1
    buffer_load_dwordx4 a[172:175], v20, s[16:19], s94 offen offset:2048 sc1
    v_sub_f32 v46, 1.0, v46
    v_sub_f32 v47, 1.0, v47
    s_mov_b32 s38, 0x20000000
    s_waitcnt vmcnt(14)
    v_mfma_f32_32x32x16_bf16 v[64:79], a[232:235], v[136:139], v[64:79]
    s_waitcnt vmcnt(5)
    ds_read_b64_tr_b16 a[200:201], v37 offset:0
    ds_read_b64_tr_b16 a[202:203], v37 offset:128
    ds_read_b64_tr_b16 a[204:205], v36 offset:0
    buffer_load_dwordx4 a[176:179], v20, s[16:19], s94 offen offset:3072 sc1
    s_add_u32 s94, s55, 16568320
    buffer_load_dwordx4 a[180:183], v20, s[16:19], s94 offen offset:0 sc1
    v_mfma_f32_32x32x16_bf16 v[80:95], v[148:151], v[128:131], v[160:175]
    ds_read_b64_tr_b16 a[206:207], v36 offset:128
    ds_read_b64_tr_b16 a[208:209], v36 offset:256
    ds_read_b64_tr_b16 a[210:211], v36 offset:384
    ds_read_b64_tr_b16 a[212:213], v36 offset:512
    buffer_load_dwordx4 a[184:187], v20, s[16:19], s94 offen offset:1024 sc1
    buffer_load_dwordx4 a[188:191], v20, s[16:19], s94 offen offset:2048 sc1
    buffer_load_dwordx4 a[192:195], v20, s[16:19], s94 offen offset:3072 sc1
    v_mfma_f32_32x32x16_bf16 v[80:95], a[232:235], v[138:141], v[80:95]
    ds_read_b64_tr_b16 a[214:215], v36 offset:640
    ds_read_b64_tr_b16 a[216:217], v36 offset:768
    ds_read_b64_tr_b16 a[218:219], v36 offset:896
    s_add_u32 s94, s55, 16572416
    buffer_load_dwordx4 a[196:199], v20, s[16:19], s94 offen offset:0 sc1
    v_exp_f32 v72, v72
    v_exp_f32 v73, v73
    v_mfma_f32_32x32x16_bf16 v[192:207], v[148:151], v[132:135], v[168:183]
    v_exp_f32 v74, v74
    v_exp_f32 v75, v75
    v_exp_f32 v76, v76
    v_exp_f32 v77, v77
    v_exp_f32 v78, v78
    v_mfma_f32_32x32x16_bf16 v[192:207], a[232:235], v[140:143], v[192:207]
    v_exp_f32 v79, v79
    v_cvt_pk_bf16_f32 v72, v72, v73
    v_cvt_pk_bf16_f32 v73, v74, v75
    v_cvt_pk_bf16_f32 v74, v76, v77
    v_cvt_pk_bf16_f32 v75, v78, v79
    v_exp_f32 v80, v80
    v_exp_f32 v81, v81
    s_waitcnt lgkmcnt(0)
    v_mfma_f32_32x32x16_bf16 v[96:111], a[200:203], v[72:75], 0
    v_exp_f32 v82, v82
    v_exp_f32 v83, v83
    v_exp_f32 v84, v84
    v_exp_f32 v85, v85
    v_exp_f32 v86, v86
    v_mfma_f32_32x32x16_bf16 v[208:223], v[152:155], v[132:135], v[160:175]
    v_exp_f32 v87, v87
    v_cvt_pk_bf16_f32 v80, v80, v81
    v_cvt_pk_bf16_f32 v81, v82, v83
    v_cvt_pk_bf16_f32 v82, v84, v85
    v_cvt_pk_bf16_f32 v83, v86, v87
    v_exp_f32 v88, v88
    v_exp_f32 v89, v89
    v_mfma_f32_32x32x16_bf16 v[96:111], a[204:207], v[80:83], v[96:111]
    v_exp_f32 v90, v90
    v_exp_f32 v91, v91
    v_exp_f32 v92, v92
    v_exp_f32 v93, v93
    v_exp_f32 v94, v94
    v_mfma_f32_32x32x16_bf16 v[208:223], a[236:239], v[140:143], v[208:223]
    v_exp_f32 v95, v95
    v_cvt_pk_bf16_f32 v88, v88, v89
    v_cvt_pk_bf16_f32 v89, v90, v91
    v_cvt_pk_bf16_f32 v90, v92, v93
    v_cvt_pk_bf16_f32 v91, v94, v95
    v_exp_f32 v200, v200
    v_exp_f32 v201, v201
    v_mfma_f32_32x32x16_bf16 v[96:111], a[208:211], v[88:91], v[96:111]
    v_exp_f32 v202, v202
    v_exp_f32 v203, v203
    v_exp_f32 v204, v204
    v_exp_f32 v205, v205
    v_exp_f32 v206, v206
    v_exp_f32 v207, v207
    v_cvt_pk_bf16_f32 v200, v200, v201
    v_cvt_pk_bf16_f32 v201, v202, v203
    v_cvt_pk_bf16_f32 v202, v204, v205
    v_cvt_pk_bf16_f32 v203, v206, v207
    v_exp_f32 v208, v208
    v_exp_f32 v209, v209
    v_mfma_f32_32x32x16_bf16 v[112:127], a[208:211], v[200:203], 0
    v_exp_f32 v210, v210
    v_exp_f32 v211, v211
    v_exp_f32 v212, v212
    v_exp_f32 v213, v213
    v_exp_f32 v214, v214
    v_exp_f32 v215, v215
    v_cvt_pk_bf16_f32 v208, v208, v209
    v_cvt_pk_bf16_f32 v209, v210, v211
    v_cvt_pk_bf16_f32 v210, v212, v213
    v_cvt_pk_bf16_f32 v211, v214, v215
    v_exp_f32 v216, v216
    v_exp_f32 v217, v217
    v_mfma_f32_32x32x16_bf16 v[112:127], a[212:215], v[208:211], v[112:127]
    v_exp_f32 v218, v218
    v_exp_f32 v219, v219
    v_exp_f32 v220, v220
    v_exp_f32 v221, v221
    v_exp_f32 v222, v222
    v_exp_f32 v223, v223
    v_cvt_pk_bf16_f32 v216, v216, v217
    v_cvt_pk_bf16_f32 v217, v218, v219
    v_cvt_pk_bf16_f32 v218, v220, v221
    v_cvt_pk_bf16_f32 v219, v222, v223
    v_rcp_f32 v22, v108
    v_subrev_u32 v24, 0x2f800000, v108
    v_mfma_f32_32x32x16_bf16 v[112:127], a[216:219], v[216:219], v[112:127]
    v_mul_f32 v22, v46, v22
    v_mul_f32 v96, v22, v96
    v_mul_f32 v97, v22, v97
    v_mul_f32 v98, v22, v98
    v_mul_f32 v99, v22, v99
    v_mul_f32 v100, v22, v100
    v_mul_f32 v101, v22, v101
    v_mul_f32 v102, v22, v102
    v_mul_f32 v103, v22, v103
    v_mul_f32 v104, v22, v104
    v_mul_f32 v105, v22, v105
    v_mul_f32 v106, v22, v106
    v_mul_f32 v107, v22, v107
    v_and_or_b32 v96, v96, s52, v43
    v_and_or_b32 v104, v104, s52, v43
    v_cvt_pk_bf16_f32 v96, v96, v97
    v_cvt_pk_bf16_f32 v97, v98, v99
    v_cvt_pk_bf16_f32 v98, v100, v101
    v_cvt_pk_bf16_f32 v99, v102, v103
    v_cvt_pk_bf16_f32 v100, v104, v105
    v_cvt_pk_bf16_f32 v101, v106, v107
    v_subrev_u32 v25, 0x2f800000, v124
    v_max_u32 v24, v24, v25
    v_cmp_le_u32 vcc, s38, v24
    s_cbranch_vccnz L_truemaxB
L_Bok:
    v_rcp_f32 v22, v124
    s_nop 0
    v_mul_f32 v22, v47, v22
    v_pk_mul_f32 v[112:113], v[112:113], v[22:23] op_sel_hi:[1,0]
    v_pk_mul_f32 v[114:115], v[114:115], v[22:23] op_sel_hi:[1,0]
    v_pk_mul_f32 v[116:117], v[116:117], v[22:23] op_sel_hi:[1,0]
    v_pk_mul_f32 v[118:119], v[118:119], v[22:23] op_sel_hi:[1,0]
    v_pk_mul_f32 v[120:121], v[120:121], v[22:23] op_sel_hi:[1,0]
    v_pk_mul_f32 v[122:123], v[122:123], v[22:23] op_sel_hi:[1,0]
    v_and_or_b32 v112, v112, s52, v43
    v_and_or_b32 v120, v120, s52, v43
    v_cvt_pk_bf16_f32 v112, v112, v113
    v_cvt_pk_bf16_f32 v113, v114, v115
    v_cvt_pk_bf16_f32 v114, v116, v117
    v_cvt_pk_bf16_f32 v115, v118, v119
    v_cvt_pk_bf16_f32 v116, v120, v121
    v_cvt_pk_bf16_f32 v117, v122, v123
    v_cndmask_b32 v116, v100, v116, s[90:91]
    v_cndmask_b32 v117, v101, v117, s[90:91]
    buffer_store_dwordx4 v[96:99], v31, s[16:19], s60 offen offset:0 sc1
    buffer_store_dwordx4 v[112:115], v31, s[16:19], s60 offen offset:512 sc1
    buffer_store_dwordx2 v[116:117], v27, s[16:19], s61 offen sc1
    s_mul_i32 s38, s56, 60
    v_add_u32 v13, s38, v20
    s_mul_i32 s38, s57, 60
    s_add_u32 s38, s38, 0
    v_add_u32 v10, s38, v20
    s_mul_i32 s38, s58, 60
    s_add_u32 s38, s38, 5120
    v_add_u32 v11, s38, v20
    s_mul_i32 s38, s59, 60
    s_add_u32 s38, s38, 10240
    v_add_u32 v12, s38, v20
    v_lshrrev_b32 v14, 4, v1
    v_and_b32 v15, 15, v1
    v_lshlrev_b32 v9, 15, v14
    v_lshl_add_u32 v9, v15, 3, v9
    s_lshr_b32 s37, s56, 1
    v_add_u32 v6, s37, v9
    s_lshr_b32 s37, s57, 1
    v_add_u32 v7, s37, v9
    s_lshr_b32 s37, s58, 1
    v_add_u32 v8, s37, v9
    s_lshr_b32 s37, s59, 1
    v_add_u32 v9, s37, v9
    s_lshl_b32 s37, s36, 17
    s_lshl_b32 s38, s100, 9
    s_add_u32 s37, s37, s38
    s_add_u32 s74, s37, 17367040
    s_add_u32 s75, s37, 17383424
    s_add_u32 s66, s37, 17891328
    s_add_u32 s67, s37, 17907712
    v_mul_u32_u24 v15, 176, v15
    v_mad_u32_u24 v15, v14, 40, v15
    s_lshl_b32 s37, s100, 2
    s_add_u32 s37, s37, s36
    s_mul_i32 s37, s37, 20480
    s_mul_i32 s38, s101, 160
    s_add_u32 s95, s37, s38
    s_mul_i32 s92, s36, 2816
    s_add_u32 s92, s92, 61440
    s_movk_i32 s93, 1120
    v_add_u32 v14, s92, v15
    s_add_u32 s62, s70, 7864320
    s_add_u32 s63, s70, 8028160
    s_add_u32 s64, s70, 8192000
    s_add_u32 s65, s70, 8355840
    buffer_load_dwordx4 v[224:227], v2, s[16:19], s70 offen sc1
    buffer_load_dwordx4 v[228:231], v3, s[16:19], s70 offen sc1
    buffer_load_dwordx4 v[232:235], v4, s[16:19], s70 offen sc1
    buffer_load_dwordx4 v[236:239], v5, s[16:19], s70 offen sc1
    buffer_load_dwordx4 v[128:131], v2, s[16:19], s71 offen sc1
    buffer_load_dwordx4 v[132:135], v3, s[16:19], s71 offen sc1
    buffer_load_dwordx4 v[136:139], v4, s[16:19], s71 offen sc1
    buffer_load_dwordx4 v[140:143], v5, s[16:19], s71 offen sc1
    v_mov_b32 v15, v20
    s_waitcnt vmcnt(6)
    v_bitop3_b32 v1, 1, v224, v228 bitop3:0x80
    s_waitcnt vmcnt(4)
    v_bitop3_b32 v1, v1, v232, v236 bitop3:0x80
    v_cmp_eq_u32 vcc, 0, v1
    s_cbranch_vccnz L_again_45
L_fresh_46:
    v_mfma_f32_16x16x32_bf16 v[16:19], a[0:3], v[224:227], 0
    buffer_load_dwordx4 v[144:147], v2, s[16:19], s72 offen sc1
    v_mfma_f32_16x16x32_bf16 v[20:23], a[4:7], v[224:227], 0
    v_mfma_f32_16x16x32_bf16 v[24:27], a[8:11], v[224:227], 0
    buffer_load_dwordx4 v[148:151], v3, s[16:19], s72 offen sc1
    v_mfma_f32_16x16x32_bf16 v[28:31], a[12:15], v[224:227], 0
    v_mfma_f32_16x16x32_bf16 v[32:35], a[16:19], v[224:227], 0
    buffer_load_dwordx4 v[152:155], v4, s[16:19], s72 offen sc1
    v_mfma_f32_16x16x32_bf16 v[52:55], a[16:19], v[228:231], 0
    v_mfma_f32_16x16x32_bf16 v[48:51], a[12:15], v[228:231], 0
    v_mfma_f32_16x16x32_bf16 v[44:47], a[8:11], v[228:231], 0
    buffer_load_dwordx4 v[156:159], v5, s[16:19], s72 offen sc1
    v_mfma_f32_16x16x32_bf16 v[40:43], a[4:7], v[228:231], 0
    v_mfma_f32_16x16x32_bf16 v[36:39], a[0:3], v[228:231], 0
    buffer_load_dwordx4 v[160:163], v2, s[16:19], s73 offen sc1
    v_mfma_f32_16x16x32_bf16 v[56:59], a[0:3], v[232:235], 0
    v_mfma_f32_16x16x32_bf16 v[60:63], a[4:7], v[232:235], 0
    buffer_load_dwordx4 v[164:167], v3, s[16:19], s73 offen sc1
    v_mfma_f32_16x16x32_bf16 v[64:67], a[8:11], v[232:235], 0
    v_mfma_f32_16x16x32_bf16 v[68:71], a[12:15], v[232:235], 0
    v_mfma_f32_16x16x32_bf16 v[72:75], a[16:19], v[232:235], 0
    buffer_load_dwordx4 v[168:171], v4, s[16:19], s73 offen sc1
    v_mfma_f32_16x16x32_bf16 v[92:95], a[16:19], v[236:239], 0
    v_mfma_f32_16x16x32_bf16 v[88:91], a[12:15], v[236:239], 0
    buffer_load_dwordx4 v[172:175], v5, s[16:19], s73 offen sc1
    s_waitcnt vmcnt(10)
    v_bitop3_b32 v1, 1, v128, v132 bitop3:0x80
    v_mfma_f32_16x16x32_bf16 v[84:87], a[8:11], v[236:239], 0
    s_waitcnt vmcnt(8)
    v_bitop3_b32 v1, v1, v136, v140 bitop3:0x80
    v_mfma_f32_16x16x32_bf16 v[80:83], a[4:7], v[236:239], 0
    v_cmp_eq_u32 vcc, 0, v1
    s_cbranch_vccnz L_again_47
L_fresh_48:
    v_mfma_f32_16x16x32_bf16 v[76:79], a[0:3], v[236:239], 0
    buffer_load_dwordx2 v[176:177], v6, s[16:19], s74 offen sc1
    v_mfma_f32_16x16x32_bf16 v[16:19], a[20:23], v[128:131], v[16:19]
    v_mfma_f32_16x16x32_bf16 v[20:23], a[24:27], v[128:131], v[20:23]
    buffer_load_dwordx2 v[178:179], v6, s[16:19], s75 offen sc1
    v_mfma_f32_16x16x32_bf16 v[24:27], a[28:31], v[128:131], v[24:27]
    v_mfma_f32_16x16x32_bf16 v[28:31], a[32:35], v[128:131], v[28:31]
    buffer_load_dwordx2 v[180:181], v7, s[16:19], s74 offen sc1
    v_mfma_f32_16x16x32_bf16 v[32:35], a[36:39], v[128:131], v[32:35]
    v_mfma_f32_16x16x32_bf16 v[52:55], a[36:39], v[132:135], v[52:55]
    v_mfma_f32_16x16x32_bf16 v[48:51], a[32:35], v[132:135], v[48:51]
    buffer_load_dwordx2 v[182:183], v7, s[16:19], s75 offen sc1
    v_mfma_f32_16x16x32_bf16 v[44:47], a[28:31], v[132:135], v[44:47]
    v_mfma_f32_16x16x32_bf16 v[40:43], a[24:27], v[132:135], v[40:43]
    buffer_load_dwordx2 v[184:185], v8, s[16:19], s74 offen sc1
    v_mfma_f32_16x16x32_bf16 v[36:39], a[20:23], v[132:135], v[36:39]
    v_mfma_f32_16x16x32_bf16 v[56:59], a[20:23], v[136:139], v[56:59]
    buffer_load_dwordx2 v[186:187], v8, s[16:19], s75 offen sc1
    v_mfma_f32_16x16x32_bf16 v[60:63], a[24:27], v[136:139], v[60:63]
    v_mfma_f32_16x16x32_bf16 v[64:67], a[28:31], v[136:139], v[64:67]
    v_mfma_f32_16x16x32_bf16 v[68:71], a[32:35], v[136:139], v[68:71]
    buffer_load_dwordx2 v[188:189], v9, s[16:19], s74 offen sc1
    v_mfma_f32_16x16x32_bf16 v[72:75], a[36:39], v[136:139], v[72:75]
    v_mfma_f32_16x16x32_bf16 v[92:95], a[36:39], v[140:143], v[92:95]
    buffer_load_dwordx2 v[190:191], v9, s[16:19], s75 offen sc1
    v_mfma_f32_16x16x32_bf16 v[88:91], a[32:35], v[140:143], v[88:91]
    s_waitcnt vmcnt(14)
    v_bitop3_b32 v1, 1, v144, v148 bitop3:0x80
    v_mfma_f32_16x16x32_bf16 v[84:87], a[28:31], v[140:143], v[84:87]
    s_waitcnt vmcnt(12)
    v_bitop3_b32 v1, v1, v152, v156 bitop3:0x80
    v_mfma_f32_16x16x32_bf16 v[80:83], a[24:27], v[140:143], v[80:83]
    v_cmp_eq_u32 vcc, 0, v1
    s_cbranch_vccnz L_again_49
L_fresh_50:
    v_mfma_f32_16x16x32_bf16 v[76:79], a[20:23], v[140:143], v[76:79]
    v_mfma_f32_16x16x32_bf16 v[16:19], a[40:43], v[144:147], v[16:19]
    v_mfma_f32_16x16x32_bf16 v[20:23], a[44:47], v[144:147], v[20:23]
    v_mfma_f32_16x16x32_bf16 v[24:27], a[48:51], v[144:147], v[24:27]
    buffer_load_dwordx4 v[100:103], v3, s[16:19], s62 offen sc1
    v_mfma_f32_16x16x32_bf16 v[28:31], a[52:55], v[144:147], v[28:31]
    v_mfma_f32_16x16x32_bf16 v[32:35], a[56:59], v[144:147], v[32:35]
    v_mfma_f32_16x16x32_bf16 v[52:55], a[56:59], v[148:151], v[52:55]
    v_mfma_f32_16x16x32_bf16 v[48:51], a[52:55], v[148:151], v[48:51]
    buffer_load_dwordx4 v[116:119], v3, s[16:19], s63 offen sc1
    v_mfma_f32_16x16x32_bf16 v[44:47], a[48:51], v[148:151], v[44:47]
    v_mfma_f32_16x16x32_bf16 v[40:43], a[44:47], v[148:151], v[40:43]
    v_mfma_f32_16x16x32_bf16 v[36:39], a[40:43], v[148:151], v[36:39]
    v_mfma_f32_16x16x32_bf16 v[56:59], a[40:43], v[152:155], v[56:59]
    buffer_load_dwordx4 v[196:199], v3, s[16:19], s64 offen sc1
    v_mfma_f32_16x16x32_bf16 v[60:63], a[44:47], v[152:155], v[60:63]
    v_mfma_f32_16x16x32_bf16 v[64:67], a[48:51], v[152:155], v[64:67]
    v_mfma_f32_16x16x32_bf16 v[68:71], a[52:55], v[152:155], v[68:71]
    v_mfma_f32_16x16x32_bf16 v[72:75], a[56:59], v[152:155], v[72:75]
    buffer_load_dwordx4 v[212:215], v3, s[16:19], s65 offen sc1
    v_mfma_f32_16x16x32_bf16 v[92:95], a[56:59], v[156:159], v[92:95]
    v_mfma_f32_16x16x32_bf16 v[88:91], a[52:55], v[156:159], v[88:91]
    s_waitcnt vmcnt(14)
    v_bitop3_b32 v1, 1, v160, v164 bitop3:0x80
    v_mfma_f32_16x16x32_bf16 v[84:87], a[48:51], v[156:159], v[84:87]
    s_waitcnt vmcnt(12)
    v_bitop3_b32 v1, v1, v168, v172 bitop3:0x80
    v_mfma_f32_16x16x32_bf16 v[80:83], a[44:47], v[156:159], v[80:83]
    buffer_load_dwordx2 v[244:245], v7, s[16:19], s66 offen sc1
    v_cmp_eq_u32 vcc, 0, v1
    s_cbranch_vccnz L_again_51
L_fresh_52:
    v_mfma_f32_16x16x32_bf16 v[76:79], a[40:43], v[156:159], v[76:79]
    v_mfma_f32_16x16x32_bf16 v[16:19], a[60:63], v[160:163], v[16:19]
    v_mfma_f32_16x16x32_bf16 v[20:23], a[64:67], v[160:163], v[20:23]
    v_mfma_f32_16x16x32_bf16 v[24:27], a[68:71], v[160:163], v[24:27]
    buffer_load_dwordx2 v[246:247], v7, s[16:19], s67 offen sc1
    v_mfma_f32_16x16x32_bf16 v[28:31], a[72:75], v[160:163], v[28:31]
    v_mfma_f32_16x16x32_bf16 v[32:35], a[76:79], v[160:163], v[32:35]
    v_mfma_f32_16x16x32_bf16 v[52:55], a[76:79], v[164:167], v[52:55]
    v_mfma_f32_16x16x32_bf16 v[48:51], a[72:75], v[164:167], v[48:51]
    buffer_load_dwordx4 v[104:107], v4, s[16:19], s62 offen sc1
    v_mfma_f32_16x16x32_bf16 v[44:47], a[68:71], v[164:167], v[44:47]
    v_mfma_f32_16x16x32_bf16 v[40:43], a[64:67], v[164:167], v[40:43]
    v_mfma_f32_16x16x32_bf16 v[36:39], a[60:63], v[164:167], v[36:39]
    v_mfma_f32_16x16x32_bf16 v[56:59], a[60:63], v[168:171], v[56:59]
    buffer_load_dwordx4 v[120:123], v4, s[16:19], s63 offen sc1
    v_mfma_f32_16x16x32_bf16 v[60:63], a[64:67], v[168:171], v[60:63]
    v_mfma_f32_16x16x32_bf16 v[64:67], a[68:71], v[168:171], v[64:67]
    v_mfma_f32_16x16x32_bf16 v[68:71], a[72:75], v[168:171], v[68:71]
    v_mfma_f32_16x16x32_bf16 v[72:75], a[76:79], v[168:171], v[72:75]
    buffer_load_dwordx4 v[200:203], v4, s[16:19], s64 offen sc1
    v_mfma_f32_16x16x32_bf16 v[92:95], a[76:79], v[172:175], v[92:95]
    v_mfma_f32_16x16x32_bf16 v[88:91], a[72:75], v[172:175], v[88:91]
    s_waitcnt vmcnt(15)
    v_bitop3_b32 v1, 1, v176, v178 bitop3:0x80
    s_waitcnt vmcnt(13)
    v_bitop3_b32 v1, v1, v180, v182 bitop3:0x80
    v_mfma_f32_16x16x32_bf16 v[84:87], a[68:71], v[172:175], v[84:87]
    s_waitcnt vmcnt(11)
    v_bitop3_b32 v1, v1, v184, v186 bitop3:0x80
    v_mfma_f32_16x16x32_bf16 v[80:83], a[64:67], v[172:175], v[80:83]
    buffer_load_dwordx4 v[216:219], v4, s[16:19], s65 offen sc1
    s_waitcnt vmcnt(10)
    v_bitop3_b32 v1, v1, v188, v190 bitop3:0x80
    v_mfma_f32_16x16x32_bf16 v[76:79], a[60:63], v[172:175], v[76:79]
    v_cmp_eq_u32 vcc, 0, v1
    s_cbranch_vccnz L_again_53
L_fresh_54:
    v_mfma_f32_16x16x32_bf16 v[16:19], a[80:83], v[176:179], v[16:19]
    v_mfma_f32_16x16x32_bf16 v[20:23], a[84:87], v[176:179], v[20:23]
    v_mfma_f32_16x16x32_bf16 v[24:27], a[88:91], v[176:179], v[24:27]
    buffer_load_dwordx2 v[248:249], v8, s[16:19], s66 offen sc1
    v_mfma_f32_16x16x32_bf16 v[28:31], a[92:95], v[176:179], v[28:31]
    v_mfma_f32_16x16x32_bf16 v[32:35], a[96:99], v[176:179], v[32:35]
    v_mfma_f32_16x16x32_bf16 v[52:55], a[96:99], v[180:183], v[52:55]
    v_mfma_f32_16x16x32_bf16 v[48:51], a[92:95], v[180:183], v[48:51]
    buffer_load_dwordx2 v[250:251], v8, s[16:19], s67 offen sc1
    v_mfma_f32_16x16x32_bf16 v[44:47], a[88:91], v[180:183], v[44:47]
    v_mfma_f32_16x16x32_bf16 v[40:43], a[84:87], v[180:183], v[40:43]
    v_mfma_f32_16x16x32_bf16 v[36:39], a[80:83], v[180:183], v[36:39]
    v_mfma_f32_16x16x32_bf16 v[56:59], a[80:83], v[184:187], v[56:59]
    v_mfma_f32_16x16x32_bf16 v[60:63], a[84:87], v[184:187], v[60:63]
    buffer_load_dwordx4 v[108:111], v5, s[16:19], s62 offen sc1
    v_mfma_f32_16x16x32_bf16 v[64:67], a[88:91], v[184:187], v[64:67]
    v_mfma_f32_16x16x32_bf16 v[68:71], a[92:95], v[184:187], v[68:71]
    v_mfma_f32_16x16x32_bf16 v[72:75], a[96:99], v[184:187], v[72:75]
    v_mfma_f32_16x16x32_bf16 v[92:95], a[96:99], v[188:191], v[92:95]
    buffer_load_dwordx4 v[124:127], v5, s[16:19], s63 offen sc1
    v_mfma_f32_16x16x32_bf16 v[88:91], a[92:95], v[188:191], v[88:91]
    s_waitcnt vmcnt(12)
    v_bitop3_b32 v1, 1, v100, v116 bitop3:0x80
    v_mfma_f32_16x16x32_bf16 v[84:87], a[88:91], v[188:191], v[84:87]
    s_waitcnt vmcnt(10)
    v_bitop3_b32 v1, v1, v196, v212 bitop3:0x80
    v_mfma_f32_16x16x32_bf16 v[80:83], a[84:87], v[188:191], v[80:83]
    s_waitcnt vmcnt(8)
    v_bitop3_b32 v1, v1, v244, v246 bitop3:0x80
    v_mfma_f32_16x16x32_bf16 v[76:79], a[80:83], v[188:191], v[76:79]
    buffer_load_dwordx4 v[204:207], v5, s[16:19], s64 offen sc1
    v_cmp_eq_u32 vcc, 0, v1
    s_cbranch_vccnz L_again_55
L_fresh_56:
    v_mfma_f32_16x16x32_bf16 v[36:39], a[100:103], v[100:103], v[36:39]
    v_mfma_f32_16x16x32_bf16 v[40:43], a[104:107], v[100:103], v[40:43]
    v_mfma_f32_16x16x32_bf16 v[44:47], a[108:111], v[100:103], v[44:47]
    v_mfma_f32_16x16x32_bf16 v[48:51], a[112:115], v[100:103], v[48:51]
    buffer_load_dwordx4 v[220:223], v5, s[16:19], s65 offen sc1
    v_mfma_f32_16x16x32_bf16 v[52:55], a[116:119], v[100:103], v[52:55]
    v_mfma_f32_16x16x32_bf16 v[36:39], a[120:123], v[116:119], v[36:39]
    v_mfma_f32_16x16x32_bf16 v[40:43], a[124:127], v[116:119], v[40:43]
    v_mfma_f32_16x16x32_bf16 v[44:47], a[128:131], v[116:119], v[44:47]
    buffer_load_dwordx2 v[252:253], v9, s[16:19], s66 offen sc1
    v_mfma_f32_16x16x32_bf16 v[48:51], a[132:135], v[116:119], v[48:51]
    v_mfma_f32_16x16x32_bf16 v[52:55], a[136:139], v[116:119], v[52:55]
    v_mfma_f32_16x16x32_bf16 v[36:39], a[140:143], v[196:199], v[36:39]
    v_mfma_f32_16x16x32_bf16 v[40:43], a[144:147], v[196:199], v[40:43]
    buffer_load_dwordx2 v[254:255], v9, s[16:19], s67 offen sc1
    v_mfma_f32_16x16x32_bf16 v[44:47], a[148:151], v[196:199], v[44:47]
    v_mfma_f32_16x16x32_bf16 v[48:51], a[152:155], v[196:199], v[48:51]
    v_mfma_f32_16x16x32_bf16 v[52:55], a[156:159], v[196:199], v[52:55]
    v_mfma_f32_16x16x32_bf16 v[36:39], a[160:163], v[212:215], v[36:39]
    buffer_load_dwordx4 v[96:99], v2, s[16:19], s62 offen sc1
    v_mfma_f32_16x16x32_bf16 v[40:43], a[164:167], v[212:215], v[40:43]
    v_mfma_f32_16x16x32_bf16 v[44:47], a[168:171], v[212:215], v[44:47]
    v_mfma_f32_16x16x32_bf16 v[48:51], a[172:175], v[212:215], v[48:51]
    v_mfma_f32_16x16x32_bf16 v[52:55], a[176:179], v[212:215], v[52:55]
    buffer_load_dwordx4 v[112:115], v2, s[16:19], s63 offen sc1
    v_mfma_f32_16x16x32_bf16 v[36:39], a[180:183], v[244:247], v[36:39]
    v_mfma_f32_16x16x32_bf16 v[40:43], a[184:187], v[244:247], v[40:43]
    s_waitcnt vmcnt(12)
    v_bitop3_b32 v1, 1, v104, v120 bitop3:0x80
    v_mfma_f32_16x16x32_bf16 v[44:47], a[188:191], v[244:247], v[44:47]
    s_waitcnt vmcnt(10)
    v_bitop3_b32 v1, v1, v200, v216 bitop3:0x80
    v_mfma_f32_16x16x32_bf16 v[48:51], a[192:195], v[244:247], v[48:51]
    buffer_load_dwordx4 v[192:195], v2, s[16:19], s64 offen sc1
    s_waitcnt vmcnt(9)
    v_bitop3_b32 v1, v1, v248, v250 bitop3:0x80
    v_mfma_f32_16x16x32_bf16 v[52:55], a[196:199], v[244:247], v[52:55]
    v_cmp_eq_u32 vcc, 0, v1
    s_cbranch_vccnz L_again_57
L_fresh_58:
    v_mfma_f32_16x16x32_bf16 v[56:59], a[100:103], v[104:107], v[56:59]
    v_mfma_f32_16x16x32_bf16 v[60:63], a[104:107], v[104:107], v[60:63]
    v_mfma_f32_16x16x32_bf16 v[64:67], a[108:111], v[104:107], v[64:67]
    buffer_load_dwordx4 v[208:211], v2, s[16:19], s65 offen sc1
    v_mfma_f32_16x16x32_bf16 v[68:71], a[112:115], v[104:107], v[68:71]
    ds_write_b128 v10, v[36:39] offset:0
    v_mfma_f32_16x16x32_bf16 v[72:75], a[116:119], v[104:107], v[72:75]
    v_mfma_f32_16x16x32_bf16 v[56:59], a[120:123], v[120:123], v[56:59]
    v_mfma_f32_16x16x32_bf16 v[60:63], a[124:127], v[120:123], v[60:63]
    buffer_load_dwordx2 v[240:241], v6, s[16:19], s66 offen sc1
    ds_write_b128 v10, v[40:43] offset:1024
    v_mfma_f32_16x16x32_bf16 v[64:67], a[128:131], v[120:123], v[64:67]
    v_mfma_f32_16x16x32_bf16 v[68:71], a[132:135], v[120:123], v[68:71]
    v_mfma_f32_16x16x32_bf16 v[72:75], a[136:139], v[120:123], v[72:75]
    ds_write_b128 v10, v[44:47] offset:2048
    v_mfma_f32_16x16x32_bf16 v[56:59], a[140:143], v[200:203], v[56:59]
    buffer_load_dwordx2 v[242:243], v6, s[16:19], s67 offen sc1
    v_mfma_f32_16x16x32_bf16 v[60:63], a[144:147], v[200:203], v[60:63]
    v_mfma_f32_16x16x32_bf16 v[64:67], a[148:151], v[200:203], v[64:67]
    ds_write_b128 v10, v[48:51] offset:3072
    v_mfma_f32_16x16x32_bf16 v[68:71], a[152:155], v[200:203], v[68:71]
    v_mfma_f32_16x16x32_bf16 v[72:75], a[156:159], v[200:203], v[72:75]
    v_mfma_f32_16x16x32_bf16 v[56:59], a[160:163], v[216:219], v[56:59]
    ds_write_b128 v10, v[52:55] offset:4096
    v_mfma_f32_16x16x32_bf16 v[60:63], a[164:167], v[216:219], v[60:63]
    v_mfma_f32_16x16x32_bf16 v[64:67], a[168:171], v[216:219], v[64:67]
    v_mfma_f32_16x16x32_bf16 v[68:71], a[172:175], v[216:219], v[68:71]
    v_mfma_f32_16x16x32_bf16 v[72:75], a[176:179], v[216:219], v[72:75]
    v_mfma_f32_16x16x32_bf16 v[56:59], a[180:183], v[248:251], v[56:59]
    v_mfma_f32_16x16x32_bf16 v[60:63], a[184:187], v[248:251], v[60:63]
    s_waitcnt vmcnt(10)
    v_bitop3_b32 v1, 1, v108, v124 bitop3:0x80
    v_mfma_f32_16x16x32_bf16 v[64:67], a[188:191], v[248:251], v[64:67]
    s_waitcnt vmcnt(8)
    v_bitop3_b32 v1, v1, v204, v220 bitop3:0x80
    v_mfma_f32_16x16x32_bf16 v[68:71], a[192:195], v[248:251], v[68:71]
    s_waitcnt vmcnt(6)
    v_bitop3_b32 v1, v1, v252, v254 bitop3:0x80
    v_mfma_f32_16x16x32_bf16 v[72:75], a[196:199], v[248:251], v[72:75]
    v_cmp_eq_u32 vcc, 0, v1
    s_cbranch_vccnz L_again_59
L_fresh_60:
    v_mfma_f32_16x16x32_bf16 v[76:79], a[100:103], v[108:111], v[76:79]
    v_mfma_f32_16x16x32_bf16 v[80:83], a[104:107], v[108:111], v[80:83]
    v_mul_u32_u24 v7, 6554, v15
    v_lshrrev_b32 v7, 20, v7
    v_mfma_f32_16x16x32_bf16 v[84:87], a[108:111], v[108:111], v[84:87]
    v_mad_u32_u24 v3, v7, s93, v15
    v_mfma_f32_16x16x32_bf16 v[88:91], a[112:115], v[108:111], v[88:91]
    ds_write_b128 v11, v[56:59] offset:0
    v_lshl_add_u32 v5, v7, 4, v15
    v_mfma_f32_16x16x32_bf16 v[92:95], a[116:119], v[108:111], v[92:95]
    v_add_u32 v5, s92, v5
    v_mfma_f32_16x16x32_bf16 v[76:79], a[120:123], v[124:127], v[76:79]
    v_add_u32 v4, 1024, v15
    v_mfma_f32_16x16x32_bf16 v[80:83], a[124:127], v[124:127], v[80:83]
    ds_write_b128 v11, v[60:63] offset:1024
    v_mul_u32_u24 v8, 6554, v4
    v_mfma_f32_16x16x32_bf16 v[84:87], a[128:131], v[124:127], v[84:87]
    v_lshrrev_b32 v8, 20, v8
    v_mfma_f32_16x16x32_bf16 v[88:91], a[132:135], v[124:127], v[88:91]
    v_mad_u32_u24 v4, v8, s93, v4
    v_mfma_f32_16x16x32_bf16 v[92:95], a[136:139], v[124:127], v[92:95]
    ds_write_b128 v11, v[64:67] offset:2048
    v_lshl_add_u32 v9, v8, 4, v15
    v_mfma_f32_16x16x32_bf16 v[76:79], a[140:143], v[204:207], v[76:79]
    v_add_u32 v9, s92, v9
    v_mfma_f32_16x16x32_bf16 v[80:83], a[144:147], v[204:207], v[80:83]
    v_add_u32 v7, 2048, v15
    v_mfma_f32_16x16x32_bf16 v[84:87], a[148:151], v[204:207], v[84:87]
    ds_write_b128 v11, v[68:71] offset:3072
    v_mul_u32_u24 v8, 6554, v7
    v_mfma_f32_16x16x32_bf16 v[88:91], a[152:155], v[204:207], v[88:91]
    v_lshrrev_b32 v8, 20, v8
    v_mfma_f32_16x16x32_bf16 v[92:95], a[156:159], v[204:207], v[92:95]
    v_mad_u32_u24 v7, v8, s93, v7
    v_mfma_f32_16x16x32_bf16 v[76:79], a[160:163], v[220:223], v[76:79]
    ds_write_b128 v11, v[72:75] offset:4096
    v_lshl_add_u32 v10, v8, 4, v15
    v_mfma_f32_16x16x32_bf16 v[80:83], a[164:167], v[220:223], v[80:83]
    v_add_u32 v10, s92, v10
    v_mfma_f32_16x16x32_bf16 v[84:87], a[168:171], v[220:223], v[84:87]
    v_cmp_gt_u32 vcc, 16, v8
    v_add_u32 v15, s92, v15
    s_nop 0
    v_cndmask_b32 v7, 1073741824, v7, vcc
    v_mfma_f32_16x16x32_bf16 v[88:91], a[172:175], v[220:223], v[88:91]
    v_mfma_f32_16x16x32_bf16 v[92:95], a[176:179], v[220:223], v[92:95]
    v_mfma_f32_16x16x32_bf16 v[76:79], a[180:183], v[252:255], v[76:79]
    v_mfma_f32_16x16x32_bf16 v[80:83], a[184:187], v[252:255], v[80:83]
    s_waitcnt vmcnt(4)
    v_bitop3_b32 v1, 1, v96, v112 bitop3:0x80
    v_mfma_f32_16x16x32_bf16 v[84:87], a[188:191], v[252:255], v[84:87]
    s_waitcnt vmcnt(2)
    v_bitop3_b32 v1, v1, v192, v208 bitop3:0x80
    v_mfma_f32_16x16x32_bf16 v[88:91], a[192:195], v[252:255], v[88:91]
    s_waitcnt vmcnt(0)
    v_bitop3_b32 v1, v1, v240, v242 bitop3:0x80
    v_mfma_f32_16x16x32_bf16 v[92:95], a[196:199], v[252:255], v[92:95]
    v_cmp_eq_u32 vcc, 0, v1
    s_cbranch_vccnz L_again_61
L_fresh_62:
    v_mfma_f32_16x16x32_bf16 v[16:19], a[100:103], v[96:99], v[16:19]
    v_mfma_f32_16x16x32_bf16 v[20:23], a[104:107], v[96:99], v[20:23]
    v_mfma_f32_16x16x32_bf16 v[24:27], a[108:111], v[96:99], v[24:27]
    v_mfma_f32_16x16x32_bf16 v[28:31], a[112:115], v[96:99], v[28:31]
    ds_write_b128 v12, v[76:79] offset:0
    v_mfma_f32_16x16x32_bf16 v[32:35], a[116:119], v[96:99], v[32:35]
    ds_write_b128 v12, v[80:83] offset:1024
    v_mfma_f32_16x16x32_bf16 v[16:19], a[120:123], v[112:115], v[16:19]
    ds_write_b128 v12, v[84:87] offset:2048
    v_mfma_f32_16x16x32_bf16 v[20:23], a[124:127], v[112:115], v[20:23]
    ds_write_b128 v12, v[88:91] offset:3072
    v_mfma_f32_16x16x32_bf16 v[24:27], a[128:131], v[112:115], v[24:27]
    ds_write_b128 v12, v[92:95] offset:4096
    v_mfma_f32_16x16x32_bf16 v[28:31], a[132:135], v[112:115], v[28:31]
    v_mfma_f32_16x16x32_bf16 v[32:35], a[136:139], v[112:115], v[32:35]
    v_mfma_f32_16x16x32_bf16 v[16:19], a[140:143], v[192:195], v[16:19]
    v_mfma_f32_16x16x32_bf16 v[20:23], a[144:147], v[192:195], v[20:23]
    v_mfma_f32_16x16x32_bf16 v[24:27], a[148:151], v[192:195], v[24:27]
    s_waitcnt lgkmcnt(0)
    s_barrier
    v_mfma_f32_16x16x32_bf16 v[28:31], a[152:155], v[192:195], v[28:31]
    ds_read_b128 v[228:231], v13 offset:0
    ds_read_b128 v[232:235], v13 offset:5120
    v_mfma_f32_16x16x32_bf16 v[32:35], a[156:159], v[192:195], v[32:35]
    ds_read_b128 v[236:239], v13 offset:10240
    v_mfma_f32_16x16x32_bf16 v[16:19], a[160:163], v[208:211], v[16:19]
    ds_read_b128 v[132:135], v13 offset:1024
    ds_read_b128 v[136:139], v13 offset:6144
    v_mfma_f32_16x16x32_bf16 v[20:23], a[164:167], v[208:211], v[20:23]
    ds_read_b128 v[140:143], v13 offset:11264
    v_mfma_f32_16x16x32_bf16 v[24:27], a[168:171], v[208:211], v[24:27]
    ds_read_b128 v[148:151], v13 offset:2048
    ds_read_b128 v[152:155], v13 offset:7168
    v_mfma_f32_16x16x32_bf16 v[28:31], a[172:175], v[208:211], v[28:31]
    ds_read_b128 v[156:159], v13 offset:12288
    v_mfma_f32_16x16x32_bf16 v[32:35], a[176:179], v[208:211], v[32:35]
    ds_read_b128 v[164:167], v13 offset:3072
    ds_read_b128 v[168:171], v13 offset:8192
    v_mfma_f32_16x16x32_bf16 v[16:19], a[180:183], v[240:243], v[16:19]
    ds_read_b128 v[172:175], v13 offset:13312
    v_mfma_f32_16x16x32_bf16 v[20:23], a[184:187], v[240:243], v[20:23]
    ds_read_b128 v[180:183], v13 offset:4096
    ds_read_b128 v[184:187], v13 offset:9216
    s_waitcnt lgkmcnt(12)
    v_add_f32 v228, v228, v232
    v_add_f32 v229, v229, v233
    v_mfma_f32_16x16x32_bf16 v[24:27], a[188:191], v[240:243], v[24:27]
    ds_read_b128 v[188:191], v13 offset:14336
    v_add_f32 v230, v230, v234
    v_add_f32 v231, v231, v235
    v_mfma_f32_16x16x32_bf16 v[28:31], a[192:195], v[240:243], v[28:31]
    s_waitcnt lgkmcnt(12)
    v_add_f32 v228, v228, v236
    v_add_f32 v229, v229, v237
    v_mfma_f32_16x16x32_bf16 v[32:35], a[196:199], v[240:243], v[32:35]
    v_add_f32 v230, v230, v238
    v_add_f32 v231, v231, v239
    s_waitcnt lgkmcnt(10)
    v_pk_add_f32 v[132:133], v[132:133], v[136:137]
    v_pk_add_f32 v[134:135], v[134:135], v[138:139]
    s_waitcnt lgkmcnt(9)
    v_pk_add_f32 v[132:133], v[132:133], v[140:141]
    v_pk_add_f32 v[134:135], v[134:135], v[142:143]
    s_waitcnt lgkmcnt(7)
    v_pk_add_f32 v[148:149], v[148:149], v[152:153]
    v_pk_add_f32 v[150:151], v[150:151], v[154:155]
    s_waitcnt lgkmcnt(6)
    v_pk_add_f32 v[148:149], v[148:149], v[156:157]
    v_pk_add_f32 v[150:151], v[150:151], v[158:159]
    s_waitcnt lgkmcnt(4)
    v_pk_add_f32 v[164:165], v[164:165], v[168:169]
    v_pk_add_f32 v[166:167], v[166:167], v[170:171]
    s_waitcnt lgkmcnt(3)
    v_pk_add_f32 v[164:165], v[164:165], v[172:173]
    v_pk_add_f32 v[166:167], v[166:167], v[174:175]
    s_waitcnt lgkmcnt(1)
    v_pk_add_f32 v[180:181], v[180:181], v[184:185]
    v_pk_add_f32 v[182:183], v[182:183], v[186:187]
    s_waitcnt lgkmcnt(0)
    v_pk_add_f32 v[180:181], v[180:181], v[188:189]
    v_pk_add_f32 v[182:183], v[182:183], v[190:191]
    v_pk_add_f32 v[16:17], v[16:17], v[228:229]
    v_pk_add_f32 v[18:19], v[18:19], v[230:231]
    v_pk_add_f32 v[20:21], v[20:21], v[132:133]
    v_pk_add_f32 v[22:23], v[22:23], v[134:135]
    v_pk_add_f32 v[24:25], v[24:25], v[148:149]
    v_pk_add_f32 v[26:27], v[26:27], v[150:151]
    v_pk_add_f32 v[28:29], v[28:29], v[164:165]
    v_pk_add_f32 v[30:31], v[30:31], v[166:167]
    v_pk_add_f32 v[32:33], v[32:33], v[180:181]
    v_pk_add_f32 v[34:35], v[34:35], v[182:183]
    v_cvt_pk_bf16_f32 v16, v16, v17
    v_cvt_pk_bf16_f32 v17, v18, v19
    v_cvt_pk_bf16_f32 v18, v20, v21
    v_cvt_pk_bf16_f32 v19, v22, v23
    v_cvt_pk_bf16_f32 v20, v24, v25
    v_cvt_pk_bf16_f32 v21, v26, v27
    v_cvt_pk_bf16_f32 v22, v28, v29
    v_cvt_pk_bf16_f32 v23, v30, v31
    v_cvt_pk_bf16_f32 v24, v32, v33
    v_cvt_pk_bf16_f32 v25, v34, v35
    ds_write_b64 v14, v[16:17] offset:0
    ds_write_b64 v14, v[18:19] offset:8
    ds_write_b64 v14, v[20:21] offset:16
    ds_write_b64 v14, v[22:23] offset:24
    ds_write_b64 v14, v[24:25] offset:32
    ds_read_b128 v[40:43], v5 offset:0
    ds_read_b128 v[44:47], v9 offset:1024
    ds_read_b128 v[48:51], v10 offset:2048
    s_waitcnt lgkmcnt(2)
    buffer_store_dwordx4 v[40:43], v3, s[20:23], s95 offen
    s_waitcnt lgkmcnt(1)
    buffer_store_dwordx4 v[44:47], v4, s[20:23], s95 offen
    s_waitcnt lgkmcnt(0)
    buffer_store_dwordx4 v[48:51], v7, s[20:23], s95 offen
    s_endpgm
L_spare:
    s_waitcnt lgkmcnt(0)
    s_load_dwordx2 s[56:57], s[0:1], 16
    s_load_dwordx2 s[58:59], s[0:1], 40
    s_load_dwordx2 s[8:9], s[0:1], 48
    s_mov_b32 s30, 819200
    s_mov_b32 s10, 1280
    s_load_dwordx2 s[12:13], s[0:1], 32
    s_load_dwordx2 s[16:17], s[0:1], 72
    s_load_dwordx2 s[20:21], s[0:1], 56
    s_load_dwordx2 s[24:25], s[0:1], 64
    s_mov_b32 s11, 0x20000
    s_mov_b32 s35, 15
    s_mov_b32 s18, 18489344
    s_mov_b32 s19, 0x20000
    s_mov_b32 s26, 256
    s_mov_b32 s27, 0x20000
    s_mov_b32 s31, 0x20000
    v_or_b32 v17, s36, v1
    v_cmp_eq_u32 vcc, 0, v17
    v_mov_b32 v21, 1073741824
    v_mov_b32 v18, 1
    v_lshlrev_b32 v20, 4, v1
    v_cndmask_b32 v17, v21, 0, vcc
    v_mov_b32 v64, 0
    v_mov_b32 v65, 0
    v_mov_b32 v66, 0
    v_mov_b32 v67, 0
    v_lshlrev_b32 v22, 4, v0
    s_lshl_b32 s39, s34, 12
    s_add_u32 s39, s39, 18423808
    s_waitcnt lgkmcnt(0)
    buffer_store_dwordx4 v[64:67], v22, s[16:19], s39 offen sc1
    s_and_b32 s92, s34, 1
    s_lshl_b32 s92, s92, 2
    s_add_u32 s92, s92, s36
    s_bfe_u32 s93, s34, 0x20001
    s_mul_i32 s39, s92, 160
    s_mul_i32 s38, s93, 204800
    s_add_u32 s39, s39, s38
    s_mov_b32 s37, 429496730
    v_add_u32 v22, 0, v1
    v_mul_hi_u32 v23, v22, s37
    v_mul_u32_u24 v24, 10, v23
    v_sub_u32 v22, v22, v24
    v_mul_u32_u24 v23, 1280, v23
    v_lshl_add_u32 v23, v22, 4, v23
    v_add_u32 v2, s39, v23
    v_add_u32 v22, 64, v1
    v_mul_hi_u32 v23, v22, s37
    v_mul_u32_u24 v24, 10, v23
    v_sub_u32 v22, v22, v24
    v_mul_u32_u24 v23, 1280, v23
    v_lshl_add_u32 v23, v22, 4, v23
    v_add_u32 v3, s39, v23
    v_add_u32 v22, 128, v1
    v_mul_hi_u32 v23, v22, s37
    v_mul_u32_u24 v24, 10, v23
    v_sub_u32 v22, v22, v24
    v_mul_u32_u24 v23, 1280, v23
    v_lshl_add_u32 v23, v22, 4, v23
    v_add_u32 v4, s39, v23
    v_add_u32 v22, 192, v1
    v_mul_hi_u32 v23, v22, s37
    v_mul_u32_u24 v24, 10, v23
    v_sub_u32 v22, v22, v24
    v_mul_u32_u24 v23, 1280, v23
    v_lshl_add_u32 v23, v22, 4, v23
    v_add_u32 v5, s39, v23
    v_add_u32 v22, 256, v1
    v_mul_hi_u32 v23, v22, s37
    v_mul_u32_u24 v24, 10, v23
    v_sub_u32 v22, v22, v24
    v_mul_u32_u24 v23, 1280, v23
    v_lshl_add_u32 v23, v22, 4, v23
    v_add_u32 v6, s39, v23
    s_mul_i32 s44, s36, 25600
    s_waitcnt lgkmcnt(0)
    s_cmp_ge_u32 s34, 8
    s_cselect_b32 s28, s58, s56
    s_cselect_b32 s29, s59, s57
    s_mov_b32 s40, 0
    s_add_u32 m0, s44, 0
    s_nop 0
    buffer_load_dwordx4 v2, s[28:31], s40 offen lds
    s_add_u32 m0, s44, 1024
    s_nop 0
    buffer_load_dwordx4 v3, s[28:31], s40 offen lds
    s_add_u32 m0, s44, 2048
    s_nop 0
    buffer_load_dwordx4 v4, s[28:31], s40 offen lds
    s_add_u32 m0, s44, 3072
    s_nop 0
    buffer_load_dwordx4 v5, s[28:31], s40 offen lds
    s_add_u32 m0, s44, 4096
    s_nop 0
    buffer_load_dwordx4 v6, s[28:31], s40 offen lds
    s_mov_b32 s40, 40960
    s_add_u32 m0, s44, 5120
    s_nop 0
    buffer_load_dwordx4 v2, s[28:31], s40 offen lds
    s_add_u32 m0, s44, 6144
    s_nop 0
    buffer_load_dwordx4 v3, s[28:31], s40 offen lds
    s_add_u32 m0, s44, 7168
    s_nop 0
    buffer_load_dwordx4 v4, s[28:31], s40 offen lds
    s_add_u32 m0, s44, 8192
    s_nop 0
    buffer_load_dwordx4 v5, s[28:31], s40 offen lds
    s_add_u32 m0, s44, 9216
    s_nop 0
    buffer_load_dwordx4 v6, s[28:31], s40 offen lds
    v_lshrrev_b32 v22, 4, v1
    v_bfe_u32 v23, v1, 2, 2
    v_and_b32 v24, 3, v1
    v_mul_u32_u24 v24, 40, v24
    v_add_u32 v24, s44, v24
    v_mad_u32_u24 v25, v22, 40, v23
    v_add_u32 v25, 16, v25
    v_mul_u32_u24 v25, 160, v25
    v_add_u32 v8, v25, v24
    v_lshrrev_b32 v25, 1, v22
    v_add_u32 v25, v25, v22
    v_lshl_add_u32 v23, v25, 3, v23
    v_mul_u32_u24 v23, 160, v23
    v_add_u32 v7, v23, v24
    s_lshr_b32 s37, s34, 3
    s_lshl_b32 s37, s37, 3
    s_add_u32 s37, s37, s92
    s_lshl_b32 s37, s37, 2
    s_add_u32 s37, s37, s93
    s_mul_i32 s41, s37, 25600
    v_and_b32 v9, 15, v1
    v_lshlrev_b32 v9, 4, v9
    v_mul_u32_u24 v10, 1280, v22
    v_add_u32 v10, v10, v9
    v_cmp_gt_u32 vcc, 128, v9
    v_lshl_add_u32 v22, v22, 2, v9
    s_lshl_b32 s91, s34, 2
    s_add_u32 s91, s91, s36
    v_cndmask_b32 v11, v21, v22, vcc
    s_mov_b32 s14, 2457600
    s_mov_b32 s15, 0x20000
    s_mov_b32 s22, 2621440
    s_mov_b32 s23, 0x20000
    s_mov_b32 s96, 18423808
    s_mov_b32 s97, 18456576
    s_and_b32 s101, s33, 7
    s_lshr_b32 s39, s33, 3
    s_lshl_b32 s37, s32, 2
    s_add_u32 s100, s37, s39
    s_mov_b32 s47, s101
    s_mov_b32 s46, s100
    s_lshr_b32 s100, s32, 1
    s_lshl_b32 s100, s100, 3
    s_lshr_b32 s37, s33, 2
    s_add_u32 s100, s100, s37
    s_and_b32 s101, s32, 1
    s_lshl_b32 s101, s101, 2
    s_and_b32 s37, s33, 3
    s_add_u32 s101, s101, s37
    s_lshl_b32 s49, s47, 8
    s_lshl_b32 s37, s36, 6
    s_add_u32 s49, s49, s37
    s_mul_i32 s92, s46, 5
    s_lshr_b32 s92, s92, 1
    s_and_b32 s40, s46, 1
    s_add_u32 s93, s92, s40
    s_lshl_b32 s48, s40, 3
    s_lshl_b32 s40, s40, 1
    s_add_u32 s94, s92, 2
    s_sub_u32 s94, s94, s40
    s_lshl_b32 s93, s93, 15
    s_lshl_b32 s94, s94, 15
    s_lshl_b32 s37, s49, 4
    s_add_u32 s84, s93, s37
    s_add_u32 s85, s94, s37
    s_lshl_b32 s95, s47, 1
    s_add_u32 s95, s95, s36
    s_lshl_b32 s37, s95, 11
    s_add_u32 s86, s93, s37
    s_add_u32 s87, s94, s37
    s_lshl_b32 s88, s36, 11
    s_mul_i32 s89, s36, 4608
    s_add_u32 s89, s89, 131584
    s_lshl_b32 s90, s49, 2
    s_add_u32 s90, s90, 18415616
    s_lshl_b32 s51, s34, 11
    s_lshl_b32 s37, s35, 7
    s_add_u32 s51, s51, s37
    s_add_u32 s51, s51, 18423808
    s_lshl_b32 s55, s101, 2
    s_add_u32 s55, s55, s36
    s_mul_i32 s55, s55, 25600
    v_and_b32 v27, 60, v1
    v_lshrrev_b32 v45, 5, v1
    v_and_b32 v46, 31, v1
    v_bfe_u32 v22, v1, 2, 1
    v_lshl_add_u32 v22, v22, 1, s92
    v_lshrrev_b32 v22, 4, v22
    v_and_b32 v23, 3, v1
    v_min_u32 v24, 2, v23
    v_mad_u32_u24 v25, v24, 5, v22
    v_mad_u32_u24 v26, v23, 5, v22
    v_min_u32 v26, 15, v26
    s_sub_u32 s38, s95, 2
    s_max_i32 s38, s38, 0
    s_lshl_b32 s38, s38, 11
    s_andn2_b32 s39, s49, 127
    s_lshl_b32 s39, s39, 4
    v_cmp_eq_u32 vcc, 0, v23
    v_mov_b32 v22, s38
    v_mov_b32 v24, s39
    v_cndmask_b32 v22, v22, v24, vcc
    v_lshl_add_u32 v28, v25, 7, v22
    s_sub_u32 s38, s49, 32
    s_max_i32 s38, s38, 0
    s_andn2_b32 s38, s38, 127
    s_lshl_b32 s38, s38, 4
    v_and_b32 v23, 8, v1
    v_cmp_eq_u32 vcc, 0, v23
    v_mov_b32 v22, s38
    v_and_b32 v23, 1, v1
    v_cndmask_b32 v22, v22, v24, vcc
    v_lshl_add_u32 v30, v26, 7, v22
    v_cmp_gt_u32 s[38:39], 32, v1
    s_lshr_b32 s37, s100, 1
    s_lshl_b32 s37, s37, 4
    s_add_u32 s37, s37, s36
    v_add_lshl_u32 v22, v23, s37, 7
    v_cndmask_b32 v30, v22, v30, s[38:39]
    s_lshr_b32 s40, s46, 1
    s_lshl_b32 s40, s40, 7
    v_add_u32 v22, s40, v24
    v_cndmask_b32 v28, v22, v28, s[38:39]
    v_cmp_gt_u32 s[38:39], 48, v1
    s_mul_i32 s40, s36, 3
    s_add_u32 s37, s37, s40
    v_and_b32 v22, 3, v1
    v_add_lshl_u32 v22, v22, s37, 7
    v_cndmask_b32 v30, v22, v30, s[38:39]
    s_lshl_b32 s53, s46, 14
    s_lshl_b32 s40, s49, 3
    s_add_u32 s53, s53, s40
    s_add_u32 s53, s53, 17367040
    s_lshl_b32 s37, s36, 1
    s_lshr_b32 s38, s101, 2
    s_add_u32 s37, s37, s38
    s_lshl_b32 s37, s37, 11
    s_add_u32 s37, s37, 1920
    v_lshl_add_u32 v29, v23, 14, s37
    v_cndmask_b32 v28, v29, v28, vcc
    v_lshlrev_b32 v31, 15, v45
    v_lshl_add_u32 v31, v46, 4, v31
    v_cmp_eq_u32 vcc, 0, v45
    v_lshl_add_u32 v22, v46, 4, s48
    s_cmp_eq_u32 s49, 0
    s_cselect_b32 s99, 1073741824, 0
    v_cndmask_b32 v32, v21, v22, vcc
    v_cndmask_b32 v33, v22, v21, vcc
    v_mov_b32 v23, s99
    v_cndmask_b32 v23, 0, v23, vcc
    v_add3_u32 v38, v23, v20, s48
    v_and_b32 v23, 15, v1
    v_mov_b32 v43, 0x10000
    v_lshrrev_b32 v22, 4, v1
    v_lshl_add_u32 v24, v22, 15, s84
    v_cmp_eq_u32 vcc, 2, v22
    v_mov_b32 v25, s85
    s_add_u32 s40, s99, 13106944
    v_cndmask_b32 v24, v24, v25, vcc
    v_cmp_eq_u32 vcc, 3, v22
    v_lshl_add_u32 v24, v23, 4, v24
    v_add_u32 v24, s40, v24
    v_cndmask_b32 v39, v24, v21, vcc
    s_lshl_b32 s37, s36, 10
    v_mul_u32_u24 v22, 8256, v45
    v_lshl_add_u32 v22, v46, 4, v22
    s_add_u32 s38, s37, 81920
    v_add_u32 v34, s38, v22
    s_add_u32 s54, s37, 98432
    s_add_u32 s54, s54, s48
    v_bfe_u32 v22, v1, 2, 2
    v_lshl_add_u32 v22, v45, 2, v22
    v_lshlrev_b32 v22, 4, v22
    v_and_b32 v19, 16, v1
    v_cmp_eq_u32 vcc, 0, v19
    v_and_b32 v23, 1, v1
    v_bfe_u32 v24, v1, 1, 1
    v_add_u32 v25, 2, v24
    v_lshlrev_b32 v24, 3, v24
    v_mov_b32 v26, s48
    v_cndmask_b32 v23, v25, v23, vcc
    v_cndmask_b32 v24, v26, v24, vcc
    v_cmp_eq_u32 vcc, 3, v23
    v_add_u32 v22, v22, v24
    s_add_u32 s38, s37, 106688
    v_mul_u32_u24 v24, 8256, v23
    v_add3_u32 v35, v22, v24, s38
    v_mul_u32_u24 v24, 1088, v23
    v_add3_u32 v36, v22, v24, s89
    s_add_u32 s38, s89, 3264
    v_lshlrev_b32 v24, 8, v23
    v_add3_u32 v37, v22, v24, s38
    s_add_u32 s38, s37, 150144
    v_add_u32 v24, s38, v22
    v_add_u32 v22, 154240, v22
    v_cndmask_b32 v35, v35, v24, vcc
    v_cndmask_b32 v36, v36, v22, vcc
    v_cndmask_b32 v37, v37, v22, vcc
    v_lshlrev_b32 v22, 2, v45
    v_sub_u32 v22, v22, v46
    v_lshlrev_b32 v22, 2, v22
    v_add_u32 v40, 158592, v22
    s_cmp_eq_u32 s49, 0
    s_cselect_b64 vcc, -1, 0
    v_mov_b32 v22, 158720
    v_cndmask_b32 v41, v40, v22, vcc
    s_and_b32 s50, s33, 7
    s_lshl_b32 s50, s50, 1
    s_add_u32 s50, s50, s36
    s_cmp_ge_u32 s50, 2
    s_cselect_b32 s43, 0, 1073741824
    s_cselect_b32 s50, 0x3f803f80, 0
    v_mov_b32 v128, s50
    v_mov_b32 v129, s50
    v_mov_b32 v130, s50
    v_mov_b32 v131, s50
    s_lshl_b32 s50, s36, 11
    s_add_u32 s50, s50, 150144
    v_add_u32 v132, s50, v20
    ds_write_b128 v132, v[128:131]
    ds_write_b128 v132, v[128:131] offset:1024
    s_cmp_eq_u32 s36, 0
    s_cselect_b32 s58, 0xffffffff, 0
    s_cselect_b32 s59, 0x1, 0
    s_cmp_eq_u32 s36, 1
    s_cselect_b32 s59, 0xfffffffe, s59
    s_cmp_eq_u32 s36, 2
    s_cselect_b32 s59, 0xaaaa0000, s59
    v_mov_b32 v138, 0xff800000
    s_lshl_b32 s50, s36, 8
    s_add_u32 s50, s50, 158464
    v_cndmask_b32 v138, v138, 0, s[58:59]
    v_lshl_add_u32 v139, v1, 2, s50
    ds_write_b32 v139, v138
    v_mov_b32 v64, 0
    v_mov_b32 v65, 0
    v_mov_b32 v66, 0
    v_mov_b32 v67, 0
    s_lshr_b32 s95, s36, 1
    s_lshl_b32 s95, s95, 4
    s_add_u32 s95, s95, s35
    s_lshl_b32 s95, s95, 1
    s_and_b32 s94, s36, 1
    s_add_u32 s95, s95, s94
    s_lshl_b32 s95, s95, 4
    s_add_u32 s95, s95, s34
    s_lshl_b32 s95, s95, 10
    s_add_u32 s95, s95, 17367040
    buffer_store_dwordx4 v[64:67], v20, s[16:19], s95 offen sc1
    s_mov_b32 s40, 81920
    s_add_u32 m0, s44, 10240
    s_nop 0
    buffer_load_dwordx4 v2, s[28:31], s40 offen lds
    s_add_u32 m0, s44, 11264
    s_nop 0
    buffer_load_dwordx4 v3, s[28:31], s40 offen lds
    s_add_u32 m0, s44, 12288
    s_nop 0
    buffer_load_dwordx4 v4, s[28:31], s40 offen lds
    s_add_u32 m0, s44, 13312
    s_nop 0
    buffer_load_dwordx4 v5, s[28:31], s40 offen lds
    s_add_u32 m0, s44, 14336
    s_nop 0
    buffer_load_dwordx4 v6, s[28:31], s40 offen lds
    s_waitcnt vmcnt(9)
    s_barrier
    s_lshl_b32 s38, s34, 2
    buffer_store_dword v18, v17, s[24:27], s38 offen sc1
    ds_read_b64_tr_b16 v[140:141], v7 offset:0
    ds_read_b64_tr_b16 v[142:143], v7 offset:640
    ds_read_b64_tr_b16 v[144:145], v7 offset:8
    ds_read_b64_tr_b16 v[146:147], v7 offset:648
    ds_read_b64_tr_b16 v[148:149], v7 offset:16
    ds_read_b64_tr_b16 v[150:151], v7 offset:656
    ds_read_b64_tr_b16 v[152:153], v7 offset:24
    ds_read_b64_tr_b16 v[154:155], v7 offset:664
    ds_read_b64_tr_b16 v[156:157], v7 offset:32
    ds_read_b64_tr_b16 v[158:159], v7 offset:672
    s_mov_b32 s40, 122880
    s_add_u32 m0, s44, 15360
    s_nop 0
    buffer_load_dwordx4 v2, s[28:31], s40 offen lds
    s_add_u32 m0, s44, 16384
    s_nop 0
    buffer_load_dwordx4 v3, s[28:31], s40 offen lds
    s_add_u32 m0, s44, 17408
    s_nop 0
    buffer_load_dwordx4 v4, s[28:31], s40 offen lds
    s_add_u32 m0, s44, 18432
    s_nop 0
    buffer_load_dwordx4 v5, s[28:31], s40 offen lds
    s_add_u32 m0, s44, 19456
    s_nop 0
    buffer_load_dwordx4 v6, s[28:31], s40 offen lds
    s_add_u32 s38, s41, 15728640
    s_waitcnt lgkmcnt(8)
    buffer_store_dwordx4 v[140:143], v20, s[16:19], s38 offen offset:0 sc1
    s_waitcnt lgkmcnt(6)
    buffer_store_dwordx4 v[144:147], v20, s[16:19], s38 offen offset:1024 sc1
    s_waitcnt lgkmcnt(4)
    buffer_store_dwordx4 v[148:151], v20, s[16:19], s38 offen offset:2048 sc1
    s_waitcnt lgkmcnt(2)
    buffer_store_dwordx4 v[152:155], v20, s[16:19], s38 offen offset:3072 sc1
    s_add_u32 s38, s41, 15732736
    s_waitcnt lgkmcnt(0)
    buffer_store_dwordx4 v[156:159], v20, s[16:19], s38 offen offset:0 sc1
    s_waitcnt vmcnt(13)
    ds_read_b64_tr_b16 v[160:161], v7 offset:6400
    ds_read_b64_tr_b16 v[162:163], v7 offset:7040
    ds_read_b64_tr_b16 v[164:165], v7 offset:6408
    ds_read_b64_tr_b16 v[166:167], v7 offset:7048
    ds_read_b64_tr_b16 v[168:169], v7 offset:6416
    ds_read_b64_tr_b16 v[170:171], v7 offset:7056
    ds_read_b64_tr_b16 v[172:173], v7 offset:6424
    ds_read_b64_tr_b16 v[174:175], v7 offset:7064
    ds_read_b64_tr_b16 v[176:177], v7 offset:6432
    ds_read_b64_tr_b16 v[178:179], v7 offset:7072
    s_mov_b32 s40, 163840
    s_add_u32 m0, s44, 20480
    s_nop 0
    buffer_load_dwordx4 v2, s[28:31], s40 offen lds
    s_add_u32 m0, s44, 21504
    s_nop 0
    buffer_load_dwordx4 v3, s[28:31], s40 offen lds
    s_add_u32 m0, s44, 22528
    s_nop 0
    buffer_load_dwordx4 v4, s[28:31], s40 offen lds
    s_add_u32 m0, s44, 23552
    s_nop 0
    buffer_load_dwordx4 v5, s[28:31], s40 offen lds
    s_add_u32 m0, s44, 24576
    s_nop 0
    buffer_load_dwordx4 v6, s[28:31], s40 offen lds
    s_waitcnt lgkmcnt(8)
    buffer_store_dwordx4 v[160:163], v20, s[16:19], s38 offen offset:1024 sc1
    s_waitcnt lgkmcnt(6)
    buffer_store_dwordx4 v[164:167], v20, s[16:19], s38 offen offset:2048 sc1
    s_waitcnt lgkmcnt(4)
    buffer_store_dwordx4 v[168:171], v20, s[16:19], s38 offen offset:3072 sc1
    s_add_u32 s38, s41, 15736832
    s_waitcnt lgkmcnt(2)
    buffer_store_dwordx4 v[172:175], v20, s[16:19], s38 offen offset:0 sc1
    s_waitcnt lgkmcnt(0)
    buffer_store_dwordx4 v[176:179], v20, s[16:19], s38 offen offset:1024 sc1
    s_waitcnt vmcnt(16)
    ds_read_b64_tr_b16 v[180:181], v7 offset:12800
    ds_read_b64_tr_b16 v[182:183], v7 offset:13440
    ds_read_b64_tr_b16 v[184:185], v7 offset:12808
    ds_read_b64_tr_b16 v[186:187], v7 offset:13448
    ds_read_b64_tr_b16 v[188:189], v7 offset:12816
    ds_read_b64_tr_b16 v[190:191], v7 offset:13456
    ds_read_b64_tr_b16 v[192:193], v7 offset:12824
    ds_read_b64_tr_b16 v[194:195], v7 offset:13464
    ds_read_b64_tr_b16 v[196:197], v7 offset:12832
    ds_read_b64_tr_b16 v[198:199], v7 offset:13472
    buffer_load_dword v19, v27, s[24:27], 0 offen offset:0 sc1
    s_waitcnt lgkmcnt(8)
    buffer_store_dwordx4 v[180:183], v20, s[16:19], s38 offen offset:2048 sc1
    s_waitcnt lgkmcnt(6)
    buffer_store_dwordx4 v[184:187], v20, s[16:19], s38 offen offset:3072 sc1
    s_add_u32 s38, s41, 15740928
    s_waitcnt lgkmcnt(4)
    buffer_store_dwordx4 v[188:191], v20, s[16:19], s38 offen offset:0 sc1
    s_waitcnt lgkmcnt(2)
    buffer_store_dwordx4 v[192:195], v20, s[16:19], s38 offen offset:1024 sc1
    s_waitcnt lgkmcnt(0)
    buffer_store_dwordx4 v[196:199], v20, s[16:19], s38 offen offset:2048 sc1
    s_waitcnt vmcnt(11)
    ds_read_b64_tr_b16 v[200:201], v7 offset:19200
    ds_read_b64_tr_b16 v[202:203], v7 offset:19840
    ds_read_b64_tr_b16 v[204:205], v7 offset:19208
    ds_read_b64_tr_b16 v[206:207], v7 offset:19848
    ds_read_b64_tr_b16 v[208:209], v7 offset:19216
    ds_read_b64_tr_b16 v[210:211], v7 offset:19856
    ds_read_b64_tr_b16 v[212:213], v7 offset:19224
    ds_read_b64_tr_b16 v[214:215], v7 offset:19864
    ds_read_b64_tr_b16 v[216:217], v7 offset:19232
    ds_read_b64_tr_b16 v[218:219], v7 offset:19872
    s_waitcnt lgkmcnt(8)
    buffer_store_dwordx4 v[200:203], v20, s[16:19], s38 offen offset:3072 sc1
    s_add_u32 s38, s41, 15745024
    s_waitcnt lgkmcnt(6)
    buffer_store_dwordx4 v[204:207], v20, s[16:19], s38 offen offset:0 sc1
    s_waitcnt lgkmcnt(4)
    buffer_store_dwordx4 v[208:211], v20, s[16:19], s38 offen offset:1024 sc1
    s_waitcnt lgkmcnt(2)
    buffer_store_dwordx4 v[212:215], v20, s[16:19], s38 offen offset:2048 sc1
    s_waitcnt lgkmcnt(0)
    buffer_store_dwordx4 v[216:219], v20, s[16:19], s38 offen offset:3072 sc1
    ds_read_b64_tr_b16 v[220:221], v8 offset:0
    ds_read_b64_tr_b16 v[222:223], v8 offset:640
    ds_read_b64_tr_b16 v[224:225], v8 offset:8
    ds_read_b64_tr_b16 v[226:227], v8 offset:648
    ds_read_b64_tr_b16 v[228:229], v8 offset:16
    ds_read_b64_tr_b16 v[230:231], v8 offset:656
    ds_read_b64_tr_b16 v[232:233], v8 offset:24
    ds_read_b64_tr_b16 v[234:235], v8 offset:664
    ds_read_b64_tr_b16 v[236:237], v8 offset:32
    ds_read_b64_tr_b16 v[238:239], v8 offset:672
    s_add_u32 s38, s41, 15749120
    s_waitcnt lgkmcnt(8)
    buffer_store_dwordx4 v[220:223], v20, s[16:19], s38 offen offset:0 sc1
    s_waitcnt lgkmcnt(6)
    buffer_store_dwordx4 v[224:227], v20, s[16:19], s38 offen offset:1024 sc1
    s_waitcnt lgkmcnt(4)
    buffer_store_dwordx4 v[228:231], v20, s[16:19], s38 offen offset:2048 sc1
    s_waitcnt lgkmcnt(2)
    buffer_store_dwordx4 v[232:235], v20, s[16:19], s38 offen offset:3072 sc1
    s_add_u32 s38, s41, 15753216
    s_waitcnt lgkmcnt(0)
    buffer_store_dwordx4 v[236:239], v20, s[16:19], s38 offen offset:0 sc1
    s_waitcnt vmcnt(15)
    v_cmp_ne_u32 vcc, 1, v19
    s_cbranch_vccnz L_poll_63
L_back_64:
    s_mul_i32 s38, s91, 40960
    buffer_load_dwordx4 v[224:227], v9, s[8:11], 0 offen offset:0
    buffer_load_dwordx4 v[228:231], v9, s[8:11], 0 offen offset:256
    buffer_load_dwordx4 v[232:235], v9, s[8:11], 0 offen offset:512
    buffer_load_dwordx4 v[236:239], v9, s[8:11], 0 offen offset:768
    buffer_load_dwordx4 v[240:243], v9, s[8:11], 0 offen offset:1024
    buffer_load_dwordx4 v[64:67], v10, s[4:7], s38 offen offset:0
    buffer_load_dwordx4 v[68:71], v10, s[4:7], s38 offen offset:256
    buffer_load_dwordx4 v[72:75], v10, s[4:7], s38 offen offset:512
    buffer_load_dwordx4 v[76:79], v10, s[4:7], s38 offen offset:768
    buffer_load_dwordx4 v[80:83], v10, s[4:7], s38 offen offset:1024
    s_add_u32 s38, s38, 5120
    buffer_load_dwordx4 v[84:87], v10, s[4:7], s38 offen offset:0
    buffer_load_dwordx4 v[88:91], v10, s[4:7], s38 offen offset:256
    buffer_load_dwordx4 v[92:95], v10, s[4:7], s38 offen offset:512
    buffer_load_dwordx4 v[96:99], v10, s[4:7], s38 offen offset:768
    buffer_load_dwordx4 v[100:103], v10, s[4:7], s38 offen offset:1024
    s_add_u32 s38, s38, 5120
    s_waitcnt vmcnt(15)
    s_barrier
    buffer_store_dword v18, v17, s[16:19], s51 offen offset:0 sc1
    buffer_load_dwordx4 v[104:107], v10, s[4:7], s38 offen offset:0
    buffer_load_dwordx4 v[108:111], v10, s[4:7], s38 offen offset:256
    buffer_load_dwordx4 v[112:115], v10, s[4:7], s38 offen offset:512
    buffer_load_dwordx4 v[116:119], v10, s[4:7], s38 offen offset:768
    buffer_load_dwordx4 v[120:123], v10, s[4:7], s38 offen offset:1024
    s_add_u32 s38, s38, 5120
    buffer_load_dwordx4 v[124:127], v10, s[4:7], s38 offen offset:0
    buffer_load_dwordx4 v[128:131], v10, s[4:7], s38 offen offset:256
    buffer_load_dwordx4 v[132:135], v10, s[4:7], s38 offen offset:512
    buffer_load_dwordx4 v[136:139], v10, s[4:7], s38 offen offset:768
    buffer_load_dwordx4 v[140:143], v10, s[4:7], s38 offen offset:1024
    s_add_u32 s38, s38, 5120
    buffer_load_dwordx4 v[144:147], v10, s[4:7], s38 offen offset:0
    buffer_load_dwordx4 v[148:151], v10, s[4:7], s38 offen offset:256
    buffer_load_dwordx4 v[152:155], v10, s[4:7], s38 offen offset:512
    buffer_load_dwordx4 v[156:159], v10, s[4:7], s38 offen offset:768
    buffer_load_dwordx4 v[160:163], v10, s[4:7], s38 offen offset:1024
    s_add_u32 s38, s38, 5120
    buffer_load_dwordx4 v[164:167], v10, s[4:7], s38 offen offset:0
    buffer_load_dwordx4 v[168:171], v10, s[4:7], s38 offen offset:256
    buffer_load_dwordx4 v[172:175], v10, s[4:7], s38 offen offset:512
    buffer_load_dwordx4 v[176:179], v10, s[4:7], s38 offen offset:768
    buffer_load_dwordx4 v[180:183], v10, s[4:7], s38 offen offset:1024
    s_add_u32 s38, s38, 5120
    buffer_load_dwordx4 v[184:187], v10, s[4:7], s38 offen offset:0
    buffer_load_dwordx4 v[188:191], v10, s[4:7], s38 offen offset:256
    buffer_load_dwordx4 v[192:195], v10, s[4:7], s38 offen offset:512
    buffer_load_dwordx4 v[196:199], v10, s[4:7], s38 offen offset:768
    buffer_load_dwordx4 v[200:203], v10, s[4:7], s38 offen offset:1024
    s_add_u32 s38, s38, 5120
    buffer_load_dwordx4 v[204:207], v10, s[4:7], s38 offen offset:0
    buffer_load_dwordx4 v[208:211], v10, s[4:7], s38 offen offset:256
    buffer_load_dwordx4 v[212:215], v10, s[4:7], s38 offen offset:512
    buffer_load_dwordx4 v[216:219], v10, s[4:7], s38 offen offset:768
    buffer_load_dwordx4 v[220:223], v10, s[4:7], s38 offen offset:1024
    s_add_u32 s38, s38, 5120
    s_lshl_b32 s91, s91, 7
    s_add_u32 s91, s91, 18415616
    v_mov_b32 v48, 0
    s_waitcnt vmcnt(40)
    v_dot2c_f32_bf16 v48, v64, v224
    v_dot2c_f32_bf16 v48, v65, v225
    v_dot2c_f32_bf16 v48, v66, v226
    v_dot2c_f32_bf16 v48, v67, v227
    s_waitcnt vmcnt(39)
    v_dot2c_f32_bf16 v48, v68, v228
    v_dot2c_f32_bf16 v48, v69, v229
    v_dot2c_f32_bf16 v48, v70, v230
    v_dot2c_f32_bf16 v48, v71, v231
    s_waitcnt vmcnt(38)
    v_dot2c_f32_bf16 v48, v72, v232
    v_dot2c_f32_bf16 v48, v73, v233
    v_dot2c_f32_bf16 v48, v74, v234
    v_dot2c_f32_bf16 v48, v75, v235
    s_waitcnt vmcnt(37)
    v_dot2c_f32_bf16 v48, v76, v236
    v_dot2c_f32_bf16 v48, v77, v237
    v_dot2c_f32_bf16 v48, v78, v238
    v_dot2c_f32_bf16 v48, v79, v239
    s_waitcnt vmcnt(36)
    v_dot2c_f32_bf16 v48, v80, v240
    v_dot2c_f32_bf16 v48, v81, v241
    v_dot2c_f32_bf16 v48, v82, v242
    v_dot2c_f32_bf16 v48, v83, v243
    v_mov_b32 v49, 0
    s_waitcnt vmcnt(35)
    v_dot2c_f32_bf16 v49, v84, v224
    v_dot2c_f32_bf16 v49, v85, v225
    v_dot2c_f32_bf16 v49, v86, v226
    v_dot2c_f32_bf16 v49, v87, v227
    s_waitcnt vmcnt(34)
    v_dot2c_f32_bf16 v49, v88, v228
    v_dot2c_f32_bf16 v49, v89, v229
    v_dot2c_f32_bf16 v49, v90, v230
    v_dot2c_f32_bf16 v49, v91, v231
    s_waitcnt vmcnt(33)
    v_dot2c_f32_bf16 v49, v92, v232
    v_dot2c_f32_bf16 v49, v93, v233
    v_dot2c_f32_bf16 v49, v94, v234
    v_dot2c_f32_bf16 v49, v95, v235
    s_waitcnt vmcnt(32)
    v_dot2c_f32_bf16 v49, v96, v236
    v_dot2c_f32_bf16 v49, v97, v237
    v_dot2c_f32_bf16 v49, v98, v238
    v_dot2c_f32_bf16 v49, v99, v239
    s_waitcnt vmcnt(31)
    v_dot2c_f32_bf16 v49, v100, v240
    v_dot2c_f32_bf16 v49, v101, v241
    v_dot2c_f32_bf16 v49, v102, v242
    v_dot2c_f32_bf16 v49, v103, v243
    v_mov_b32 v50, 0
    s_waitcnt vmcnt(29)
    v_dot2c_f32_bf16 v50, v104, v224
    v_dot2c_f32_bf16 v50, v105, v225
    v_dot2c_f32_bf16 v50, v106, v226
    v_dot2c_f32_bf16 v50, v107, v227
    s_waitcnt vmcnt(28)
    v_dot2c_f32_bf16 v50, v108, v228
    v_dot2c_f32_bf16 v50, v109, v229
    v_dot2c_f32_bf16 v50, v110, v230
    v_dot2c_f32_bf16 v50, v111, v231
    s_waitcnt vmcnt(27)
    v_dot2c_f32_bf16 v50, v112, v232
    v_dot2c_f32_bf16 v50, v113, v233
    v_dot2c_f32_bf16 v50, v114, v234
    v_dot2c_f32_bf16 v50, v115, v235
    s_waitcnt vmcnt(26)
    v_dot2c_f32_bf16 v50, v116, v236
    v_dot2c_f32_bf16 v50, v117, v237
    v_dot2c_f32_bf16 v50, v118, v238
    v_dot2c_f32_bf16 v50, v119, v239
    s_waitcnt vmcnt(25)
    v_dot2c_f32_bf16 v50, v120, v240
    v_dot2c_f32_bf16 v50, v121, v241
    v_dot2c_f32_bf16 v50, v122, v242
    v_dot2c_f32_bf16 v50, v123, v243
    v_mov_b32 v51, 0
    s_waitcnt vmcnt(24)
    v_dot2c_f32_bf16 v51, v124, v224
    v_dot2c_f32_bf16 v51, v125, v225
    v_dot2c_f32_bf16 v51, v126, v226
    v_dot2c_f32_bf16 v51, v127, v227
    s_waitcnt vmcnt(23)
    v_dot2c_f32_bf16 v51, v128, v228
    v_dot2c_f32_bf16 v51, v129, v229
    v_dot2c_f32_bf16 v51, v130, v230
    v_dot2c_f32_bf16 v51, v131, v231
    s_waitcnt vmcnt(22)
    v_dot2c_f32_bf16 v51, v132, v232
    v_dot2c_f32_bf16 v51, v133, v233
    v_dot2c_f32_bf16 v51, v134, v234
    v_dot2c_f32_bf16 v51, v135, v235
    s_waitcnt vmcnt(21)
    v_dot2c_f32_bf16 v51, v136, v236
    v_dot2c_f32_bf16 v51, v137, v237
    v_dot2c_f32_bf16 v51, v138, v238
    v_dot2c_f32_bf16 v51, v139, v239
    s_waitcnt vmcnt(20)
    v_dot2c_f32_bf16 v51, v140, v240
    v_dot2c_f32_bf16 v51, v141, v241
    v_dot2c_f32_bf16 v51, v142, v242
    v_dot2c_f32_bf16 v51, v143, v243
    v_mov_b32 v52, 0
    s_waitcnt vmcnt(19)
    v_dot2c_f32_bf16 v52, v144, v224
    v_dot2c_f32_bf16 v52, v145, v225
    v_dot2c_f32_bf16 v52, v146, v226
    v_dot2c_f32_bf16 v52, v147, v227
    s_waitcnt vmcnt(18)
    v_dot2c_f32_bf16 v52, v148, v228
    v_dot2c_f32_bf16 v52, v149, v229
    v_dot2c_f32_bf16 v52, v150, v230
    v_dot2c_f32_bf16 v52, v151, v231
    s_waitcnt vmcnt(17)
    v_dot2c_f32_bf16 v52, v152, v232
    v_dot2c_f32_bf16 v52, v153, v233
    v_dot2c_f32_bf16 v52, v154, v234
    v_dot2c_f32_bf16 v52, v155, v235
    s_waitcnt vmcnt(16)
    v_dot2c_f32_bf16 v52, v156, v236
    v_dot2c_f32_bf16 v52, v157, v237
    v_dot2c_f32_bf16 v52, v158, v238
    v_dot2c_f32_bf16 v52, v159, v239
    s_waitcnt vmcnt(15)
    v_dot2c_f32_bf16 v52, v160, v240
    v_dot2c_f32_bf16 v52, v161, v241
    v_dot2c_f32_bf16 v52, v162, v242
    v_dot2c_f32_bf16 v52, v163, v243
    v_mov_b32 v53, 0
    s_waitcnt vmcnt(14)
    v_dot2c_f32_bf16 v53, v164, v224
    v_dot2c_f32_bf16 v53, v165, v225
    v_dot2c_f32_bf16 v53, v166, v226
    v_dot2c_f32_bf16 v53, v167, v227
    s_waitcnt vmcnt(13)
    v_dot2c_f32_bf16 v53, v168, v228
    v_dot2c_f32_bf16 v53, v169, v229
    v_dot2c_f32_bf16 v53, v170, v230
    v_dot2c_f32_bf16 v53, v171, v231
    s_waitcnt vmcnt(12)
    v_dot2c_f32_bf16 v53, v172, v232
    v_dot2c_f32_bf16 v53, v173, v233
    v_dot2c_f32_bf16 v53, v174, v234
    v_dot2c_f32_bf16 v53, v175, v235
    s_waitcnt vmcnt(11)
    v_dot2c_f32_bf16 v53, v176, v236
    v_dot2c_f32_bf16 v53, v177, v237
    v_dot2c_f32_bf16 v53, v178, v238
    v_dot2c_f32_bf16 v53, v179, v239
    s_waitcnt vmcnt(10)
    v_dot2c_f32_bf16 v53, v180, v240
    v_dot2c_f32_bf16 v53, v181, v241
    v_dot2c_f32_bf16 v53, v182, v242
    v_dot2c_f32_bf16 v53, v183, v243
    v_mov_b32 v54, 0
    s_waitcnt vmcnt(9)
    v_dot2c_f32_bf16 v54, v184, v224
    v_dot2c_f32_bf16 v54, v185, v225
    v_dot2c_f32_bf16 v54, v186, v226
    v_dot2c_f32_bf16 v54, v187, v227
    s_waitcnt vmcnt(8)
    v_dot2c_f32_bf16 v54, v188, v228
    v_dot2c_f32_bf16 v54, v189, v229
    v_dot2c_f32_bf16 v54, v190, v230
    v_dot2c_f32_bf16 v54, v191, v231
    s_waitcnt vmcnt(7)
    v_dot2c_f32_bf16 v54, v192, v232
    v_dot2c_f32_bf16 v54, v193, v233
    v_dot2c_f32_bf16 v54, v194, v234
    v_dot2c_f32_bf16 v54, v195, v235
    s_waitcnt vmcnt(6)
    v_dot2c_f32_bf16 v54, v196, v236
    v_dot2c_f32_bf16 v54, v197, v237
    v_dot2c_f32_bf16 v54, v198, v238
    v_dot2c_f32_bf16 v54, v199, v239
    s_waitcnt vmcnt(5)
    v_dot2c_f32_bf16 v54, v200, v240
    v_dot2c_f32_bf16 v54, v201, v241
    v_dot2c_f32_bf16 v54, v202, v242
    v_dot2c_f32_bf16 v54, v203, v243
    buffer_load_dword v19, v28, s[16:19], s96 offen offset:0 sc1
    v_mov_b32 v55, 0
    s_waitcnt vmcnt(5)
    v_dot2c_f32_bf16 v55, v204, v224
    v_dot2c_f32_bf16 v55, v205, v225
    v_dot2c_f32_bf16 v55, v206, v226
    v_dot2c_f32_bf16 v55, v207, v227
    s_waitcnt vmcnt(4)
    v_dot2c_f32_bf16 v55, v208, v228
    v_dot2c_f32_bf16 v55, v209, v229
    v_dot2c_f32_bf16 v55, v210, v230
    v_dot2c_f32_bf16 v55, v211, v231
    s_waitcnt vmcnt(3)
    v_dot2c_f32_bf16 v55, v212, v232
    v_dot2c_f32_bf16 v55, v213, v233
    v_dot2c_f32_bf16 v55, v214, v234
    v_dot2c_f32_bf16 v55, v215, v235
    s_waitcnt vmcnt(2)
    v_dot2c_f32_bf16 v55, v216, v236
    v_dot2c_f32_bf16 v55, v217, v237
    v_dot2c_f32_bf16 v55, v218, v238
    v_dot2c_f32_bf16 v55, v219, v239
    s_waitcnt vmcnt(1)
    v_dot2c_f32_bf16 v55, v220, v240
    v_dot2c_f32_bf16 v55, v221, v241
    v_dot2c_f32_bf16 v55, v222, v242
    v_dot2c_f32_bf16 v55, v223, v243
    v_add_f32_dpp v48, v48, v48 row_ror:8 row_mask:0xf bank_mask:0xf
    v_add_f32_dpp v49, v49, v49 row_ror:8 row_mask:0xf bank_mask:0xf
    v_add_f32_dpp v50, v50, v50 row_ror:8 row_mask:0xf bank_mask:0xf
    v_add_f32_dpp v51, v51, v51 row_ror:8 row_mask:0xf bank_mask:0xf
    v_add_f32_dpp v52, v52, v52 row_ror:8 row_mask:0xf bank_mask:0xf
    v_add_f32_dpp v53, v53, v53 row_ror:8 row_mask:0xf bank_mask:0xf
    v_add_f32_dpp v54, v54, v54 row_ror:8 row_mask:0xf bank_mask:0xf
    v_add_f32_dpp v55, v55, v55 row_ror:8 row_mask:0xf bank_mask:0xf
    v_add_f32_dpp v48, v48, v48 row_ror:4 row_mask:0xf bank_mask:0xf
    v_add_f32_dpp v49, v49, v49 row_ror:4 row_mask:0xf bank_mask:0xf
    v_add_f32_dpp v50, v50, v50 row_ror:4 row_mask:0xf bank_mask:0xf
    v_add_f32_dpp v51, v51, v51 row_ror:4 row_mask:0xf bank_mask:0xf
    v_add_f32_dpp v52, v52, v52 row_ror:4 row_mask:0xf bank_mask:0xf
    v_add_f32_dpp v53, v53, v53 row_ror:4 row_mask:0xf bank_mask:0xf
    v_add_f32_dpp v54, v54, v54 row_ror:4 row_mask:0xf bank_mask:0xf
    v_add_f32_dpp v55, v55, v55 row_ror:4 row_mask:0xf bank_mask:0xf
    v_add_f32_dpp v48, v48, v48 row_ror:2 row_mask:0xf bank_mask:0xf
    v_add_f32_dpp v49, v49, v49 row_ror:2 row_mask:0xf bank_mask:0xf
    v_add_f32_dpp v50, v50, v50 row_ror:2 row_mask:0xf bank_mask:0xf
    v_add_f32_dpp v51, v51, v51 row_ror:2 row_mask:0xf bank_mask:0xf
    v_add_f32_dpp v52, v52, v52 row_ror:2 row_mask:0xf bank_mask:0xf
    v_add_f32_dpp v53, v53, v53 row_ror:2 row_mask:0xf bank_mask:0xf
    v_add_f32_dpp v54, v54, v54 row_ror:2 row_mask:0xf bank_mask:0xf
    v_add_f32_dpp v55, v55, v55 row_ror:2 row_mask:0xf bank_mask:0xf
    v_add_f32_dpp v48, v48, v48 row_ror:1 row_mask:0xf bank_mask:0xf
    v_add_f32_dpp v49, v49, v49 row_ror:1 row_mask:0xf bank_mask:0xf
    v_add_f32_dpp v50, v50, v50 row_ror:1 row_mask:0xf bank_mask:0xf
    v_add_f32_dpp v51, v51, v51 row_ror:1 row_mask:0xf bank_mask:0xf
    v_add_f32_dpp v52, v52, v52 row_ror:1 row_mask:0xf bank_mask:0xf
    v_add_f32_dpp v53, v53, v53 row_ror:1 row_mask:0xf bank_mask:0xf
    v_add_f32_dpp v54, v54, v54 row_ror:1 row_mask:0xf bank_mask:0xf
    v_add_f32_dpp v55, v55, v55 row_ror:1 row_mask:0xf bank_mask:0xf
    s_mov_b32 vcc_lo, 0x20002
    s_mov_b32 vcc_hi, 0x20002
    v_cndmask_b32 v48, v48, v49, vcc
    s_mov_b32 vcc_lo, 0x40004
    s_mov_b32 vcc_hi, 0x40004
    v_cndmask_b32 v48, v48, v50, vcc
    s_mov_b32 vcc_lo, 0x80008
    s_mov_b32 vcc_hi, 0x80008
    v_cndmask_b32 v48, v48, v51, vcc
    s_mov_b32 vcc_lo, 0x100010
    s_mov_b32 vcc_hi, 0x100010
    v_cndmask_b32 v48, v48, v52, vcc
    s_mov_b32 vcc_lo, 0x200020
    s_mov_b32 vcc_hi, 0x200020
    v_cndmask_b32 v48, v48, v53, vcc
    s_mov_b32 vcc_lo, 0x400040
    s_mov_b32 vcc_hi, 0x400040
    v_cndmask_b32 v48, v48, v54, vcc
    s_mov_b32 vcc_lo, 0x800080
    s_mov_b32 vcc_hi, 0x800080
    v_cndmask_b32 v48, v48, v55, vcc
    v_mul_f32 v48, 0xbfb8aa3b, v48
    v_exp_f32 v48, v48
    s_nop 0
    v_add_f32 v48, 1.0, v48
    v_rcp_f32 v48, v48
    v_add_u32 v6, s43, v20
    v_lshlrev_b32 v7, 2, v46
    v_add_u32 v8, s99, v31
    v_add_u32 v9, s54, v20
    v_lshlrev_b32 v27, 3, v1
    s_waitcnt vmcnt(0)
    v_cmp_ne_u32 vcc, 1, v19
    s_cbranch_vccnz L_poll_65
L_back_66:
    s_add_u32 m0, s88, 81920
    s_add_u32 s93, s86, 2617344
    buffer_load_dwordx4 v6, s[16:19], s93 offen sc1 lds
    buffer_load_dwordx4 v6, s[16:19], s93 offen offset:1024 sc1 lds
    s_add_u32 m0, s88, 90176
    s_add_u32 s93, s86, 2650112
    buffer_load_dwordx4 v6, s[16:19], s93 offen sc1 lds
    buffer_load_dwordx4 v6, s[16:19], s93 offen offset:1024 sc1 lds
    s_add_u32 m0, s88, 98432
    s_add_u32 s93, s87, 2617344
    buffer_load_dwordx4 v6, s[16:19], s93 offen sc1 lds
    buffer_load_dwordx4 v6, s[16:19], s93 offen offset:1024 sc1 lds
    s_add_u32 m0, s88, 106688
    s_add_u32 s93, s86, 5238784
    buffer_load_dwordx4 v6, s[16:19], s93 offen sc1 lds
    buffer_load_dwordx4 v6, s[16:19], s93 offen offset:1024 sc1 lds
    s_add_u32 m0, s88, 114944
    s_add_u32 s93, s86, 5271552
    buffer_load_dwordx4 v6, s[16:19], s93 offen sc1 lds
    buffer_load_dwordx4 v6, s[16:19], s93 offen offset:1024 sc1 lds
    s_add_u32 m0, s88, 123200
    s_add_u32 s93, s87, 5238784
    buffer_load_dwordx4 v6, s[16:19], s93 offen sc1 lds
    buffer_load_dwordx4 v6, s[16:19], s93 offen offset:1024 sc1 lds
    buffer_load_dwordx4 v[96:99], v31, s[16:19], s84 offen sc1
    buffer_load_dwordx2 v[104:105], v32, s[16:19], s85 offen sc1
    buffer_load_dwordx2 v[106:107], v33, s[16:19], s85 offen sc1
    buffer_load_dwordx4 v[100:103], v31, s[16:19], s84 offen offset:512 sc1
    buffer_load_dwordx2 v[108:109], v32, s[16:19], s85 offen offset:512 sc1
    buffer_load_dwordx2 v[110:111], v33, s[16:19], s85 offen offset:512 sc1
    buffer_store_dword v48, v11, s[16:19], s91 offen sc1
    ds_read2_b32 v[80:81], v40 offset0:64 offset1:65
    ds_read2_b32 v[82:83], v40 offset0:66 offset1:67
    ds_read2_b32 v[84:85], v40 offset0:72 offset1:73
    ds_read2_b32 v[86:87], v40 offset0:74 offset1:75
    ds_read2_b32 v[88:89], v40 offset0:80 offset1:81
    ds_read2_b32 v[90:91], v40 offset0:82 offset1:83
    ds_read2_b32 v[92:93], v40 offset0:88 offset1:89
    ds_read2_b32 v[94:95], v40 offset0:90 offset1:91
    v_accvgpr_write_b32 a210, 0
    v_accvgpr_write_b32 a211, 0
    v_accvgpr_write_b32 a214, 0
    v_accvgpr_write_b32 a215, 0
    v_accvgpr_write_b32 a234, 0
    v_accvgpr_write_b32 a235, 0
    v_accvgpr_write_b32 a238, 0
    v_accvgpr_write_b32 a239, 0
    v_mov_b32 v112, 0
    v_mov_b32 v113, 0
    v_lshrrev_b32 v22, 4, v1
    v_and_b32 v23, 15, v1
    v_add_lshl_u32 v26, v22, v45, 15
    v_lshl_add_u32 v26, v23, 4, v26
    s_add_u32 s56, s36, 0
    s_and_b32 s56, s56, 3
    s_lshl_b32 s56, s56, 8
    s_add_u32 s57, s36, 1
    s_and_b32 s57, s57, 3
    s_lshl_b32 s57, s57, 8
    s_add_u32 s58, s36, 2
    s_and_b32 s58, s58, 3
    s_lshl_b32 s58, s58, 8
    s_add_u32 s59, s36, 3
    s_and_b32 s59, s59, 3
    s_lshl_b32 s59, s59, 8
    v_add_u32 v2, s56, v26
    v_add_u32 v3, s57, v26
    v_add_u32 v4, s58, v26
    v_add_u32 v5, s59, v26
    s_add_u32 s94, s55, 15728640
    buffer_load_dwordx4 a[0:3], v20, s[16:19], s94 offen offset:0 sc1
    buffer_load_dwordx4 a[4:7], v20, s[16:19], s94 offen offset:1024 sc1
    buffer_load_dwordx4 a[8:11], v20, s[16:19], s94 offen offset:2048 sc1
    buffer_load_dwordx4 a[12:15], v20, s[16:19], s94 offen offset:3072 sc1
    s_add_u32 s94, s55, 15732736
    buffer_load_dwordx4 a[16:19], v20, s[16:19], s94 offen offset:0 sc1
    buffer_load_dwordx4 a[20:23], v20, s[16:19], s94 offen offset:1024 sc1
    buffer_load_dwordx4 a[24:27], v20, s[16:19], s94 offen offset:2048 sc1
    buffer_load_dwordx4 a[28:31], v20, s[16:19], s94 offen offset:3072 sc1
    s_add_u32 s94, s55, 15736832
    buffer_load_dwordx4 a[32:35], v20, s[16:19], s94 offen offset:0 sc1
    buffer_load_dwordx4 a[36:39], v20, s[16:19], s94 offen offset:1024 sc1
    buffer_load_dwordx4 a[40:43], v20, s[16:19], s94 offen offset:2048 sc1
    buffer_load_dwordx4 a[44:47], v20, s[16:19], s94 offen offset:3072 sc1
    s_add_u32 s94, s55, 15740928
    buffer_load_dwordx4 a[48:51], v20, s[16:19], s94 offen offset:0 sc1
    buffer_load_dwordx4 a[52:55], v20, s[16:19], s94 offen offset:1024 sc1
    buffer_load_dwordx4 a[56:59], v20, s[16:19], s94 offen offset:2048 sc1
    buffer_load_dwordx4 a[60:63], v20, s[16:19], s94 offen offset:3072 sc1
    s_add_u32 s94, s55, 15745024
    buffer_load_dwordx4 a[64:67], v20, s[16:19], s94 offen offset:0 sc1
    buffer_load_dwordx4 a[68:71], v20, s[16:19], s94 offen offset:1024 sc1
    buffer_load_dwordx4 a[72:75], v20, s[16:19], s94 offen offset:2048 sc1
    buffer_load_dwordx4 a[76:79], v20, s[16:19], s94 offen offset:3072 sc1
    s_waitcnt vmcnt(21)
    s_waitcnt lgkmcnt(0)
    s_barrier
    ds_read_b128 a[200:203], v34 offset:0
    ds_read_b64 a[208:209], v9 offset:0
    ds_read_b128 a[204:207], v34 offset:512
    ds_read_b64_tr_b16 a[216:217], v35 offset:0
    ds_read_b64_tr_b16 a[218:219], v35 offset:128
    ds_read_b64_tr_b16 a[220:221], v35 offset:256
    ds_read_b64_tr_b16 a[222:223], v35 offset:384
    s_waitcnt lgkmcnt(6)
    v_mfma_f32_32x32x16_bf16 v[64:79], a[200:203], v[96:99], v[80:95]
    s_waitcnt lgkmcnt(5)
    v_mfma_f32_32x32x16_bf16 v[64:79], a[208:211], v[104:107], v[64:79]
    ds_read2_b32 v[208:209], v40 offset0:0 offset1:1
    ds_read2_b32 v[210:211], v40 offset0:2 offset1:3
    ds_read2_b32 v[212:213], v40 offset0:8 offset1:9
    ds_read2_b32 v[214:215], v40 offset0:10 offset1:11
    ds_read2_b32 v[216:217], v40 offset0:16 offset1:17
    ds_read2_b32 v[218:219], v40 offset0:18 offset1:19
    ds_read2_b32 v[220:221], v40 offset0:24 offset1:25
    ds_read2_b32 v[222:223], v40 offset0:26 offset1:27
    s_nop 7
    s_waitcnt lgkmcnt(0)
    s_branch L_join
L_poll_1:
    s_mov_b32 s50, 0
L_poll_1_a:
    buffer_load_dword v19, v28, s[16:19], s96 offen offset:0 sc1
    s_add_u32 s50, s50, 1
    s_waitcnt vmcnt(0)
    v_cmp_ne_u32 vcc, 1, v19
    s_cbranch_vccz L_back_2
    s_cmp_lt_u32 s50, 0x40000
    s_cbranch_scc1 L_poll_1_a
    s_branch L_back_2
L_poll_3:
    s_mov_b32 s50, 0
L_poll_3_a:
    buffer_load_dword v19, v27, s[24:27], 0 offen offset:0 sc1
    s_add_u32 s50, s50, 1
    s_waitcnt vmcnt(0)
    v_cmp_ne_u32 vcc, 1, v19
    s_cbranch_vccz L_back_4
    s_cmp_lt_u32 s50, 0x40000
    s_cbranch_scc1 L_poll_3_a
    s_branch L_back_4
L_poll_5:
    s_mov_b32 s50, 0
L_poll_5_a:
    buffer_load_dword v19, v29, s[16:19], s96 offen offset:0 sc1
    s_add_u32 s50, s50, 1
    s_waitcnt vmcnt(0)
    v_cmp_ne_u32 vcc, 1, v19
    s_cbranch_vccz L_back_6
    s_cmp_lt_u32 s50, 0x40000
    s_cbranch_scc1 L_poll_5_a
    s_branch L_back_6
L_poll_7:
    s_mov_b32 s50, 0
L_poll_7_a:
    buffer_load_dword v19, v30, s[16:19], s97 offen offset:0 sc1
    s_add_u32 s50, s50, 1
    s_waitcnt vmcnt(0)
    v_cmp_ne_u32 vcc, 1, v19
    s_cbranch_vccz L_back_8
    s_cmp_lt_u32 s50, 0x40000
    s_cbranch_scc1 L_poll_7_a
    s_branch L_back_8
L_again_45:
    s_mov_b32 s50, 0
L_again_45_a:
    buffer_load_dwordx4 v[224:227], v2, s[16:19], s70 offen sc1
    buffer_load_dwordx4 v[228:231], v3, s[16:19], s70 offen sc1
    buffer_load_dwordx4 v[232:235], v4, s[16:19], s70 offen sc1
    buffer_load_dwordx4 v[236:239], v5, s[16:19], s70 offen sc1
    s_add_u32 s50, s50, 1
    s_waitcnt vmcnt(0)
    v_bitop3_b32 v1, 1, v224, v228 bitop3:0x80
    v_bitop3_b32 v1, v1, v232, v236 bitop3:0x80
    v_cmp_eq_u32 vcc, 0, v1
    s_cbranch_vccz L_fresh_46
    s_cmp_lt_u32 s50, 0x40000
    s_cbranch_scc1 L_again_45_a
    s_branch L_fresh_46
L_again_47:
    s_mov_b32 s50, 0
L_again_47_a:
    buffer_load_dwordx4 v[128:131], v2, s[16:19], s71 offen sc1
    buffer_load_dwordx4 v[132:135], v3, s[16:19], s71 offen sc1
    buffer_load_dwordx4 v[136:139], v4, s[16:19], s71 offen sc1
    buffer_load_dwordx4 v[140:143], v5, s[16:19], s71 offen sc1
    s_add_u32 s50, s50, 1
    s_waitcnt vmcnt(0)
    v_bitop3_b32 v1, 1, v128, v132 bitop3:0x80
    v_bitop3_b32 v1, v1, v136, v140 bitop3:0x80
    v_cmp_eq_u32 vcc, 0, v1
    s_cbranch_vccz L_fresh_48
    s_cmp_lt_u32 s50, 0x40000
    s_cbranch_scc1 L_again_47_a
    s_branch L_fresh_48
L_again_49:
    s_mov_b32 s50, 0
L_again_49_a:
    buffer_load_dwordx4 v[144:147], v2, s[16:19], s72 offen sc1
    buffer_load_dwordx4 v[148:151], v3, s[16:19], s72 offen sc1
    buffer_load_dwordx4 v[152:155], v4, s[16:19], s72 offen sc1
    buffer_load_dwordx4 v[156:159], v5, s[16:19], s72 offen sc1
    s_add_u32 s50, s50, 1
    s_waitcnt vmcnt(0)
    v_bitop3_b32 v1, 1, v144, v148 bitop3:0x80
    v_bitop3_b32 v1, v1, v152, v156 bitop3:0x80
    v_cmp_eq_u32 vcc, 0, v1
    s_cbranch_vccz L_fresh_50
    s_cmp_lt_u32 s50, 0x40000
    s_cbranch_scc1 L_again_49_a
    s_branch L_fresh_50
L_again_51:
    s_mov_b32 s50, 0
L_again_51_a:
    buffer_load_dwordx4 v[160:163], v2, s[16:19], s73 offen sc1
    buffer_load_dwordx4 v[164:167], v3, s[16:19], s73 offen sc1
    buffer_load_dwordx4 v[168:171], v4, s[16:19], s73 offen sc1
    buffer_load_dwordx4 v[172:175], v5, s[16:19], s73 offen sc1
    s_add_u32 s50, s50, 1
    s_waitcnt vmcnt(0)
    v_bitop3_b32 v1, 1, v160, v164 bitop3:0x80
    v_bitop3_b32 v1, v1, v168, v172 bitop3:0x80
    v_cmp_eq_u32 vcc, 0, v1
    s_cbranch_vccz L_fresh_52
    s_cmp_lt_u32 s50, 0x40000
    s_cbranch_scc1 L_again_51_a
    s_branch L_fresh_52
L_again_53:
    s_mov_b32 s50, 0
L_again_53_a:
    buffer_load_dwordx2 v[176:177], v6, s[16:19], s74 offen sc1
    buffer_load_dwordx2 v[178:179], v6, s[16:19], s75 offen sc1
    buffer_load_dwordx2 v[180:181], v7, s[16:19], s74 offen sc1
    buffer_load_dwordx2 v[182:183], v7, s[16:19], s75 offen sc1
    buffer_load_dwordx2 v[184:185], v8, s[16:19], s74 offen sc1
    buffer_load_dwordx2 v[186:187], v8, s[16:19], s75 offen sc1
    buffer_load_dwordx2 v[188:189], v9, s[16:19], s74 offen sc1
    buffer_load_dwordx2 v[190:191], v9, s[16:19], s75 offen sc1
    s_add_u32 s50, s50, 1
    s_waitcnt vmcnt(0)
    v_bitop3_b32 v1, 1, v176, v178 bitop3:0x80
    v_bitop3_b32 v1, v1, v180, v182 bitop3:0x80
    v_bitop3_b32 v1, v1, v184, v186 bitop3:0x80
    v_bitop3_b32 v1, v1, v188, v190 bitop3:0x80
    v_cmp_eq_u32 vcc, 0, v1
    s_cbranch_vccz L_fresh_54
    s_cmp_lt_u32 s50, 0x40000
    s_cbranch_scc1 L_again_53_a
    s_branch L_fresh_54
L_again_55:
    s_mov_b32 s50, 0
L_again_55_a:
    buffer_load_dwordx4 v[100:103], v3, s[16:19], s62 offen sc1
    buffer_load_dwordx4 v[116:119], v3, s[16:19], s63 offen sc1
    buffer_load_dwordx4 v[196:199], v3, s[16:19], s64 offen sc1
    buffer_load_dwordx4 v[212:215], v3, s[16:19], s65 offen sc1
    buffer_load_dwordx2 v[244:245], v7, s[16:19], s66 offen sc1
    buffer_load_dwordx2 v[246:247], v7, s[16:19], s67 offen sc1
    s_add_u32 s50, s50, 1
    s_waitcnt vmcnt(0)
    v_bitop3_b32 v1, 1, v100, v116 bitop3:0x80
    v_bitop3_b32 v1, v1, v196, v212 bitop3:0x80
    v_bitop3_b32 v1, v1, v244, v246 bitop3:0x80
    v_cmp_eq_u32 vcc, 0, v1
    s_cbranch_vccz L_fresh_56
    s_cmp_lt_u32 s50, 0x40000
    s_cbranch_scc1 L_again_55_a
    s_branch L_fresh_56
L_again_57:
    s_mov_b32 s50, 0
L_again_57_a:
    buffer_load_dwordx4 v[104:107], v4, s[16:19], s62 offen sc1
    buffer_load_dwordx4 v[120:123], v4, s[16:19], s63 offen sc1
    buffer_load_dwordx4 v[200:203], v4, s[16:19], s64 offen sc1
    buffer_load_dwordx4 v[216:219], v4, s[16:19], s65 offen sc1
    buffer_load_dwordx2 v[248:249], v8, s[16:19], s66 offen sc1
    buffer_load_dwordx2 v[250:251], v8, s[16:19], s67 offen sc1
    s_add_u32 s50, s50, 1
    s_waitcnt vmcnt(0)
    v_bitop3_b32 v1, 1, v104, v120 bitop3:0x80
    v_bitop3_b32 v1, v1, v200, v216 bitop3:0x80
    v_bitop3_b32 v1, v1, v248, v250 bitop3:0x80
    v_cmp_eq_u32 vcc, 0, v1
    s_cbranch_vccz L_fresh_58
    s_cmp_lt_u32 s50, 0x40000
    s_cbranch_scc1 L_again_57_a
    s_branch L_fresh_58
L_again_59:
    s_mov_b32 s50, 0
L_again_59_a:
    buffer_load_dwordx4 v[108:111], v5, s[16:19], s62 offen sc1
    buffer_load_dwordx4 v[124:127], v5, s[16:19], s63 offen sc1
    buffer_load_dwordx4 v[204:207], v5, s[16:19], s64 offen sc1
    buffer_load_dwordx4 v[220:223], v5, s[16:19], s65 offen sc1
    buffer_load_dwordx2 v[252:253], v9, s[16:19], s66 offen sc1
    buffer_load_dwordx2 v[254:255], v9, s[16:19], s67 offen sc1
    s_add_u32 s50, s50, 1
    s_waitcnt vmcnt(0)
    v_bitop3_b32 v1, 1, v108, v124 bitop3:0x80
    v_bitop3_b32 v1, v1, v204, v220 bitop3:0x80
    v_bitop3_b32 v1, v1, v252, v254 bitop3:0x80
    v_cmp_eq_u32 vcc, 0, v1
    s_cbranch_vccz L_fresh_60
    s_cmp_lt_u32 s50, 0x40000
    s_cbranch_scc1 L_again_59_a
    s_branch L_fresh_60
L_again_61:
    s_mov_b32 s50, 0
L_again_61_a:
    buffer_load_dwordx4 v[96:99], v2, s[16:19], s62 offen sc1
    buffer_load_dwordx4 v[112:115], v2, s[16:19], s63 offen sc1
    buffer_load_dwordx4 v[192:195], v2, s[16:19], s64 offen sc1
    buffer_load_dwordx4 v[208:211], v2, s[16:19], s65 offen sc1
    buffer_load_dwordx2 v[240:241], v6, s[16:19], s66 offen sc1
    buffer_load_dwordx2 v[242:243], v6, s[16:19], s67 offen sc1
    s_add_u32 s50, s50, 1
    s_waitcnt vmcnt(0)
    v_bitop3_b32 v1, 1, v96, v112 bitop3:0x80
    v_bitop3_b32 v1, v1, v192, v208 bitop3:0x80
    v_bitop3_b32 v1, v1, v240, v242 bitop3:0x80
    v_cmp_eq_u32 vcc, 0, v1
    s_cbranch_vccz L_fresh_62
    s_cmp_lt_u32 s50, 0x40000
    s_cbranch_scc1 L_again_61_a
    s_branch L_fresh_62
L_poll_63:
    s_mov_b32 s50, 0
L_poll_63_a:
    buffer_load_dword v19, v27, s[24:27], 0 offen offset:0 sc1
    s_add_u32 s50, s50, 1
    s_waitcnt vmcnt(0)
    v_cmp_ne_u32 vcc, 1, v19
    s_cbranch_vccz L_back_64
    s_cmp_lt_u32 s50, 0x40000
    s_cbranch_scc1 L_poll_63_a
    s_branch L_back_64
L_poll_65:
    s_mov_b32 s50, 0
L_poll_65_a:
    buffer_load_dword v19, v28, s[16:19], s96 offen offset:0 sc1
    s_add_u32 s50, s50, 1
    s_waitcnt vmcnt(0)
    v_cmp_ne_u32 vcc, 1, v19
    s_cbranch_vccz L_back_66
    s_cmp_lt_u32 s50, 0x40000
    s_cbranch_scc1 L_poll_65_a
    s_branch L_back_66
L_end:
    s_endpgm
L_truemax:
    s_lshr_b32 s38, s49, 5
    s_sub_u32 s38, 8, s38
    s_nop 7
    v_mov_b32 v24, 0xff800000
    v_mov_b32 v224, 0
    v_mov_b32 v225, 0
    v_mov_b32 v226, 0
    v_mov_b32 v227, 0
    v_mov_b32 v228, 0
    v_mov_b32 v229, 0
    v_mov_b32 v230, 0
    v_mov_b32 v231, 0
    v_mov_b32 v232, 0
    v_mov_b32 v233, 0
    v_mov_b32 v234, 0
    v_mov_b32 v235, 0
    v_mov_b32 v236, 0
    v_mov_b32 v237, 0
    v_mov_b32 v238, 0
    v_mov_b32 v239, 0
    s_cmp_gt_i32 s38, 0
    s_cbranch_scc1 L_skip_9
    ds_read_b128 a[200:203], v34 offset:0
    ds_read_b64 a[208:209], v9 offset:0
    s_waitcnt lgkmcnt(1)
    v_mfma_f32_32x32x16_bf16 v[64:79], a[200:203], v[96:99], v[80:95]
    s_waitcnt lgkmcnt(0)
    v_mfma_f32_32x32x16_bf16 v[64:79], a[208:211], v[104:107], v[64:79]
    s_nop 11
    v_max3_f32 v24, v24, v64, v65
    v_max3_f32 v24, v24, v66, v67
    v_max3_f32 v24, v24, v68, v69
    v_max3_f32 v24, v24, v70, v71
    v_max3_f32 v24, v24, v72, v73
    v_max3_f32 v24, v24, v74, v75
    v_max3_f32 v24, v24, v76, v77
    v_max3_f32 v24, v24, v78, v79
L_skip_9:
    s_cmp_gt_i32 s38, 1
    s_cbranch_scc1 L_skip_10
    ds_read_b128 a[200:203], v34 offset:512
    ds_read_b64 a[208:209], v9 offset:0
    s_waitcnt lgkmcnt(1)
    v_mfma_f32_32x32x16_bf16 v[64:79], a[200:203], v[96:99], 0
    s_waitcnt lgkmcnt(0)
    v_mfma_f32_32x32x16_bf16 v[64:79], a[208:211], v[106:109], v[64:79]
    s_nop 11
    v_max3_f32 v24, v24, v64, v65
    v_max3_f32 v24, v24, v66, v67
    v_max3_f32 v24, v24, v68, v69
    v_max3_f32 v24, v24, v70, v71
    v_max3_f32 v24, v24, v72, v73
    v_max3_f32 v24, v24, v74, v75
    v_max3_f32 v24, v24, v76, v77
    v_max3_f32 v24, v24, v78, v79
L_skip_10:
    s_cmp_gt_i32 s38, 2
    s_cbranch_scc1 L_skip_11
    ds_read_b128 a[200:203], v34 offset:1024
    ds_read_b64 a[208:209], v9 offset:1024
    s_waitcnt lgkmcnt(1)
    v_mfma_f32_32x32x16_bf16 v[64:79], a[200:203], v[96:99], 0
    s_waitcnt lgkmcnt(0)
    v_mfma_f32_32x32x16_bf16 v[64:79], a[208:211], v[104:107], v[64:79]
    s_nop 11
    v_max3_f32 v24, v24, v64, v65
    v_max3_f32 v24, v24, v66, v67
    v_max3_f32 v24, v24, v68, v69
    v_max3_f32 v24, v24, v70, v71
    v_max3_f32 v24, v24, v72, v73
    v_max3_f32 v24, v24, v74, v75
    v_max3_f32 v24, v24, v76, v77
    v_max3_f32 v24, v24, v78, v79
L_skip_11:
    s_cmp_gt_i32 s38, 3
    s_cbranch_scc1 L_skip_12
    ds_read_b128 a[200:203], v34 offset:1536
    ds_read_b64 a[208:209], v9 offset:1024
    s_waitcnt lgkmcnt(1)
    v_mfma_f32_32x32x16_bf16 v[64:79], a[200:203], v[96:99], 0
    s_waitcnt lgkmcnt(0)
    v_mfma_f32_32x32x16_bf16 v[64:79], a[208:211], v[106:109], v[64:79]
    s_nop 11
    v_max3_f32 v24, v24, v64, v65
    v_max3_f32 v24, v24, v66, v67
    v_max3_f32 v24, v24, v68, v69
    v_max3_f32 v24, v24, v70, v71
    v_max3_f32 v24, v24, v72, v73
    v_max3_f32 v24, v24, v74, v75
    v_max3_f32 v24, v24, v76, v77
    v_max3_f32 v24, v24, v78, v79
L_skip_12:
    s_cmp_gt_i32 s38, 4
    s_cbranch_scc1 L_skip_13
    ds_read_b128 a[200:203], v34 offset:2048
    ds_read_b64 a[208:209], v9 offset:2048
    s_waitcnt lgkmcnt(1)
    v_mfma_f32_32x32x16_bf16 v[64:79], a[200:203], v[96:99], 0
    s_waitcnt lgkmcnt(0)
    v_mfma_f32_32x32x16_bf16 v[64:79], a[208:211], v[104:107], v[64:79]
    s_nop 11
    v_max3_f32 v24, v24, v64, v65
    v_max3_f32 v24, v24, v66, v67
    v_max3_f32 v24, v24, v68, v69
    v_max3_f32 v24, v24, v70, v71
    v_max3_f32 v24, v24, v72, v73
    v_max3_f32 v24, v24, v74, v75
    v_max3_f32 v24, v24, v76, v77
    v_max3_f32 v24, v24, v78, v79
L_skip_13:
    s_cmp_gt_i32 s38, 5
    s_cbranch_scc1 L_skip_14
    ds_read_b128 a[200:203], v34 offset:2560
    ds_read_b64 a[208:209], v9 offset:2048
    s_waitcnt lgkmcnt(1)
    v_mfma_f32_32x32x16_bf16 v[64:79], a[200:203], v[96:99], 0
    s_waitcnt lgkmcnt(0)
    v_mfma_f32_32x32x16_bf16 v[64:79], a[208:211], v[106:109], v[64:79]
    s_nop 11
    v_max3_f32 v24, v24, v64, v65
    v_max3_f32 v24, v24, v66, v67
    v_max3_f32 v24, v24, v68, v69
    v_max3_f32 v24, v24, v70, v71
    v_max3_f32 v24, v24, v72, v73
    v_max3_f32 v24, v24, v74, v75
    v_max3_f32 v24, v24, v76, v77
    v_max3_f32 v24, v24, v78, v79
L_skip_14:
    s_cmp_gt_i32 s38, 6
    s_cbranch_scc1 L_skip_15
    ds_read_b128 a[200:203], v34 offset:3072
    ds_read_b64 a[208:209], v9 offset:3072
    s_waitcnt lgkmcnt(1)
    v_mfma_f32_32x32x16_bf16 v[64:79], a[200:203], v[96:99], 0
    s_waitcnt lgkmcnt(0)
    v_mfma_f32_32x32x16_bf16 v[64:79], a[208:211], v[104:107], v[64:79]
    s_nop 11
    v_max3_f32 v24, v24, v64, v65
    v_max3_f32 v24, v24, v66, v67
    v_max3_f32 v24, v24, v68, v69
    v_max3_f32 v24, v24, v70, v71
    v_max3_f32 v24, v24, v72, v73
    v_max3_f32 v24, v24, v74, v75
    v_max3_f32 v24, v24, v76, v77
    v_max3_f32 v24, v24, v78, v79
L_skip_15:
    s_cmp_gt_i32 s38, 7
    s_cbranch_scc1 L_skip_16
    ds_read_b128 a[200:203], v34 offset:3584
    ds_read_b64 a[208:209], v9 offset:3072
    s_waitcnt lgkmcnt(1)
    v_mfma_f32_32x32x16_bf16 v[64:79], a[200:203], v[96:99], 0
    s_waitcnt lgkmcnt(0)
    v_mfma_f32_32x32x16_bf16 v[64:79], a[208:211], v[106:109], v[64:79]
    s_nop 11
    v_max3_f32 v24, v24, v64, v65
    v_max3_f32 v24, v24, v66, v67
    v_max3_f32 v24, v24, v68, v69
    v_max3_f32 v24, v24, v70, v71
    v_max3_f32 v24, v24, v72, v73
    v_max3_f32 v24, v24, v74, v75
    v_max3_f32 v24, v24, v76, v77
    v_max3_f32 v24, v24, v78, v79
L_skip_16:
    s_cmp_gt_i32 s38, 8
    s_cbranch_scc1 L_skip_17
    ds_read_b128 a[200:203], v34 offset:4096
    ds_read_b64 a[208:209], v9 offset:4096
    s_waitcnt lgkmcnt(1)
    v_mfma_f32_32x32x16_bf16 v[64:79], a[200:203], v[96:99], v[208:223]
    s_waitcnt lgkmcnt(0)
    v_mfma_f32_32x32x16_bf16 v[64:79], a[208:211], v[104:107], v[64:79]
    s_nop 11
    v_max3_f32 v24, v24, v64, v65
    v_max3_f32 v24, v24, v66, v67
    v_max3_f32 v24, v24, v68, v69
    v_max3_f32 v24, v24, v70, v71
    v_max3_f32 v24, v24, v72, v73
    v_max3_f32 v24, v24, v74, v75
    v_max3_f32 v24, v24, v76, v77
    v_max3_f32 v24, v24, v78, v79
L_skip_17:
    s_nop 1
    v_mov_b32 v25, v24
    s_nop 1
    v_permlane32_swap_b32 v24, v25
    v_max_f32 v24, v24, v25
    s_cmp_gt_i32 s38, 0
    s_cbranch_scc1 L_skip_18
    ds_read_b64_tr_b16 a[216:217], v35 offset:0
    ds_read_b64_tr_b16 a[218:219], v35 offset:128
    ds_read_b64_tr_b16 a[220:221], v35 offset:256
    ds_read_b64_tr_b16 a[222:223], v35 offset:384
    ds_read_b128 a[200:203], v34 offset:0
    ds_read_b64 a[208:209], v9 offset:0
    s_waitcnt lgkmcnt(1)
    v_mfma_f32_32x32x16_bf16 v[64:79], a[200:203], v[96:99], v[80:95]
    s_waitcnt lgkmcnt(0)
    v_mfma_f32_32x32x16_bf16 v[64:79], a[208:211], v[104:107], v[64:79]
    s_nop 11
    v_sub_f32 v64, v64, v24
    v_sub_f32 v65, v65, v24
    v_sub_f32 v66, v66, v24
    v_sub_f32 v67, v67, v24
    v_sub_f32 v68, v68, v24
    v_sub_f32 v69, v69, v24
    v_sub_f32 v70, v70, v24
    v_sub_f32 v71, v71, v24
    v_sub_f32 v72, v72, v24
    v_sub_f32 v73, v73, v24
    v_sub_f32 v74, v74, v24
    v_sub_f32 v75, v75, v24
    v_sub_f32 v76, v76, v24
    v_sub_f32 v77, v77, v24
    v_sub_f32 v78, v78, v24
    v_sub_f32 v79, v79, v24
    v_exp_f32 v64, v64
    v_exp_f32 v65, v65
    v_exp_f32 v66, v66
    v_exp_f32 v67, v67
    v_exp_f32 v68, v68
    v_exp_f32 v69, v69
    v_exp_f32 v70, v70
    v_exp_f32 v71, v71
    v_exp_f32 v72, v72
    v_exp_f32 v73, v73
    v_exp_f32 v74, v74
    v_exp_f32 v75, v75
    v_exp_f32 v76, v76
    v_exp_f32 v77, v77
    v_exp_f32 v78, v78
    v_exp_f32 v79, v79
    v_cvt_pk_bf16_f32 v56, v64, v65
    v_cvt_pk_bf16_f32 v57, v66, v67
    v_cvt_pk_bf16_f32 v58, v68, v69
    v_cvt_pk_bf16_f32 v59, v70, v71
    v_cvt_pk_bf16_f32 v60, v72, v73
    v_cvt_pk_bf16_f32 v61, v74, v75
    v_cvt_pk_bf16_f32 v62, v76, v77
    v_cvt_pk_bf16_f32 v63, v78, v79
    v_mfma_f32_32x32x16_bf16 v[224:239], a[216:219], v[56:59], v[224:239]
    s_nop 0
    v_mfma_f32_32x32x16_bf16 v[224:239], a[220:223], v[60:63], v[224:239]
    s_nop 7
L_skip_18:
    s_cmp_gt_i32 s38, 1
    s_cbranch_scc1 L_skip_19
    ds_read_b64_tr_b16 a[216:217], v35 offset:512
    ds_read_b64_tr_b16 a[218:219], v35 offset:640
    ds_read_b64_tr_b16 a[220:221], v35 offset:768
    ds_read_b64_tr_b16 a[222:223], v35 offset:896
    ds_read_b128 a[200:203], v34 offset:512
    ds_read_b64 a[208:209], v9 offset:0
    s_waitcnt lgkmcnt(1)
    v_mfma_f32_32x32x16_bf16 v[64:79], a[200:203], v[96:99], 0
    s_waitcnt lgkmcnt(0)
    v_mfma_f32_32x32x16_bf16 v[64:79], a[208:211], v[106:109], v[64:79]
    s_nop 11
    v_sub_f32 v64, v64, v24
    v_sub_f32 v65, v65, v24
    v_sub_f32 v66, v66, v24
    v_sub_f32 v67, v67, v24
    v_sub_f32 v68, v68, v24
    v_sub_f32 v69, v69, v24
    v_sub_f32 v70, v70, v24
    v_sub_f32 v71, v71, v24
    v_sub_f32 v72, v72, v24
    v_sub_f32 v73, v73, v24
    v_sub_f32 v74, v74, v24
    v_sub_f32 v75, v75, v24
    v_sub_f32 v76, v76, v24
    v_sub_f32 v77, v77, v24
    v_sub_f32 v78, v78, v24
    v_sub_f32 v79, v79, v24
    v_exp_f32 v64, v64
    v_exp_f32 v65, v65
    v_exp_f32 v66, v66
    v_exp_f32 v67, v67
    v_exp_f32 v68, v68
    v_exp_f32 v69, v69
    v_exp_f32 v70, v70
    v_exp_f32 v71, v71
    v_exp_f32 v72, v72
    v_exp_f32 v73, v73
    v_exp_f32 v74, v74
    v_exp_f32 v75, v75
    v_exp_f32 v76, v76
    v_exp_f32 v77, v77
    v_exp_f32 v78, v78
    v_exp_f32 v79, v79
    v_cvt_pk_bf16_f32 v56, v64, v65
    v_cvt_pk_bf16_f32 v57, v66, v67
    v_cvt_pk_bf16_f32 v58, v68, v69
    v_cvt_pk_bf16_f32 v59, v70, v71
    v_cvt_pk_bf16_f32 v60, v72, v73
    v_cvt_pk_bf16_f32 v61, v74, v75
    v_cvt_pk_bf16_f32 v62, v76, v77
    v_cvt_pk_bf16_f32 v63, v78, v79
    v_mfma_f32_32x32x16_bf16 v[224:239], a[216:219], v[56:59], v[224:239]
    s_nop 0
    v_mfma_f32_32x32x16_bf16 v[224:239], a[220:223], v[60:63], v[224:239]
    s_nop 7
L_skip_19:
    s_cmp_gt_i32 s38, 2
    s_cbranch_scc1 L_skip_20
    ds_read_b64_tr_b16 a[216:217], v35 offset:1024
    ds_read_b64_tr_b16 a[218:219], v35 offset:1152
    ds_read_b64_tr_b16 a[220:221], v35 offset:1280
    ds_read_b64_tr_b16 a[222:223], v35 offset:1408
    ds_read_b128 a[200:203], v34 offset:1024
    ds_read_b64 a[208:209], v9 offset:1024
    s_waitcnt lgkmcnt(1)
    v_mfma_f32_32x32x16_bf16 v[64:79], a[200:203], v[96:99], 0
    s_waitcnt lgkmcnt(0)
    v_mfma_f32_32x32x16_bf16 v[64:79], a[208:211], v[104:107], v[64:79]
    s_nop 11
    v_sub_f32 v64, v64, v24
    v_sub_f32 v65, v65, v24
    v_sub_f32 v66, v66, v24
    v_sub_f32 v67, v67, v24
    v_sub_f32 v68, v68, v24
    v_sub_f32 v69, v69, v24
    v_sub_f32 v70, v70, v24
    v_sub_f32 v71, v71, v24
    v_sub_f32 v72, v72, v24
    v_sub_f32 v73, v73, v24
    v_sub_f32 v74, v74, v24
    v_sub_f32 v75, v75, v24
    v_sub_f32 v76, v76, v24
    v_sub_f32 v77, v77, v24
    v_sub_f32 v78, v78, v24
    v_sub_f32 v79, v79, v24
    v_exp_f32 v64, v64
    v_exp_f32 v65, v65
    v_exp_f32 v66, v66
    v_exp_f32 v67, v67
    v_exp_f32 v68, v68
    v_exp_f32 v69, v69
    v_exp_f32 v70, v70
    v_exp_f32 v71, v71
    v_exp_f32 v72, v72
    v_exp_f32 v73, v73
    v_exp_f32 v74, v74
    v_exp_f32 v75, v75
    v_exp_f32 v76, v76
    v_exp_f32 v77, v77
    v_exp_f32 v78, v78
    v_exp_f32 v79, v79
    v_cvt_pk_bf16_f32 v56, v64, v65
    v_cvt_pk_bf16_f32 v57, v66, v67
    v_cvt_pk_bf16_f32 v58, v68, v69
    v_cvt_pk_bf16_f32 v59, v70, v71
    v_cvt_pk_bf16_f32 v60, v72, v73
    v_cvt_pk_bf16_f32 v61, v74, v75
    v_cvt_pk_bf16_f32 v62, v76, v77
    v_cvt_pk_bf16_f32 v63, v78, v79
    v_mfma_f32_32x32x16_bf16 v[224:239], a[216:219], v[56:59], v[224:239]
    s_nop 0
    v_mfma_f32_32x32x16_bf16 v[224:239], a[220:223], v[60:63], v[224:239]
    s_nop 7
L_skip_20:
    s_cmp_gt_i32 s38, 3
    s_cbranch_scc1 L_skip_21
    ds_read_b64_tr_b16 a[216:217], v35 offset:1536
    ds_read_b64_tr_b16 a[218:219], v35 offset:1664
    ds_read_b64_tr_b16 a[220:221], v35 offset:1792
    ds_read_b64_tr_b16 a[222:223], v35 offset:1920
    ds_read_b128 a[200:203], v34 offset:1536
    ds_read_b64 a[208:209], v9 offset:1024
    s_waitcnt lgkmcnt(1)
    v_mfma_f32_32x32x16_bf16 v[64:79], a[200:203], v[96:99], 0
    s_waitcnt lgkmcnt(0)
    v_mfma_f32_32x32x16_bf16 v[64:79], a[208:211], v[106:109], v[64:79]
    s_nop 11
    v_sub_f32 v64, v64, v24
    v_sub_f32 v65, v65, v24
    v_sub_f32 v66, v66, v24
    v_sub_f32 v67, v67, v24
    v_sub_f32 v68, v68, v24
    v_sub_f32 v69, v69, v24
    v_sub_f32 v70, v70, v24
    v_sub_f32 v71, v71, v24
    v_sub_f32 v72, v72, v24
    v_sub_f32 v73, v73, v24
    v_sub_f32 v74, v74, v24
    v_sub_f32 v75, v75, v24
    v_sub_f32 v76, v76, v24
    v_sub_f32 v77, v77, v24
    v_sub_f32 v78, v78, v24
    v_sub_f32 v79, v79, v24
    v_exp_f32 v64, v64
    v_exp_f32 v65, v65
    v_exp_f32 v66, v66
    v_exp_f32 v67, v67
    v_exp_f32 v68, v68
    v_exp_f32 v69, v69
    v_exp_f32 v70, v70
    v_exp_f32 v71, v71
    v_exp_f32 v72, v72
    v_exp_f32 v73, v73
    v_exp_f32 v74, v74
    v_exp_f32 v75, v75
    v_exp_f32 v76, v76
    v_exp_f32 v77, v77
    v_exp_f32 v78, v78
    v_exp_f32 v79, v79
    v_cvt_pk_bf16_f32 v56, v64, v65
    v_cvt_pk_bf16_f32 v57, v66, v67
    v_cvt_pk_bf16_f32 v58, v68, v69
    v_cvt_pk_bf16_f32 v59, v70, v71
    v_cvt_pk_bf16_f32 v60, v72, v73
    v_cvt_pk_bf16_f32 v61, v74, v75
    v_cvt_pk_bf16_f32 v62, v76, v77
    v_cvt_pk_bf16_f32 v63, v78, v79
    v_mfma_f32_32x32x16_bf16 v[224:239], a[216:219], v[56:59], v[224:239]
    s_nop 0
    v_mfma_f32_32x32x16_bf16 v[224:239], a[220:223], v[60:63], v[224:239]
    s_nop 7
L_skip_21:
    s_cmp_gt_i32 s38, 4
    s_cbranch_scc1 L_skip_22
    ds_read_b64_tr_b16 a[216:217], v35 offset:2048
    ds_read_b64_tr_b16 a[218:219], v35 offset:2176
    ds_read_b64_tr_b16 a[220:221], v35 offset:2304
    ds_read_b64_tr_b16 a[222:223], v35 offset:2432
    ds_read_b128 a[200:203], v34 offset:2048
    ds_read_b64 a[208:209], v9 offset:2048
    s_waitcnt lgkmcnt(1)
    v_mfma_f32_32x32x16_bf16 v[64:79], a[200:203], v[96:99], 0
    s_waitcnt lgkmcnt(0)
    v_mfma_f32_32x32x16_bf16 v[64:79], a[208:211], v[104:107], v[64:79]
    s_nop 11
    v_sub_f32 v64, v64, v24
    v_sub_f32 v65, v65, v24
    v_sub_f32 v66, v66, v24
    v_sub_f32 v67, v67, v24
    v_sub_f32 v68, v68, v24
    v_sub_f32 v69, v69, v24
    v_sub_f32 v70, v70, v24
    v_sub_f32 v71, v71, v24
    v_sub_f32 v72, v72, v24
    v_sub_f32 v73, v73, v24
    v_sub_f32 v74, v74, v24
    v_sub_f32 v75, v75, v24
    v_sub_f32 v76, v76, v24
    v_sub_f32 v77, v77, v24
    v_sub_f32 v78, v78, v24
    v_sub_f32 v79, v79, v24
    v_exp_f32 v64, v64
    v_exp_f32 v65, v65
    v_exp_f32 v66, v66
    v_exp_f32 v67, v67
    v_exp_f32 v68, v68
    v_exp_f32 v69, v69
    v_exp_f32 v70, v70
    v_exp_f32 v71, v71
    v_exp_f32 v72, v72
    v_exp_f32 v73, v73
    v_exp_f32 v74, v74
    v_exp_f32 v75, v75
    v_exp_f32 v76, v76
    v_exp_f32 v77, v77
    v_exp_f32 v78, v78
    v_exp_f32 v79, v79
    v_cvt_pk_bf16_f32 v56, v64, v65
    v_cvt_pk_bf16_f32 v57, v66, v67
    v_cvt_pk_bf16_f32 v58, v68, v69
    v_cvt_pk_bf16_f32 v59, v70, v71
    v_cvt_pk_bf16_f32 v60, v72, v73
    v_cvt_pk_bf16_f32 v61, v74, v75
    v_cvt_pk_bf16_f32 v62, v76, v77
    v_cvt_pk_bf16_f32 v63, v78, v79
    v_mfma_f32_32x32x16_bf16 v[224:239], a[216:219], v[56:59], v[224:239]
    s_nop 0
    v_mfma_f32_32x32x16_bf16 v[224:239], a[220:223], v[60:63], v[224:239]
    s_nop 7
L_skip_22:
    s_cmp_gt_i32 s38, 5
    s_cbranch_scc1 L_skip_23
    ds_read_b64_tr_b16 a[216:217], v35 offset:2560
    ds_read_b64_tr_b16 a[218:219], v35 offset:2688
    ds_read_b64_tr_b16 a[220:221], v35 offset:2816
    ds_read_b64_tr_b16 a[222:223], v35 offset:2944
    ds_read_b128 a[200:203], v34 offset:2560
    ds_read_b64 a[208:209], v9 offset:2048
    s_waitcnt lgkmcnt(1)
    v_mfma_f32_32x32x16_bf16 v[64:79], a[200:203], v[96:99], 0
    s_waitcnt lgkmcnt(0)
    v_mfma_f32_32x32x16_bf16 v[64:79], a[208:211], v[106:109], v[64:79]
    s_nop 11
    v_sub_f32 v64, v64, v24
    v_sub_f32 v65, v65, v24
    v_sub_f32 v66, v66, v24
    v_sub_f32 v67, v67, v24
    v_sub_f32 v68, v68, v24
    v_sub_f32 v69, v69, v24
    v_sub_f32 v70, v70, v24
    v_sub_f32 v71, v71, v24
    v_sub_f32 v72, v72, v24
    v_sub_f32 v73, v73, v24
    v_sub_f32 v74, v74, v24
    v_sub_f32 v75, v75, v24
    v_sub_f32 v76, v76, v24
    v_sub_f32 v77, v77, v24
    v_sub_f32 v78, v78, v24
    v_sub_f32 v79, v79, v24
    v_exp_f32 v64, v64
    v_exp_f32 v65, v65
    v_exp_f32 v66, v66
    v_exp_f32 v67, v67
    v_exp_f32 v68, v68
    v_exp_f32 v69, v69
    v_exp_f32 v70, v70
    v_exp_f32 v71, v71
    v_exp_f32 v72, v72
    v_exp_f32 v73, v73
    v_exp_f32 v74, v74
    v_exp_f32 v75, v75
    v_exp_f32 v76, v76
    v_exp_f32 v77, v77
    v_exp_f32 v78, v78
    v_exp_f32 v79, v79
    v_cvt_pk_bf16_f32 v56, v64, v65
    v_cvt_pk_bf16_f32 v57, v66, v67
    v_cvt_pk_bf16_f32 v58, v68, v69
    v_cvt_pk_bf16_f32 v59, v70, v71
    v_cvt_pk_bf16_f32 v60, v72, v73
    v_cvt_pk_bf16_f32 v61, v74, v75
    v_cvt_pk_bf16_f32 v62, v76, v77
    v_cvt_pk_bf16_f32 v63, v78, v79
    v_mfma_f32_32x32x16_bf16 v[224:239], a[216:219], v[56:59], v[224:239]
    s_nop 0
    v_mfma_f32_32x32x16_bf16 v[224:239], a[220:223], v[60:63], v[224:239]
    s_nop 7
L_skip_23:
    s_cmp_gt_i32 s38, 6
    s_cbranch_scc1 L_skip_24
    ds_read_b64_tr_b16 a[216:217], v35 offset:3072
    ds_read_b64_tr_b16 a[218:219], v35 offset:3200
    ds_read_b64_tr_b16 a[220:221], v35 offset:3328
    ds_read_b64_tr_b16 a[222:223], v35 offset:3456
    ds_read_b128 a[200:203], v34 offset:3072
    ds_read_b64 a[208:209], v9 offset:3072
    s_waitcnt lgkmcnt(1)
    v_mfma_f32_32x32x16_bf16 v[64:79], a[200:203], v[96:99], 0
    s_waitcnt lgkmcnt(0)
    v_mfma_f32_32x32x16_bf16 v[64:79], a[208:211], v[104:107], v[64:79]
    s_nop 11
    v_sub_f32 v64, v64, v24
    v_sub_f32 v65, v65, v24
    v_sub_f32 v66, v66, v24
    v_sub_f32 v67, v67, v24
    v_sub_f32 v68, v68, v24
    v_sub_f32 v69, v69, v24
    v_sub_f32 v70, v70, v24
    v_sub_f32 v71, v71, v24
    v_sub_f32 v72, v72, v24
    v_sub_f32 v73, v73, v24
    v_sub_f32 v74, v74, v24
    v_sub_f32 v75, v75, v24
    v_sub_f32 v76, v76, v24
    v_sub_f32 v77, v77, v24
    v_sub_f32 v78, v78, v24
    v_sub_f32 v79, v79, v24
    v_exp_f32 v64, v64
    v_exp_f32 v65, v65
    v_exp_f32 v66, v66
    v_exp_f32 v67, v67
    v_exp_f32 v68, v68
    v_exp_f32 v69, v69
    v_exp_f32 v70, v70
    v_exp_f32 v71, v71
    v_exp_f32 v72, v72
    v_exp_f32 v73, v73
    v_exp_f32 v74, v74
    v_exp_f32 v75, v75
    v_exp_f32 v76, v76
    v_exp_f32 v77, v77
    v_exp_f32 v78, v78
    v_exp_f32 v79, v79
    v_cvt_pk_bf16_f32 v56, v64, v65
    v_cvt_pk_bf16_f32 v57, v66, v67
    v_cvt_pk_bf16_f32 v58, v68, v69
    v_cvt_pk_bf16_f32 v59, v70, v71
    v_cvt_pk_bf16_f32 v60, v72, v73
    v_cvt_pk_bf16_f32 v61, v74, v75
    v_cvt_pk_bf16_f32 v62, v76, v77
    v_cvt_pk_bf16_f32 v63, v78, v79
    v_mfma_f32_32x32x16_bf16 v[224:239], a[216:219], v[56:59], v[224:239]
    s_nop 0
    v_mfma_f32_32x32x16_bf16 v[224:239], a[220:223], v[60:63], v[224:239]
    s_nop 7
L_skip_24:
    s_cmp_gt_i32 s38, 7
    s_cbranch_scc1 L_skip_25
    ds_read_b64_tr_b16 a[216:217], v35 offset:3584
    ds_read_b64_tr_b16 a[218:219], v35 offset:3712
    ds_read_b64_tr_b16 a[220:221], v35 offset:3840
    ds_read_b64_tr_b16 a[222:223], v35 offset:3968
    ds_read_b128 a[200:203], v34 offset:3584
    ds_read_b64 a[208:209], v9 offset:3072
    s_waitcnt lgkmcnt(1)
    v_mfma_f32_32x32x16_bf16 v[64:79], a[200:203], v[96:99], 0
    s_waitcnt lgkmcnt(0)
    v_mfma_f32_32x32x16_bf16 v[64:79], a[208:211], v[106:109], v[64:79]
    s_nop 11
    v_sub_f32 v64, v64, v24
    v_sub_f32 v65, v65, v24
    v_sub_f32 v66, v66, v24
    v_sub_f32 v67, v67, v24
    v_sub_f32 v68, v68, v24
    v_sub_f32 v69, v69, v24
    v_sub_f32 v70, v70, v24
    v_sub_f32 v71, v71, v24
    v_sub_f32 v72, v72, v24
    v_sub_f32 v73, v73, v24
    v_sub_f32 v74, v74, v24
    v_sub_f32 v75, v75, v24
    v_sub_f32 v76, v76, v24
    v_sub_f32 v77, v77, v24
    v_sub_f32 v78, v78, v24
    v_sub_f32 v79, v79, v24
    v_exp_f32 v64, v64
    v_exp_f32 v65, v65
    v_exp_f32 v66, v66
    v_exp_f32 v67, v67
    v_exp_f32 v68, v68
    v_exp_f32 v69, v69
    v_exp_f32 v70, v70
    v_exp_f32 v71, v71
    v_exp_f32 v72, v72
    v_exp_f32 v73, v73
    v_exp_f32 v74, v74
    v_exp_f32 v75, v75
    v_exp_f32 v76, v76
    v_exp_f32 v77, v77
    v_exp_f32 v78, v78
    v_exp_f32 v79, v79
    v_cvt_pk_bf16_f32 v56, v64, v65
    v_cvt_pk_bf16_f32 v57, v66, v67
    v_cvt_pk_bf16_f32 v58, v68, v69
    v_cvt_pk_bf16_f32 v59, v70, v71
    v_cvt_pk_bf16_f32 v60, v72, v73
    v_cvt_pk_bf16_f32 v61, v74, v75
    v_cvt_pk_bf16_f32 v62, v76, v77
    v_cvt_pk_bf16_f32 v63, v78, v79
    v_mfma_f32_32x32x16_bf16 v[224:239], a[216:219], v[56:59], v[224:239]
    s_nop 0
    v_mfma_f32_32x32x16_bf16 v[224:239], a[220:223], v[60:63], v[224:239]
    s_nop 7
L_skip_25:
    s_cmp_gt_i32 s38, 8
    s_cbranch_scc1 L_skip_26
    ds_read_b64_tr_b16 a[216:217], v35 offset:4096
    ds_read_b64_tr_b16 a[218:219], v35 offset:4224
    ds_read_b64_tr_b16 a[220:221], v35 offset:4352
    ds_read_b64_tr_b16 a[222:223], v35 offset:4480
    ds_read_b128 a[200:203], v34 offset:4096
    ds_read_b64 a[208:209], v9 offset:4096
    s_waitcnt lgkmcnt(1)
    v_mfma_f32_32x32x16_bf16 v[64:79], a[200:203], v[96:99], v[208:223]
    s_waitcnt lgkmcnt(0)
    v_mfma_f32_32x32x16_bf16 v[64:79], a[208:211], v[104:107], v[64:79]
    s_nop 11
    v_sub_f32 v64, v64, v24
    v_sub_f32 v65, v65, v24
    v_sub_f32 v66, v66, v24
    v_sub_f32 v67, v67, v24
    v_sub_f32 v68, v68, v24
    v_sub_f32 v69, v69, v24
    v_sub_f32 v70, v70, v24
    v_sub_f32 v71, v71, v24
    v_sub_f32 v72, v72, v24
    v_sub_f32 v73, v73, v24
    v_sub_f32 v74, v74, v24
    v_sub_f32 v75, v75, v24
    v_sub_f32 v76, v76, v24
    v_sub_f32 v77, v77, v24
    v_sub_f32 v78, v78, v24
    v_sub_f32 v79, v79, v24
    v_exp_f32 v64, v64
    v_exp_f32 v65, v65
    v_exp_f32 v66, v66
    v_exp_f32 v67, v67
    v_exp_f32 v68, v68
    v_exp_f32 v69, v69
    v_exp_f32 v70, v70
    v_exp_f32 v71, v71
    v_exp_f32 v72, v72
    v_exp_f32 v73, v73
    v_exp_f32 v74, v74
    v_exp_f32 v75, v75
    v_exp_f32 v76, v76
    v_exp_f32 v77, v77
    v_exp_f32 v78, v78
    v_exp_f32 v79, v79
    v_cvt_pk_bf16_f32 v56, v64, v65
    v_cvt_pk_bf16_f32 v57, v66, v67
    v_cvt_pk_bf16_f32 v58, v68, v69
    v_cvt_pk_bf16_f32 v59, v70, v71
    v_cvt_pk_bf16_f32 v60, v72, v73
    v_cvt_pk_bf16_f32 v61, v74, v75
    v_cvt_pk_bf16_f32 v62, v76, v77
    v_cvt_pk_bf16_f32 v63, v78, v79
    v_mfma_f32_32x32x16_bf16 v[224:239], a[216:219], v[56:59], v[224:239]
    s_nop 0
    v_mfma_f32_32x32x16_bf16 v[224:239], a[220:223], v[60:63], v[224:239]
    s_nop 7
L_skip_26:
    v_mov_b32 v24, 0xff800000
    v_mov_b32 v240, 0
    v_mov_b32 v241, 0
    v_mov_b32 v242, 0
    v_mov_b32 v243, 0
    v_mov_b32 v244, 0
    v_mov_b32 v245, 0
    v_mov_b32 v246, 0
    v_mov_b32 v247, 0
    v_mov_b32 v248, 0
    v_mov_b32 v249, 0
    v_mov_b32 v250, 0
    v_mov_b32 v251, 0
    v_mov_b32 v252, 0
    v_mov_b32 v253, 0
    v_mov_b32 v254, 0
    v_mov_b32 v255, 0
    s_cmp_gt_i32 s38, 1
    s_cbranch_scc1 L_skip_27
    ds_read_b128 a[200:203], v34 offset:512
    ds_read_b64 a[208:209], v9 offset:0
    s_waitcnt lgkmcnt(1)
    v_mfma_f32_32x32x16_bf16 v[64:79], a[200:203], v[100:103], v[80:95]
    s_waitcnt lgkmcnt(0)
    v_mfma_f32_32x32x16_bf16 v[64:79], a[208:211], v[110:113], v[64:79]
    s_nop 11
    v_max3_f32 v24, v24, v64, v65
    v_max3_f32 v24, v24, v66, v67
    v_max3_f32 v24, v24, v68, v69
    v_max3_f32 v24, v24, v70, v71
    v_max3_f32 v24, v24, v72, v73
    v_max3_f32 v24, v24, v74, v75
    v_max3_f32 v24, v24, v76, v77
    v_max3_f32 v24, v24, v78, v79
L_skip_27:
    s_cmp_gt_i32 s38, 2
    s_cbranch_scc1 L_skip_28
    ds_read_b128 a[200:203], v34 offset:1024
    ds_read_b64 a[208:209], v9 offset:1024
    s_waitcnt lgkmcnt(1)
    v_mfma_f32_32x32x16_bf16 v[64:79], a[200:203], v[100:103], 0
    s_waitcnt lgkmcnt(0)
    v_mfma_f32_32x32x16_bf16 v[64:79], a[208:211], v[108:111], v[64:79]
    s_nop 11
    v_max3_f32 v24, v24, v64, v65
    v_max3_f32 v24, v24, v66, v67
    v_max3_f32 v24, v24, v68, v69
    v_max3_f32 v24, v24, v70, v71
    v_max3_f32 v24, v24, v72, v73
    v_max3_f32 v24, v24, v74, v75
    v_max3_f32 v24, v24, v76, v77
    v_max3_f32 v24, v24, v78, v79
L_skip_28:
    s_cmp_gt_i32 s38, 3
    s_cbranch_scc1 L_skip_29
    ds_read_b128 a[200:203], v34 offset:1536
    ds_read_b64 a[208:209], v9 offset:1024
    s_waitcnt lgkmcnt(1)
    v_mfma_f32_32x32x16_bf16 v[64:79], a[200:203], v[100:103], 0
    s_waitcnt lgkmcnt(0)
    v_mfma_f32_32x32x16_bf16 v[64:79], a[208:211], v[110:113], v[64:79]
    s_nop 11
    v_max3_f32 v24, v24, v64, v65
    v_max3_f32 v24, v24, v66, v67
    v_max3_f32 v24, v24, v68, v69
    v_max3_f32 v24, v24, v70, v71
    v_max3_f32 v24, v24, v72, v73
    v_max3_f32 v24, v24, v74, v75
    v_max3_f32 v24, v24, v76, v77
    v_max3_f32 v24, v24, v78, v79
L_skip_29:
    s_cmp_gt_i32 s38, 4
    s_cbranch_scc1 L_skip_30
    ds_read_b128 a[200:203], v34 offset:2048
    ds_read_b64 a[208:209], v9 offset:2048
    s_waitcnt lgkmcnt(1)
    v_mfma_f32_32x32x16_bf16 v[64:79], a[200:203], v[100:103], 0
    s_waitcnt lgkmcnt(0)
    v_mfma_f32_32x32x16_bf16 v[64:79], a[208:211], v[108:111], v[64:79]
    s_nop 11
    v_max3_f32 v24, v24, v64, v65
    v_max3_f32 v24, v24, v66, v67
    v_max3_f32 v24, v24, v68, v69
    v_max3_f32 v24, v24, v70, v71
    v_max3_f32 v24, v24, v72, v73
    v_max3_f32 v24, v24, v74, v75
    v_max3_f32 v24, v24, v76, v77
    v_max3_f32 v24, v24, v78, v79
L_skip_30:
    s_cmp_gt_i32 s38, 5
    s_cbranch_scc1 L_skip_31
    ds_read_b128 a[200:203], v34 offset:2560
    ds_read_b64 a[208:209], v9 offset:2048
    s_waitcnt lgkmcnt(1)
    v_mfma_f32_32x32x16_bf16 v[64:79], a[200:203], v[100:103], 0
    s_waitcnt lgkmcnt(0)
    v_mfma_f32_32x32x16_bf16 v[64:79], a[208:211], v[110:113], v[64:79]
    s_nop 11
    v_max3_f32 v24, v24, v64, v65
    v_max3_f32 v24, v24, v66, v67
    v_max3_f32 v24, v24, v68, v69
    v_max3_f32 v24, v24, v70, v71
    v_max3_f32 v24, v24, v72, v73
    v_max3_f32 v24, v24, v74, v75
    v_max3_f32 v24, v24, v76, v77
    v_max3_f32 v24, v24, v78, v79
L_skip_31:
    s_cmp_gt_i32 s38, 6
    s_cbranch_scc1 L_skip_32
    ds_read_b128 a[200:203], v34 offset:3072
    ds_read_b64 a[208:209], v9 offset:3072
    s_waitcnt lgkmcnt(1)
    v_mfma_f32_32x32x16_bf16 v[64:79], a[200:203], v[100:103], 0
    s_waitcnt lgkmcnt(0)
    v_mfma_f32_32x32x16_bf16 v[64:79], a[208:211], v[108:111], v[64:79]
    s_nop 11
    v_max3_f32 v24, v24, v64, v65
    v_max3_f32 v24, v24, v66, v67
    v_max3_f32 v24, v24, v68, v69
    v_max3_f32 v24, v24, v70, v71
    v_max3_f32 v24, v24, v72, v73
    v_max3_f32 v24, v24, v74, v75
    v_max3_f32 v24, v24, v76, v77
    v_max3_f32 v24, v24, v78, v79
L_skip_32:
    s_cmp_gt_i32 s38, 7
    s_cbranch_scc1 L_skip_33
    ds_read_b128 a[200:203], v34 offset:3584
    ds_read_b64 a[208:209], v9 offset:3072
    s_waitcnt lgkmcnt(1)
    v_mfma_f32_32x32x16_bf16 v[64:79], a[200:203], v[100:103], 0
    s_waitcnt lgkmcnt(0)
    v_mfma_f32_32x32x16_bf16 v[64:79], a[208:211], v[110:113], v[64:79]
    s_nop 11
    v_max3_f32 v24, v24, v64, v65
    v_max3_f32 v24, v24, v66, v67
    v_max3_f32 v24, v24, v68, v69
    v_max3_f32 v24, v24, v70, v71
    v_max3_f32 v24, v24, v72, v73
    v_max3_f32 v24, v24, v74, v75
    v_max3_f32 v24, v24, v76, v77
    v_max3_f32 v24, v24, v78, v79
L_skip_33:
    s_cmp_gt_i32 s38, 8
    s_cbranch_scc1 L_skip_34
    ds_read_b128 a[200:203], v34 offset:4096
    ds_read_b64 a[208:209], v9 offset:4096
    s_waitcnt lgkmcnt(1)
    v_mfma_f32_32x32x16_bf16 v[64:79], a[200:203], v[100:103], 0
    s_waitcnt lgkmcnt(0)
    v_mfma_f32_32x32x16_bf16 v[64:79], a[208:211], v[108:111], v[64:79]
    s_nop 11
    v_max3_f32 v24, v24, v64, v65
    v_max3_f32 v24, v24, v66, v67
    v_max3_f32 v24, v24, v68, v69
    v_max3_f32 v24, v24, v70, v71
    v_max3_f32 v24, v24, v72, v73
    v_max3_f32 v24, v24, v74, v75
    v_max3_f32 v24, v24, v76, v77
    v_max3_f32 v24, v24, v78, v79
L_skip_34:
    s_cmp_gt_i32 s38, 9
    s_cbranch_scc1 L_skip_35
    ds_read_b128 a[200:203], v34 offset:4608
    ds_read_b64 a[208:209], v9 offset:4096
    s_waitcnt lgkmcnt(1)
    v_mfma_f32_32x32x16_bf16 v[64:79], a[200:203], v[100:103], v[208:223]
    s_waitcnt lgkmcnt(0)
    v_mfma_f32_32x32x16_bf16 v[64:79], a[208:211], v[110:113], v[64:79]
    s_nop 11
    v_max3_f32 v24, v24, v64, v65
    v_max3_f32 v24, v24, v66, v67
    v_max3_f32 v24, v24, v68, v69
    v_max3_f32 v24, v24, v70, v71
    v_max3_f32 v24, v24, v72, v73
    v_max3_f32 v24, v24, v74, v75
    v_max3_f32 v24, v24, v76, v77
    v_max3_f32 v24, v24, v78, v79
L_skip_35:
    s_nop 1
    v_mov_b32 v25, v24
    s_nop 1
    v_permlane32_swap_b32 v24, v25
    v_max_f32 v24, v24, v25
    s_cmp_gt_i32 s38, 1
    s_cbranch_scc1 L_skip_36
    ds_read_b64_tr_b16 a[216:217], v35 offset:512
    ds_read_b64_tr_b16 a[218:219], v35 offset:640
    ds_read_b64_tr_b16 a[220:221], v35 offset:768
    ds_read_b64_tr_b16 a[222:223], v35 offset:896
    ds_read_b128 a[200:203], v34 offset:512
    ds_read_b64 a[208:209], v9 offset:0
    s_waitcnt lgkmcnt(1)
    v_mfma_f32_32x32x16_bf16 v[64:79], a[200:203], v[100:103], v[80:95]
    s_waitcnt lgkmcnt(0)
    v_mfma_f32_32x32x16_bf16 v[64:79], a[208:211], v[110:113], v[64:79]
    s_nop 11
    v_sub_f32 v64, v64, v24
    v_sub_f32 v65, v65, v24
    v_sub_f32 v66, v66, v24
    v_sub_f32 v67, v67, v24
    v_sub_f32 v68, v68, v24
    v_sub_f32 v69, v69, v24
    v_sub_f32 v70, v70, v24
    v_sub_f32 v71, v71, v24
    v_sub_f32 v72, v72, v24
    v_sub_f32 v73, v73, v24
    v_sub_f32 v74, v74, v24
    v_sub_f32 v75, v75, v24
    v_sub_f32 v76, v76, v24
    v_sub_f32 v77, v77, v24
    v_sub_f32 v78, v78, v24
    v_sub_f32 v79, v79, v24
    v_exp_f32 v64, v64
    v_exp_f32 v65, v65
    v_exp_f32 v66, v66
    v_exp_f32 v67, v67
    v_exp_f32 v68, v68
    v_exp_f32 v69, v69
    v_exp_f32 v70, v70
    v_exp_f32 v71, v71
    v_exp_f32 v72, v72
    v_exp_f32 v73, v73
    v_exp_f32 v74, v74
    v_exp_f32 v75, v75
    v_exp_f32 v76, v76
    v_exp_f32 v77, v77
    v_exp_f32 v78, v78
    v_exp_f32 v79, v79
    v_cvt_pk_bf16_f32 v56, v64, v65
    v_cvt_pk_bf16_f32 v57, v66, v67
    v_cvt_pk_bf16_f32 v58, v68, v69
    v_cvt_pk_bf16_f32 v59, v70, v71
    v_cvt_pk_bf16_f32 v60, v72, v73
    v_cvt_pk_bf16_f32 v61, v74, v75
    v_cvt_pk_bf16_f32 v62, v76, v77
    v_cvt_pk_bf16_f32 v63, v78, v79
    v_mfma_f32_32x32x16_bf16 v[240:255], a[216:219], v[56:59], v[240:255]
    s_nop 0
    v_mfma_f32_32x32x16_bf16 v[240:255], a[220:223], v[60:63], v[240:255]
    s_nop 7
L_skip_36:
    s_cmp_gt_i32 s38, 2
    s_cbranch_scc1 L_skip_37
    ds_read_b64_tr_b16 a[216:217], v35 offset:1024
    ds_read_b64_tr_b16 a[218:219], v35 offset:1152
    ds_read_b64_tr_b16 a[220:221], v35 offset:1280
    ds_read_b64_tr_b16 a[222:223], v35 offset:1408
    ds_read_b128 a[200:203], v34 offset:1024
    ds_read_b64 a[208:209], v9 offset:1024
    s_waitcnt lgkmcnt(1)
    v_mfma_f32_32x32x16_bf16 v[64:79], a[200:203], v[100:103], 0
    s_waitcnt lgkmcnt(0)
    v_mfma_f32_32x32x16_bf16 v[64:79], a[208:211], v[108:111], v[64:79]
    s_nop 11
    v_sub_f32 v64, v64, v24
    v_sub_f32 v65, v65, v24
    v_sub_f32 v66, v66, v24
    v_sub_f32 v67, v67, v24
    v_sub_f32 v68, v68, v24
    v_sub_f32 v69, v69, v24
    v_sub_f32 v70, v70, v24
    v_sub_f32 v71, v71, v24
    v_sub_f32 v72, v72, v24
    v_sub_f32 v73, v73, v24
    v_sub_f32 v74, v74, v24
    v_sub_f32 v75, v75, v24
    v_sub_f32 v76, v76, v24
    v_sub_f32 v77, v77, v24
    v_sub_f32 v78, v78, v24
    v_sub_f32 v79, v79, v24
    v_exp_f32 v64, v64
    v_exp_f32 v65, v65
    v_exp_f32 v66, v66
    v_exp_f32 v67, v67
    v_exp_f32 v68, v68
    v_exp_f32 v69, v69
    v_exp_f32 v70, v70
    v_exp_f32 v71, v71
    v_exp_f32 v72, v72
    v_exp_f32 v73, v73
    v_exp_f32 v74, v74
    v_exp_f32 v75, v75
    v_exp_f32 v76, v76
    v_exp_f32 v77, v77
    v_exp_f32 v78, v78
    v_exp_f32 v79, v79
    v_cvt_pk_bf16_f32 v56, v64, v65
    v_cvt_pk_bf16_f32 v57, v66, v67
    v_cvt_pk_bf16_f32 v58, v68, v69
    v_cvt_pk_bf16_f32 v59, v70, v71
    v_cvt_pk_bf16_f32 v60, v72, v73
    v_cvt_pk_bf16_f32 v61, v74, v75
    v_cvt_pk_bf16_f32 v62, v76, v77
    v_cvt_pk_bf16_f32 v63, v78, v79
    v_mfma_f32_32x32x16_bf16 v[240:255], a[216:219], v[56:59], v[240:255]
    s_nop 0
    v_mfma_f32_32x32x16_bf16 v[240:255], a[220:223], v[60:63], v[240:255]
    s_nop 7
L_skip_37:
    s_cmp_gt_i32 s38, 3
    s_cbranch_scc1 L_skip_38
    ds_read_b64_tr_b16 a[216:217], v35 offset:1536
    ds_read_b64_tr_b16 a[218:219], v35 offset:1664
    ds_read_b64_tr_b16 a[220:221], v35 offset:1792
    ds_read_b64_tr_b16 a[222:223], v35 offset:1920
    ds_read_b128 a[200:203], v34 offset:1536
    ds_read_b64 a[208:209], v9 offset:1024
    s_waitcnt lgkmcnt(1)
    v_mfma_f32_32x32x16_bf16 v[64:79], a[200:203], v[100:103], 0
    s_waitcnt lgkmcnt(0)
    v_mfma_f32_32x32x16_bf16 v[64:79], a[208:211], v[110:113], v[64:79]
    s_nop 11
    v_sub_f32 v64, v64, v24
    v_sub_f32 v65, v65, v24
    v_sub_f32 v66, v66, v24
    v_sub_f32 v67, v67, v24
    v_sub_f32 v68, v68, v24
    v_sub_f32 v69, v69, v24
    v_sub_f32 v70, v70, v24
    v_sub_f32 v71, v71, v24
    v_sub_f32 v72, v72, v24
    v_sub_f32 v73, v73, v24
    v_sub_f32 v74, v74, v24
    v_sub_f32 v75, v75, v24
    v_sub_f32 v76, v76, v24
    v_sub_f32 v77, v77, v24
    v_sub_f32 v78, v78, v24
    v_sub_f32 v79, v79, v24
    v_exp_f32 v64, v64
    v_exp_f32 v65, v65
    v_exp_f32 v66, v66
    v_exp_f32 v67, v67
    v_exp_f32 v68, v68
    v_exp_f32 v69, v69
    v_exp_f32 v70, v70
    v_exp_f32 v71, v71
    v_exp_f32 v72, v72
    v_exp_f32 v73, v73
    v_exp_f32 v74, v74
    v_exp_f32 v75, v75
    v_exp_f32 v76, v76
    v_exp_f32 v77, v77
    v_exp_f32 v78, v78
    v_exp_f32 v79, v79
    v_cvt_pk_bf16_f32 v56, v64, v65
    v_cvt_pk_bf16_f32 v57, v66, v67
    v_cvt_pk_bf16_f32 v58, v68, v69
    v_cvt_pk_bf16_f32 v59, v70, v71
    v_cvt_pk_bf16_f32 v60, v72, v73
    v_cvt_pk_bf16_f32 v61, v74, v75
    v_cvt_pk_bf16_f32 v62, v76, v77
    v_cvt_pk_bf16_f32 v63, v78, v79
    v_mfma_f32_32x32x16_bf16 v[240:255], a[216:219], v[56:59], v[240:255]
    s_nop 0
    v_mfma_f32_32x32x16_bf16 v[240:255], a[220:223], v[60:63], v[240:255]
    s_nop 7
L_skip_38:
    s_cmp_gt_i32 s38, 4
    s_cbranch_scc1 L_skip_39
    ds_read_b64_tr_b16 a[216:217], v35 offset:2048
    ds_read_b64_tr_b16 a[218:219], v35 offset:2176
    ds_read_b64_tr_b16 a[220:221], v35 offset:2304
    ds_read_b64_tr_b16 a[222:223], v35 offset:2432
    ds_read_b128 a[200:203], v34 offset:2048
    ds_read_b64 a[208:209], v9 offset:2048
    s_waitcnt lgkmcnt(1)
    v_mfma_f32_32x32x16_bf16 v[64:79], a[200:203], v[100:103], 0
    s_waitcnt lgkmcnt(0)
    v_mfma_f32_32x32x16_bf16 v[64:79], a[208:211], v[108:111], v[64:79]
    s_nop 11
    v_sub_f32 v64, v64, v24
    v_sub_f32 v65, v65, v24
    v_sub_f32 v66, v66, v24
    v_sub_f32 v67, v67, v24
    v_sub_f32 v68, v68, v24
    v_sub_f32 v69, v69, v24
    v_sub_f32 v70, v70, v24
    v_sub_f32 v71, v71, v24
    v_sub_f32 v72, v72, v24
    v_sub_f32 v73, v73, v24
    v_sub_f32 v74, v74, v24
    v_sub_f32 v75, v75, v24
    v_sub_f32 v76, v76, v24
    v_sub_f32 v77, v77, v24
    v_sub_f32 v78, v78, v24
    v_sub_f32 v79, v79, v24
    v_exp_f32 v64, v64
    v_exp_f32 v65, v65
    v_exp_f32 v66, v66
    v_exp_f32 v67, v67
    v_exp_f32 v68, v68
    v_exp_f32 v69, v69
    v_exp_f32 v70, v70
    v_exp_f32 v71, v71
    v_exp_f32 v72, v72
    v_exp_f32 v73, v73
    v_exp_f32 v74, v74
    v_exp_f32 v75, v75
    v_exp_f32 v76, v76
    v_exp_f32 v77, v77
    v_exp_f32 v78, v78
    v_exp_f32 v79, v79
    v_cvt_pk_bf16_f32 v56, v64, v65
    v_cvt_pk_bf16_f32 v57, v66, v67
    v_cvt_pk_bf16_f32 v58, v68, v69
    v_cvt_pk_bf16_f32 v59, v70, v71
    v_cvt_pk_bf16_f32 v60, v72, v73
    v_cvt_pk_bf16_f32 v61, v74, v75
    v_cvt_pk_bf16_f32 v62, v76, v77
    v_cvt_pk_bf16_f32 v63, v78, v79
    v_mfma_f32_32x32x16_bf16 v[240:255], a[216:219], v[56:59], v[240:255]
    s_nop 0
    v_mfma_f32_32x32x16_bf16 v[240:255], a[220:223], v[60:63], v[240:255]
    s_nop 7
L_skip_39:
    s_cmp_gt_i32 s38, 5
    s_cbranch_scc1 L_skip_40
    ds_read_b64_tr_b16 a[216:217], v35 offset:2560
    ds_read_b64_tr_b16 a[218:219], v35 offset:2688
    ds_read_b64_tr_b16 a[220:221], v35 offset:2816
    ds_read_b64_tr_b16 a[222:223], v35 offset:2944
    ds_read_b128 a[200:203], v34 offset:2560
    ds_read_b64 a[208:209], v9 offset:2048
    s_waitcnt lgkmcnt(1)
    v_mfma_f32_32x32x16_bf16 v[64:79], a[200:203], v[100:103], 0
    s_waitcnt lgkmcnt(0)
    v_mfma_f32_32x32x16_bf16 v[64:79], a[208:211], v[110:113], v[64:79]
    s_nop 11
    v_sub_f32 v64, v64, v24
    v_sub_f32 v65, v65, v24
    v_sub_f32 v66, v66, v24
    v_sub_f32 v67, v67, v24
    v_sub_f32 v68, v68, v24
    v_sub_f32 v69, v69, v24
    v_sub_f32 v70, v70, v24
    v_sub_f32 v71, v71, v24
    v_sub_f32 v72, v72, v24
    v_sub_f32 v73, v73, v24
    v_sub_f32 v74, v74, v24
    v_sub_f32 v75, v75, v24
    v_sub_f32 v76, v76, v24
    v_sub_f32 v77, v77, v24
    v_sub_f32 v78, v78, v24
    v_sub_f32 v79, v79, v24
    v_exp_f32 v64, v64
    v_exp_f32 v65, v65
    v_exp_f32 v66, v66
    v_exp_f32 v67, v67
    v_exp_f32 v68, v68
    v_exp_f32 v69, v69
    v_exp_f32 v70, v70
    v_exp_f32 v71, v71
    v_exp_f32 v72, v72
    v_exp_f32 v73, v73
    v_exp_f32 v74, v74
    v_exp_f32 v75, v75
    v_exp_f32 v76, v76
    v_exp_f32 v77, v77
    v_exp_f32 v78, v78
    v_exp_f32 v79, v79
    v_cvt_pk_bf16_f32 v56, v64, v65
    v_cvt_pk_bf16_f32 v57, v66, v67
    v_cvt_pk_bf16_f32 v58, v68, v69
    v_cvt_pk_bf16_f32 v59, v70, v71
    v_cvt_pk_bf16_f32 v60, v72, v73
    v_cvt_pk_bf16_f32 v61, v74, v75
    v_cvt_pk_bf16_f32 v62, v76, v77
    v_cvt_pk_bf16_f32 v63, v78, v79
    v_mfma_f32_32x32x16_bf16 v[240:255], a[216:219], v[56:59], v[240:255]
    s_nop 0
    v_mfma_f32_32x32x16_bf16 v[240:255], a[220:223], v[60:63], v[240:255]
    s_nop 7
L_skip_40:
    s_cmp_gt_i32 s38, 6
    s_cbranch_scc1 L_skip_41
    ds_read_b64_tr_b16 a[216:217], v35 offset:3072
    ds_read_b64_tr_b16 a[218:219], v35 offset:3200
    ds_read_b64_tr_b16 a[220:221], v35 offset:3328
    ds_read_b64_tr_b16 a[222:223], v35 offset:3456
    ds_read_b128 a[200:203], v34 offset:3072
    ds_read_b64 a[208:209], v9 offset:3072
    s_waitcnt lgkmcnt(1)
    v_mfma_f32_32x32x16_bf16 v[64:79], a[200:203], v[100:103], 0
    s_waitcnt lgkmcnt(0)
    v_mfma_f32_32x32x16_bf16 v[64:79], a[208:211], v[108:111], v[64:79]
    s_nop 11
    v_sub_f32 v64, v64, v24
    v_sub_f32 v65, v65, v24
    v_sub_f32 v66, v66, v24
    v_sub_f32 v67, v67, v24
    v_sub_f32 v68, v68, v24
    v_sub_f32 v69, v69, v24
    v_sub_f32 v70, v70, v24
    v_sub_f32 v71, v71, v24
    v_sub_f32 v72, v72, v24
    v_sub_f32 v73, v73, v24
    v_sub_f32 v74, v74, v24
    v_sub_f32 v75, v75, v24
    v_sub_f32 v76, v76, v24
    v_sub_f32 v77, v77, v24
    v_sub_f32 v78, v78, v24
    v_sub_f32 v79, v79, v24
    v_exp_f32 v64, v64
    v_exp_f32 v65, v65
    v_exp_f32 v66, v66
    v_exp_f32 v67, v67
    v_exp_f32 v68, v68
    v_exp_f32 v69, v69
    v_exp_f32 v70, v70
    v_exp_f32 v71, v71
    v_exp_f32 v72, v72
    v_exp_f32 v73, v73
    v_exp_f32 v74, v74
    v_exp_f32 v75, v75
    v_exp_f32 v76, v76
    v_exp_f32 v77, v77
    v_exp_f32 v78, v78
    v_exp_f32 v79, v79
    v_cvt_pk_bf16_f32 v56, v64, v65
    v_cvt_pk_bf16_f32 v57, v66, v67
    v_cvt_pk_bf16_f32 v58, v68, v69
    v_cvt_pk_bf16_f32 v59, v70, v71
    v_cvt_pk_bf16_f32 v60, v72, v73
    v_cvt_pk_bf16_f32 v61, v74, v75
    v_cvt_pk_bf16_f32 v62, v76, v77
    v_cvt_pk_bf16_f32 v63, v78, v79
    v_mfma_f32_32x32x16_bf16 v[240:255], a[216:219], v[56:59], v[240:255]
    s_nop 0
    v_mfma_f32_32x32x16_bf16 v[240:255], a[220:223], v[60:63], v[240:255]
    s_nop 7
L_skip_41:
    s_cmp_gt_i32 s38, 7
    s_cbranch_scc1 L_skip_42
    ds_read_b64_tr_b16 a[216:217], v35 offset:3584
    ds_read_b64_tr_b16 a[218:219], v35 offset:3712
    ds_read_b64_tr_b16 a[220:221], v35 offset:3840
    ds_read_b64_tr_b16 a[222:223], v35 offset:3968
    ds_read_b128 a[200:203], v34 offset:3584
    ds_read_b64 a[208:209], v9 offset:3072
    s_waitcnt lgkmcnt(1)
    v_mfma_f32_32x32x16_bf16 v[64:79], a[200:203], v[100:103], 0
    s_waitcnt lgkmcnt(0)
    v_mfma_f32_32x32x16_bf16 v[64:79], a[208:211], v[110:113], v[64:79]
    s_nop 11
    v_sub_f32 v64, v64, v24
    v_sub_f32 v65, v65, v24
    v_sub_f32 v66, v66, v24
    v_sub_f32 v67, v67, v24
    v_sub_f32 v68, v68, v24
    v_sub_f32 v69, v69, v24
    v_sub_f32 v70, v70, v24
    v_sub_f32 v71, v71, v24
    v_sub_f32 v72, v72, v24
    v_sub_f32 v73, v73, v24
    v_sub_f32 v74, v74, v24
    v_sub_f32 v75, v75, v24
    v_sub_f32 v76, v76, v24
    v_sub_f32 v77, v77, v24
    v_sub_f32 v78, v78, v24
    v_sub_f32 v79, v79, v24
    v_exp_f32 v64, v64
    v_exp_f32 v65, v65
    v_exp_f32 v66, v66
    v_exp_f32 v67, v67
    v_exp_f32 v68, v68
    v_exp_f32 v69, v69
    v_exp_f32 v70, v70
    v_exp_f32 v71, v71
    v_exp_f32 v72, v72
    v_exp_f32 v73, v73
    v_exp_f32 v74, v74
    v_exp_f32 v75, v75
    v_exp_f32 v76, v76
    v_exp_f32 v77, v77
    v_exp_f32 v78, v78
    v_exp_f32 v79, v79
    v_cvt_pk_bf16_f32 v56, v64, v65
    v_cvt_pk_bf16_f32 v57, v66, v67
    v_cvt_pk_bf16_f32 v58, v68, v69
    v_cvt_pk_bf16_f32 v59, v70, v71
    v_cvt_pk_bf16_f32 v60, v72, v73
    v_cvt_pk_bf16_f32 v61, v74, v75
    v_cvt_pk_bf16_f32 v62, v76, v77
    v_cvt_pk_bf16_f32 v63, v78, v79
    v_mfma_f32_32x32x16_bf16 v[240:255], a[216:219], v[56:59], v[240:255]
    s_nop 0
    v_mfma_f32_32x32x16_bf16 v[240:255], a[220:223], v[60:63], v[240:255]
    s_nop 7
L_skip_42:
    s_cmp_gt_i32 s38, 8
    s_cbranch_scc1 L_skip_43
    ds_read_b64_tr_b16 a[216:217], v35 offset:4096
    ds_read_b64_tr_b16 a[218:219], v35 offset:4224
    ds_read_b64_tr_b16 a[220:221], v35 offset:4352
    ds_read_b64_tr_b16 a[222:223], v35 offset:4480
    ds_read_b128 a[200:203], v34 offset:4096
    ds_read_b64 a[208:209], v9 offset:4096
    s_waitcnt lgkmcnt(1)
    v_mfma_f32_32x32x16_bf16 v[64:79], a[200:203], v[100:103], 0
    s_waitcnt lgkmcnt(0)
    v_mfma_f32_32x32x16_bf16 v[64:79], a[208:211], v[108:111], v[64:79]
    s_nop 11
    v_sub_f32 v64, v64, v24
    v_sub_f32 v65, v65, v24
    v_sub_f32 v66, v66, v24
    v_sub_f32 v67, v67, v24
    v_sub_f32 v68, v68, v24
    v_sub_f32 v69, v69, v24
    v_sub_f32 v70, v70, v24
    v_sub_f32 v71, v71, v24
    v_sub_f32 v72, v72, v24
    v_sub_f32 v73, v73, v24
    v_sub_f32 v74, v74, v24
    v_sub_f32 v75, v75, v24
    v_sub_f32 v76, v76, v24
    v_sub_f32 v77, v77, v24
    v_sub_f32 v78, v78, v24
    v_sub_f32 v79, v79, v24
    v_exp_f32 v64, v64
    v_exp_f32 v65, v65
    v_exp_f32 v66, v66
    v_exp_f32 v67, v67
    v_exp_f32 v68, v68
    v_exp_f32 v69, v69
    v_exp_f32 v70, v70
    v_exp_f32 v71, v71
    v_exp_f32 v72, v72
    v_exp_f32 v73, v73
    v_exp_f32 v74, v74
    v_exp_f32 v75, v75
    v_exp_f32 v76, v76
    v_exp_f32 v77, v77
    v_exp_f32 v78, v78
    v_exp_f32 v79, v79
    v_cvt_pk_bf16_f32 v56, v64, v65
    v_cvt_pk_bf16_f32 v57, v66, v67
    v_cvt_pk_bf16_f32 v58, v68, v69
    v_cvt_pk_bf16_f32 v59, v70, v71
    v_cvt_pk_bf16_f32 v60, v72, v73
    v_cvt_pk_bf16_f32 v61, v74, v75
    v_cvt_pk_bf16_f32 v62, v76, v77
    v_cvt_pk_bf16_f32 v63, v78, v79
    v_mfma_f32_32x32x16_bf16 v[240:255], a[216:219], v[56:59], v[240:255]
    s_nop 0
    v_mfma_f32_32x32x16_bf16 v[240:255], a[220:223], v[60:63], v[240:255]
    s_nop 7
L_skip_43:
    s_cmp_gt_i32 s38, 9
    s_cbranch_scc1 L_skip_44
    ds_read_b64_tr_b16 a[216:217], v35 offset:4608
    ds_read_b64_tr_b16 a[218:219], v35 offset:4736
    ds_read_b64_tr_b16 a[220:221], v35 offset:4864
    ds_read_b64_tr_b16 a[222:223], v35 offset:4992
    ds_read_b128 a[200:203], v34 offset:4608
    ds_read_b64 a[208:209], v9 offset:4096
    s_waitcnt lgkmcnt(1)
    v_mfma_f32_32x32x16_bf16 v[64:79], a[200:203], v[100:103], v[208:223]
    s_waitcnt lgkmcnt(0)
    v_mfma_f32_32x32x16_bf16 v[64:79], a[208:211], v[110:113], v[64:79]
    s_nop 11
    v_sub_f32 v64, v64, v24
    v_sub_f32 v65, v65, v24
    v_sub_f32 v66, v66, v24
    v_sub_f32 v67, v67, v24
    v_sub_f32 v68, v68, v24
    v_sub_f32 v69, v69, v24
    v_sub_f32 v70, v70, v24
    v_sub_f32 v71, v71, v24
    v_sub_f32 v72, v72, v24
    v_sub_f32 v73, v73, v24
    v_sub_f32 v74, v74, v24
    v_sub_f32 v75, v75, v24
    v_sub_f32 v76, v76, v24
    v_sub_f32 v77, v77, v24
    v_sub_f32 v78, v78, v24
    v_sub_f32 v79, v79, v24
    v_exp_f32 v64, v64
    v_exp_f32 v65, v65
    v_exp_f32 v66, v66
    v_exp_f32 v67, v67
    v_exp_f32 v68, v68
    v_exp_f32 v69, v69
    v_exp_f32 v70, v70
    v_exp_f32 v71, v71
    v_exp_f32 v72, v72
    v_exp_f32 v73, v73
    v_exp_f32 v74, v74
    v_exp_f32 v75, v75
    v_exp_f32 v76, v76
    v_exp_f32 v77, v77
    v_exp_f32 v78, v78
    v_exp_f32 v79, v79
    v_cvt_pk_bf16_f32 v56, v64, v65
    v_cvt_pk_bf16_f32 v57, v66, v67
    v_cvt_pk_bf16_f32 v58, v68, v69
    v_cvt_pk_bf16_f32 v59, v70, v71
    v_cvt_pk_bf16_f32 v60, v72, v73
    v_cvt_pk_bf16_f32 v61, v74, v75
    v_cvt_pk_bf16_f32 v62, v76, v77
    v_cvt_pk_bf16_f32 v63, v78, v79
    v_mfma_f32_32x32x16_bf16 v[240:255], a[216:219], v[56:59], v[240:255]
    s_nop 0
    v_mfma_f32_32x32x16_bf16 v[240:255], a[220:223], v[60:63], v[240:255]
    s_nop 7
L_skip_44:
    s_nop 15
    s_branch L_Aok
L_truemaxB:
    s_nop 7
    v_mfma_f32_32x32x16_bf16 v[64:79], v[144:147], v[128:131], v[176:191]
    v_mfma_f32_32x32x16_bf16 v[64:79], a[232:235], v[136:139], v[64:79]
    v_mfma_f32_32x32x16_bf16 v[80:95], v[148:151], v[128:131], v[160:175]
    v_mfma_f32_32x32x16_bf16 v[80:95], a[232:235], v[138:141], v[80:95]
    v_mfma_f32_32x32x16_bf16 v[192:207], v[148:151], v[132:135], v[168:183]
    v_mfma_f32_32x32x16_bf16 v[192:207], a[232:235], v[140:143], v[192:207]
    v_mfma_f32_32x32x16_bf16 v[208:223], v[152:155], v[132:135], v[160:175]
    v_mfma_f32_32x32x16_bf16 v[208:223], a[236:239], v[140:143], v[208:223]
    s_nop 5
    v_max3_f32 v24, v72, v73, v74
    v_max3_f32 v25, v75, v76, v77
    v_max3_f32 v24, v24, v78, v79
    v_max3_f32 v25, v25, v80, v81
    v_max3_f32 v24, v24, v82, v83
    v_max3_f32 v25, v25, v84, v85
    v_max3_f32 v24, v24, v86, v87
    v_max3_f32 v25, v25, v88, v89
    v_max3_f32 v24, v24, v90, v91
    v_max3_f32 v25, v25, v92, v93
    v_max3_f32 v24, v24, v94, v95
    v_max_f32 v24, v24, v25
    v_mov_b32 v25, v24
    s_nop 1
    v_permlane32_swap_b32 v24, v25
    v_max_f32 v24, v24, v25
    v_pk_add_f32 v[72:73], v[72:73], v[24:25] op_sel_hi:[1,0] neg_lo:[0,1] neg_hi:[0,1]
    v_pk_add_f32 v[74:75], v[74:75], v[24:25] op_sel_hi:[1,0] neg_lo:[0,1] neg_hi:[0,1]
    v_pk_add_f32 v[76:77], v[76:77], v[24:25] op_sel_hi:[1,0] neg_lo:[0,1] neg_hi:[0,1]
    v_pk_add_f32 v[78:79], v[78:79], v[24:25] op_sel_hi:[1,0] neg_lo:[0,1] neg_hi:[0,1]
    v_pk_add_f32 v[80:81], v[80:81], v[24:25] op_sel_hi:[1,0] neg_lo:[0,1] neg_hi:[0,1]
    v_pk_add_f32 v[82:83], v[82:83], v[24:25] op_sel_hi:[1,0] neg_lo:[0,1] neg_hi:[0,1]
    v_pk_add_f32 v[84:85], v[84:85], v[24:25] op_sel_hi:[1,0] neg_lo:[0,1] neg_hi:[0,1]
    v_pk_add_f32 v[86:87], v[86:87], v[24:25] op_sel_hi:[1,0] neg_lo:[0,1] neg_hi:[0,1]
    v_pk_add_f32 v[88:89], v[88:89], v[24:25] op_sel_hi:[1,0] neg_lo:[0,1] neg_hi:[0,1]
    v_pk_add_f32 v[90:91], v[90:91], v[24:25] op_sel_hi:[1,0] neg_lo:[0,1] neg_hi:[0,1]
    v_pk_add_f32 v[92:93], v[92:93], v[24:25] op_sel_hi:[1,0] neg_lo:[0,1] neg_hi:[0,1]
    v_pk_add_f32 v[94:95], v[94:95], v[24:25] op_sel_hi:[1,0] neg_lo:[0,1] neg_hi:[0,1]
    v_exp_f32 v72, v72
    v_exp_f32 v73, v73
    v_exp_f32 v74, v74
    v_exp_f32 v75, v75
    v_exp_f32 v76, v76
    v_exp_f32 v77, v77
    v_exp_f32 v78, v78
    v_exp_f32 v79, v79
    v_cvt_pk_bf16_f32 v72, v72, v73
    v_cvt_pk_bf16_f32 v73, v74, v75
    v_cvt_pk_bf16_f32 v74, v76, v77
    v_cvt_pk_bf16_f32 v75, v78, v79
    v_exp_f32 v80, v80
    v_exp_f32 v81, v81
    v_exp_f32 v82, v82
    v_exp_f32 v83, v83
    v_exp_f32 v84, v84
    v_exp_f32 v85, v85
    v_exp_f32 v86, v86
    v_exp_f32 v87, v87
    v_mfma_f32_32x32x16_bf16 v[96:111], a[200:203], v[72:75], 0
    v_cvt_pk_bf16_f32 v80, v80, v81
    v_cvt_pk_bf16_f32 v81, v82, v83
    v_cvt_pk_bf16_f32 v82, v84, v85
    v_cvt_pk_bf16_f32 v83, v86, v87
    v_exp_f32 v88, v88
    v_exp_f32 v89, v89
    v_exp_f32 v90, v90
    v_exp_f32 v91, v91
    v_exp_f32 v92, v92
    v_exp_f32 v93, v93
    v_exp_f32 v94, v94
    v_exp_f32 v95, v95
    v_mfma_f32_32x32x16_bf16 v[96:111], a[204:207], v[80:83], v[96:111]
    v_cvt_pk_bf16_f32 v88, v88, v89
    v_cvt_pk_bf16_f32 v89, v90, v91
    v_cvt_pk_bf16_f32 v90, v92, v93
    v_cvt_pk_bf16_f32 v91, v94, v95
    s_nop 1
    v_mfma_f32_32x32x16_bf16 v[96:111], a[208:211], v[88:91], v[96:111]
    v_max3_f32 v24, v200, v201, v202
    v_max3_f32 v25, v203, v204, v205
    v_max3_f32 v24, v24, v206, v207
    v_max3_f32 v25, v25, v208, v209
    v_max3_f32 v24, v24, v210, v211
    v_max3_f32 v25, v25, v212, v213
    v_max3_f32 v24, v24, v214, v215
    v_max3_f32 v25, v25, v216, v217
    v_max3_f32 v24, v24, v218, v219
    v_max3_f32 v25, v25, v220, v221
    v_max3_f32 v24, v24, v222, v223
    v_max_f32 v24, v24, v25
    v_mov_b32 v25, v24
    s_nop 1
    v_permlane32_swap_b32 v24, v25
    v_max_f32 v24, v24, v25
    v_pk_add_f32 v[200:201], v[200:201], v[24:25] op_sel_hi:[1,0] neg_lo:[0,1] neg_hi:[0,1]
    v_pk_add_f32 v[202:203], v[202:203], v[24:25] op_sel_hi:[1,0] neg_lo:[0,1] neg_hi:[0,1]
    v_pk_add_f32 v[204:205], v[204:205], v[24:25] op_sel_hi:[1,0] neg_lo:[0,1] neg_hi:[0,1]
    v_pk_add_f32 v[206:207], v[206:207], v[24:25] op_sel_hi:[1,0] neg_lo:[0,1] neg_hi:[0,1]
    v_pk_add_f32 v[208:209], v[208:209], v[24:25] op_sel_hi:[1,0] neg_lo:[0,1] neg_hi:[0,1]
    v_pk_add_f32 v[210:211], v[210:211], v[24:25] op_sel_hi:[1,0] neg_lo:[0,1] neg_hi:[0,1]
    v_pk_add_f32 v[212:213], v[212:213], v[24:25] op_sel_hi:[1,0] neg_lo:[0,1] neg_hi:[0,1]
    v_pk_add_f32 v[214:215], v[214:215], v[24:25] op_sel_hi:[1,0] neg_lo:[0,1] neg_hi:[0,1]
    v_pk_add_f32 v[216:217], v[216:217], v[24:25] op_sel_hi:[1,0] neg_lo:[0,1] neg_hi:[0,1]
    v_pk_add_f32 v[218:219], v[218:219], v[24:25] op_sel_hi:[1,0] neg_lo:[0,1] neg_hi:[0,1]
    v_pk_add_f32 v[220:221], v[220:221], v[24:25] op_sel_hi:[1,0] neg_lo:[0,1] neg_hi:[0,1]
    v_pk_add_f32 v[222:223], v[222:223], v[24:25] op_sel_hi:[1,0] neg_lo:[0,1] neg_hi:[0,1]
    v_exp_f32 v200, v200
    v_exp_f32 v201, v201
    v_exp_f32 v202, v202
    v_exp_f32 v203, v203
    v_exp_f32 v204, v204
    v_exp_f32 v205, v205
    v_exp_f32 v206, v206
    v_exp_f32 v207, v207
    v_cvt_pk_bf16_f32 v200, v200, v201
    v_cvt_pk_bf16_f32 v201, v202, v203
    v_cvt_pk_bf16_f32 v202, v204, v205
    v_cvt_pk_bf16_f32 v203, v206, v207
    v_exp_f32 v208, v208
    v_exp_f32 v209, v209
    v_exp_f32 v210, v210
    v_exp_f32 v211, v211
    v_exp_f32 v212, v212
    v_exp_f32 v213, v213
    v_exp_f32 v214, v214
    v_exp_f32 v215, v215
    v_mfma_f32_32x32x16_bf16 v[112:127], a[208:211], v[200:203], 0
    v_cvt_pk_bf16_f32 v208, v208, v209
    v_cvt_pk_bf16_f32 v209, v210, v211
    v_cvt_pk_bf16_f32 v210, v212, v213
    v_cvt_pk_bf16_f32 v211, v214, v215
    v_exp_f32 v216, v216
    v_exp_f32 v217, v217
    v_exp_f32 v218, v218
    v_exp_f32 v219, v219
    v_exp_f32 v220, v220
    v_exp_f32 v221, v221
    v_exp_f32 v222, v222
    v_exp_f32 v223, v223
    v_mfma_f32_32x32x16_bf16 v[112:127], a[212:215], v[208:211], v[112:127]
    v_cvt_pk_bf16_f32 v216, v216, v217
    v_cvt_pk_bf16_f32 v217, v218, v219
    v_cvt_pk_bf16_f32 v218, v220, v221
    v_cvt_pk_bf16_f32 v219, v222, v223
    s_nop 1
    v_mfma_f32_32x32x16_bf16 v[112:127], a[216:219], v[216:219], v[112:127]
    v_rcp_f32 v22, v108
    s_nop 0
    v_mul_f32 v22, v46, v22
    v_mul_f32 v96, v22, v96
    v_mul_f32 v97, v22, v97
    v_mul_f32 v98, v22, v98
    v_mul_f32 v99, v22, v99
    v_mul_f32 v100, v22, v100
    v_mul_f32 v101, v22, v101
    v_mul_f32 v102, v22, v102
    v_mul_f32 v103, v22, v103
    v_mul_f32 v104, v22, v104
    v_mul_f32 v105, v22, v105
    v_mul_f32 v106, v22, v106
    v_mul_f32 v107, v22, v107
    v_and_or_b32 v96, v96, s52, v43
    v_and_or_b32 v104, v104, s52, v43
    v_cvt_pk_bf16_f32 v96, v96, v97
    v_cvt_pk_bf16_f32 v97, v98, v99
    v_cvt_pk_bf16_f32 v98, v100, v101
    v_cvt_pk_bf16_f32 v99, v102, v103
    v_cvt_pk_bf16_f32 v100, v104, v105
    v_cvt_pk_bf16_f32 v101, v106, v107
    s_nop 7
    s_branch L_Bok
.section .rodata,"a"
.p2align 6
.amdhsa_kernel gated_mix__sliding_block__sliding_local_dilated__prompt_kernel
  .amdhsa_next_free_vgpr 512
  .amdhsa_next_free_sgpr 102
  .amdhsa_accum_offset 256
  .amdhsa_group_segment_fixed_size 0
  .amdhsa_kernarg_size 80
  .amdhsa_user_sgpr_count 2
  .amdhsa_user_sgpr_kernarg_segment_ptr 1
  .amdhsa_system_sgpr_workgroup_id_x 1
  .amdhsa_float_denorm_mode_32 3
.end_amdhsa_kernel
```
